```python
import torch

def _softmax(x, axis=-1):
    return torch.softmax(x, dim=axis)
def _gelu(x):
    return torch.nn.functional.gelu(x, approximate="tanh")
def _silu(x):
    return torch.nn.functional.silu(x)
def _sigmoid(x):
    return torch.sigmoid(x)
def _layernorm(x, axis=-1, eps=1e-5):
    m = x.mean(dim=axis, keepdim=True)
    v = x.var(dim=axis, keepdim=True, unbiased=False)
    return (x - m) / torch.sqrt(v + eps)
def _scatter_add(tgt, idx, src, axis=0):
    return tgt.clone().index_add_(axis, idx, src)
def _segment_sum(src, seg, n):
    out = torch.zeros((n,) + src.shape[1:], dtype=src.dtype)
    return out.index_add_(0, seg, src)
def _pad(x, pw):
    flat = tuple(v for pair in reversed(pw) for v in pair)
    return torch.nn.functional.pad(x, flat)

kernel_name = 'parallel_sum__ssm_conv_s5__swiglu_ffn__prompt'

def setup_inputs():

    _w = (lambda a: (lambda t: t.to(torch.bfloat16) if t.is_floating_point() else t)(torch.as_tensor(a)))
    def _A_setup():
        B, S, D = 1, 2048, 640
        P = D
        Lambda_re = -0.5 * (lambda _x: torch.exp(torch.as_tensor(_x)))((lambda *s: torch.randn(*s, dtype=torch.bfloat16) * 0.8)(P))
        Lambda_im = (lambda *s: torch.randn(*s, dtype=torch.bfloat16) * 0.8)(P) * 1.0
        B_re = (lambda *s: torch.randn(*s, dtype=torch.bfloat16) * 0.8)(P, D) * (D ** -0.5)
        B_im = (lambda *s: torch.randn(*s, dtype=torch.bfloat16) * 0.8)(P, D) * (D ** -0.5)
        C_re = (lambda *s: torch.randn(*s, dtype=torch.bfloat16) * 0.8)(D, P) * (P ** -0.5)
        C_im = (lambda *s: torch.randn(*s, dtype=torch.bfloat16) * 0.8)(D, P) * (P ** -0.5)
        log_dt = (lambda *s: torch.randn(*s, dtype=torch.bfloat16) * 0.8)(P) * 0.3 - 2.0
        Dskip = (lambda *s: torch.randn(*s, dtype=torch.bfloat16) * 0.8)(D)
        return {
            "x": _w((lambda *s: torch.randn(*s, dtype=torch.bfloat16) * 0.05)(B, S, D)),
            "Lambda_re": _w(Lambda_re),
            "Lambda_im": _w(Lambda_im),
            "B_re": _w(B_re),
            "B_im": _w(B_im),
            "C_re": _w(C_re),
            "C_im": _w(C_im),
            "log_dt": _w(log_dt),
            "Dskip": _w(Dskip),
        }
    _A_in = _A_setup()

    def _B_setup():
        B, S, D, F = 1, 2048, 640, 1728
        return {
            "x": _w((lambda *s: torch.randn(*s, dtype=torch.bfloat16) * 0.05)(B, S, D)),
            "w_gate": _w((lambda *s: torch.randn(*s, dtype=torch.bfloat16) * 0.05)(D, F)),
            "w_up": _w((lambda *s: torch.randn(*s, dtype=torch.bfloat16) * 0.05)(D, F)),
            "w_down": _w((lambda *s: torch.randn(*s, dtype=torch.bfloat16) * 0.05)(F, D)),
        }
    _B_in = _B_setup()

    return {
        "A_x": _A_in["x"],
        "A_Lambda_re": _A_in["Lambda_re"],
        "A_Lambda_im": _A_in["Lambda_im"],
        "A_B_re": _A_in["B_re"],
        "A_B_im": _A_in["B_im"],
        "A_C_re": _A_in["C_re"],
        "A_C_im": _A_in["C_im"],
        "A_log_dt": _A_in["log_dt"],
        "A_Dskip": _A_in["Dskip"],
        "B_x": _B_in["x"],
        "B_w_gate": _B_in["w_gate"],
        "B_w_up": _B_in["w_up"],
        "B_w_down": _B_in["w_down"],
    }

def reference(A_x, A_Lambda_re, A_Lambda_im, A_B_re, A_B_im, A_C_re, A_C_im, A_log_dt, A_Dskip, B_x, B_w_gate, B_w_up, B_w_down):
    def _A_ref(x, Lambda_re, Lambda_im, B_re, B_im, C_re, C_im, log_dt, Dskip):
        Bsz, L, H = x.shape
        Lam = Lambda_re + 1j * Lambda_im
        Bmat = B_re + 1j * B_im
        Cmat = C_re + 1j * C_im
        dt = torch.exp(log_dt)
        Lam_bar = torch.exp(dt * Lam)
        B_bar = ((Lam_bar - 1.0) / Lam)[:, None] * Bmat
        Bu = torch.einsum("bld,pd->blp", x + 0j, B_bar)
        h = torch.zeros_like(Bu[:, 0, :])
        hs = []
        for t in range(L):
            h = Lam_bar[None, :] * h + Bu[:, t, :]
            hs.append(h)
        hseq = torch.stack(hs, 1)
        y = 2.0 * torch.einsum("blp,dp->bld", hseq, Cmat).real + x * Dskip[None, None, :]
        return y

    def _B_ref(x, w_gate, w_up, w_down):
        g = _silu(x @ w_gate)
        u = x @ w_up
        return (g * u) @ w_down

    x = A_x
    xn = _layernorm(x, axis=-1)
    return x + _A_ref(xn, A_Lambda_re, A_Lambda_im, A_B_re, A_B_im, A_C_re, A_C_im, A_log_dt, A_Dskip) + _B_ref(xn, B_w_gate, B_w_up, B_w_down)
```

```asm
; @launch grid=(256,1,1) block=(256,1,1) lds=163840
.amdgcn_target "amdgcn-amd-amdhsa--gfx950"
.text
.globl parallel_sum__ssm_conv_s5__swiglu_ffn__prompt_kernel
.p2align 8
.type parallel_sum__ssm_conv_s5__swiglu_ffn__prompt_kernel,@function
parallel_sum__ssm_conv_s5__swiglu_ffn__prompt_kernel:
    s_cmp_ge_u32 s2, 256
    s_cbranch_scc1 L_end
    s_load_dwordx16 s[64:79], s[0:1], 0
    s_load_dwordx16 s[80:95], s[0:1], 64
    s_getpc_b64 s[58:59]
L_pc:
    s_lshr_b32 s56, s2, 3
    s_lshl_b32 s56, s56, 11
    v_lshrrev_b32 v17, 4, v0
    v_lshl_add_u32 v17, v17, 7, s56
    v_min_u32 v17, L_codeend-L_pc-4, v17
    global_load_dword v95, v17, s[58:59]
    v_lshrrev_b32 v16, 6, v0
    v_and_b32 v0, 63, v0
    v_readfirstlane_b32 s40, v16
    s_and_b32 s56, s2, 1
    s_lshl_b32 s56, s56, 2
    s_bfe_u32 s57, s2, 0x20003
    s_add_u32 s41, s56, s57
    s_lshr_b32 s56, s2, 5
    s_lshl_b32 s56, s56, 2
    s_bfe_u32 s57, s2, 0x20001
    s_add_u32 s42, s56, s57
    s_lshl2_add_u32 s49, s41, s40
    s_lshl_b32 s51, s49, 5
    s_add_u32 s51, s51, s42
    s_mul_i32 s56, s42, 3
    s_sub_u32 s56, s56, 54
    s_cmp_lt_u32 s42, 27
    s_cselect_b32 s50, s42, s56
    s_lshl_b32 s43, s40, 14
    s_mul_i32 s44, s40, 5120
    s_add_u32 s44, s44, 65536
    s_mul_i32 s48, s40, 9216
    s_add_u32 s48, s48, 126976
    v_lshlrev_b32 v14, 4, v0
    v_lshrrev_b32 v16, 3, v0
    v_and_b32 v17, 7, v0
    v_lshrrev_b32 v18, 4, v0
    v_xor_b32 v19, v17, v18
    v_lshlrev_b32 v19, 4, v19
    v_lshrrev_b32 v20, 5, v0
    v_and_b32 v21, 3, v16
    v_lshl_add_u32 v21, v20, 4, v21
    v_mul_u32_u24 v21, 1280, v21
    v_add_u32 v1, v21, v19
    v_xor_b32 v2, 64, v1
    v_add_u32 v2, 39936, v2
    s_and_b32 s56, s40, 1
    s_lshl_b32 s57, s56, 6
    s_mul_i32 s56, s56, 10240
    v_mul_u32_u24 v22, 1280, v16
    v_xor_b32 v23, s57, v19
    v_add3_u32 v3, v22, v23, s56
    v_lshl_add_u32 v90, v17, 4, v22
    v_and_b32 v22, 1, v18
    v_lshlrev_b32 v22, 1, v22
    v_xor_b32 v22, v22, v17
    v_mul_u32_u24 v23, 3456, v16
    v_lshl_add_u32 v4, v22, 4, v23
    v_xor_b32 v5, 64, v4
    v_add_u32 v5, 26624, v5
    v_and_b32 v23, 15, v0
    s_lshl_b32 s56, s50, 5
    v_lshl_add_u32 v23, v23, 1, s56
    s_waitcnt lgkmcnt(0)
    s_mul_i32 s56, s49, 81920
    s_add_u32 s4, s64, s56
    s_addc_u32 s5, s65, 0
    s_mov_b32 s6, 81920
    s_mov_b32 s7, 0x20000
    s_cmp_lt_u32 s40, 2
    s_cselect_b32 s8, s70, s72
    s_cselect_b32 s9, s71, s73
    s_mul_i32 s56, s50, 20480
    s_add_u32 s8, s8, s56
    s_addc_u32 s9, s9, 0
    s_sub_u32 s10, 819200, s56
    s_mov_b32 s11, 0x20000
    s_cmp_ge_u32 s42, 27
    s_cbranch_scc1 L_y
    s_and_b32 s56, s49, 15
    s_mul_i32 s56, s56, 27648
    s_lshl_b32 s57, s42, 7
    s_add_u32 s56, s56, s57
    s_cmp_lt_u32 s41, 4
    s_cselect_b32 s36, s84, s86
    s_cselect_b32 s37, s85, s87
    s_add_u32 s36, s36, s56
    s_addc_u32 s37, s37, 0
    s_mov_b32 s38, 1793792
    s_mov_b32 s39, 0x20000
    s_mov_b32 s56, 0x3f803f80
    v_accvgpr_write_b32 a220, s56
    v_accvgpr_write_b32 a221, s56
    v_accvgpr_write_b32 a222, s56
    v_accvgpr_write_b32 a223, s56
    v_lshrrev_b32 v88, 5, v0
    v_mul_u32_u24 v88, 1280, v88
    v_and_b32 v89, 31, v0
    v_cmp_gt_u32 vcc, 16, v89
    v_lshl_add_u32 v88, v89, 4, v88
    v_mov_b32 v89, 0x7fff0000
    v_cndmask_b32 v89, v89, v88, vcc
    s_mul_i32 s56, s51, 2560
    s_add_u32 s32, s64, s56
    s_addc_u32 s33, s65, 0
    s_mov_b32 s34, 2560
    s_mov_b32 s35, 0x20000
    s_add_u32 m0, s48, 4096
    s_mov_b32 s59, 0
    buffer_load_dwordx4 v4, s[36:39], s59 offen lds
    buffer_load_dwordx4 v[76:79], v88, s[32:35], 0 offen
    s_add_u32 m0, s48, 5120
    s_mov_b32 s59, 442368
    buffer_load_dwordx4 v4, s[36:39], s59 offen lds
    buffer_load_dwordx4 v[80:83], v88, s[32:35], 0 offen offset:512
    s_mov_b32 s30, 1280
    s_mov_b32 s31, 0x20000
    s_mov_b32 s28, s66
    s_mov_b32 s29, s67
    buffer_load_ushort v28, v23, s[28:31], 0 offen offset:0
    s_mov_b32 s28, s68
    s_mov_b32 s29, s69
    buffer_load_ushort v29, v23, s[28:31], 0 offen offset:0
    s_mov_b32 s28, s78
    s_mov_b32 s29, s79
    buffer_load_ushort v30, v23, s[28:31], 0 offen offset:0
    s_lshl_b32 s56, s42, 7
    s_mul_i32 s57, s40, 55296
    s_add_u32 s56, s56, s57
    s_sub_u32 s57, 2211840, s56
    s_add_u32 s12, s84, s56
    s_addc_u32 s13, s85, 0
    s_mov_b32 s14, s57
    s_mov_b32 s15, 0x20000
    s_add_u32 s16, s86, s56
    s_addc_u32 s17, s87, 0
    s_mov_b32 s18, s57
    s_mov_b32 s19, 0x20000
    s_add_u32 m0, s48, 6144
    s_mov_b32 s59, 884736
    buffer_load_dwordx4 v4, s[36:39], s59 offen lds
    buffer_load_dwordx4 v[84:87], v89, s[32:35], 0 offen offset:1024
    s_add_u32 m0, s48, 7168
    s_mov_b32 s59, 1327104
    buffer_load_dwordx4 v4, s[36:39], s59 offen lds
    s_add_u32 m0, s48, 8192
    s_mov_b32 s59, 1769472
    buffer_load_dwordx4 v4, s[36:39], s59 offen lds
    s_mul_i32 s56, s40, 216
    s_mul_i32 s57, s41, 27
    s_add_u32 s56, s56, s57
    s_add_u32 s72, s56, s42
    s_cmp_lt_u32 s72, 540
    s_cselect_b32 s56, 0, 540
    s_cselect_b32 s24, s88, s74
    s_cselect_b32 s25, s89, s75
    s_cselect_b32 s28, s88, s76
    s_cselect_b32 s29, s89, s77
    s_cselect_b32 s55, 20480, 0
    s_add_u32 s47, s55, 20480
    s_sub_u32 s56, s72, s56
    s_mul_i32 s58, s56, 6554
    s_lshr_b32 s58, s58, 16
    s_mul_i32 s57, s58, 10
    s_sub_u32 s59, s56, s57
    s_mul_i32 s56, s58, s47
    s_lshl_b32 s57, s59, 7
    s_add_u32 s56, s56, s57
    s_cmp_lt_u32 s72, 940
    s_cselect_b32 s56, s56, 0
    s_cselect_b32 s26, 19328, 0
    s_cselect_b32 s30, 19328, 0
    s_add_u32 s24, s24, s56
    s_addc_u32 s25, s25, 0
    s_add_u32 s56, s56, s55
    s_add_u32 s28, s28, s56
    s_addc_u32 s29, s29, 0
    s_mov_b32 s27, 0x20000
    s_cmp_ge_u32 s72, 540
    s_cbranch_scc1 L_jS_1
    v_lshrrev_b32 v24, 2, v0
    v_and_b32 v25, 3, v0
    s_lshr_b32 s56, s58, 1
    s_and_b32 s57, s58, 1
    s_mul_i32 s57, s57, 12
    s_lshr_b32 s58, s56, 2
    s_add_u32 s57, s57, s58
    s_and_b32 s56, s56, 3
    s_mul_i32 s56, s56, 24
    s_add_u32 s56, s56, s57
    s_mul_i32 s56, s56, 5120
    s_lshl_b32 s57, s59, 12
    s_add_u32 s56, s56, s57
    s_mul_i32 s59, s59, 208
    s_add_u32 s57, s59, 0
    s_lshr_b32 s57, s57, 8
    s_mul_i32 s57, s57, 486400
    s_add_u32 s57, s57, s56
    s_add_u32 s82, s57, 1048576
    s_add_u32 s57, s59, 52
    s_lshr_b32 s57, s57, 8
    s_mul_i32 s57, s57, 486400
    s_add_u32 s57, s57, s56
    s_add_u32 s83, s57, 1049600
    s_add_u32 s57, s59, 104
    s_lshr_b32 s57, s57, 8
    s_mul_i32 s57, s57, 486400
    s_add_u32 s57, s57, s56
    s_add_u32 s100, s57, 1050624
    s_add_u32 s57, s59, 156
    s_lshr_b32 s57, s57, 8
    s_mul_i32 s57, s57, 486400
    s_add_u32 s57, s57, s56
    s_add_u32 s101, s57, 1051648
    s_branch L_jn_2
L_jS_1:
    v_and_b32 v24, 15, v0
    v_lshrrev_b32 v25, 4, v0
    s_mul_i32 s57, s58, 52
    s_lshr_b32 s57, s57, 8
    s_mul_i32 s56, s57, 486400
    s_lshl_b32 s57, s58, 10
    s_add_u32 s56, s56, s57
    s_and_b32 s57, s59, 1
    s_mul_i32 s57, s57, 12
    s_lshr_b32 s59, s59, 1
    s_add_u32 s59, s59, s57
    s_mul_i32 s59, s59, 5120
    s_add_u32 s56, s56, s59
    s_cmp_lt_u32 s72, 940
    s_cselect_b32 s56, s56, 1073741824
    s_add_u32 s82, s56, 1084416
    s_add_u32 s83, s56, 1207296
    s_add_u32 s100, s56, 1330176
    s_add_u32 s101, s56, 1453056
L_jn_2:
    v_lshlrev_b32 v25, 3, v25
    v_lshl_add_u32 v24, v24, 7, v25
    v_add_u32 v91, s48, v24
    s_add_u32 m0, s44, 1024
    s_mov_b32 s45, 0
    buffer_load_dwordx4 v4, s[12:15], s45 offen lds
    s_mov_b64 exec, 0
    s_cmp_eq_u32 s40, 0
    s_cbranch_scc1 L_st_0
    s_cmp_eq_u32 s40, 1
    s_cbranch_scc1 L_st_2
    s_cmp_eq_u32 s40, 2
    s_cbranch_scc1 L_st_4
    s_branch L_st_6
L_tr_x:
    s_mov_b64 exec, -1
    s_nop 0
    s_nop 0
    s_cmp_eq_u32 s40, 3
    s_cselect_b32 s54, 1073741824, 0
    s_mov_b32 s60, 0xffff0000
    s_mov_b32 s61, 0
    s_mov_b32 s62, 0
    s_mov_b32 s63, 0xffff
    s_mov_b32 s96, 0
    s_mov_b32 s97, 0xffff0000
    s_lshl_b32 s56, s49, 5
    s_add_u32 s56, s56, s42
    s_lshl_b32 s56, s56, 7
    s_add_u32 s3, s56, 262144
    s_bfe_u32 s56, s2, 0x20001
    s_bfe_u32 s57, s2, 0x20003
    s_lshl2_add_u32 s56, s56, s57
    s_lshr_b32 s53, s2, 5
    s_and_b32 s57, s2, 1
    s_lshl1_add_u32 s52, s56, s57
    buffer_load_dwordx4 v5, s[12:15], s45 offen offset:1024 lds
    v_and_b32 v22, 15, v0
    v_lshrrev_b32 v23, 1, v22
    v_xor_b32 v23, v23, v18
    v_lshlrev_b32 v23, 4, v23
    v_lshl_add_u32 v24, v22, 7, v23
    v_add_u32 v6, s43, v24
    v_xor_b32 v7, 64, v6
    v_lshrrev_b32 v25, 3, v22
    v_mul_u32_u24 v25, 4096, v25
    v_add_u32 v24, v24, v25
    v_add_u32 v8, 65536, v24
    v_xor_b32 v9, 64, v8
    v_lshrrev_b32 v23, 2, v22
    v_and_b32 v24, 3, v0
    v_lshlrev_b32 v24, 3, v24
    v_lshl_add_u32 v24, v23, 7, v24
    v_lshrrev_b32 v25, 1, v18
    v_mul_u32_u24 v25, 5120, v25
    v_and_b32 v26, 1, v18
    v_lshl_add_u32 v25, v26, 10, v25
    v_add_u32 v25, v24, v25
    v_lshrrev_b32 v23, 1, v23
    v_lshl_or_b32 v23, v26, 1, v23
    v_lshl_add_u32 v25, v23, 5, v25
    v_add_u32 v10, 65536, v25
    s_andn2_b32 s56, 1, s40
    s_lshl_b32 s56, s56, 6
    v_xor_b32 v10, s56, v10
    v_xor_b32 v11, 32, v10
    v_xor_b32 v12, 64, v10
    v_xor_b32 v13, 0x60, v10
    s_add_u32 m0, s44, 3072
    s_nop 0
    buffer_load_dwordx4 v4, s[16:19], s45 offen lds
    s_mov_b32 s20, s94
    s_mov_b32 s21, s95
    s_mov_b32 s22, 268435456
    s_mov_b32 s23, 0x20000
    s_mov_b32 s68, s92
    s_mov_b32 s69, s93
    s_mov_b32 s70, 256
    s_mov_b32 s71, 0x20000
    s_lshl_b32 s56, s40, 11
    s_add_u32 s66, s56, 16384
    s_and_b32 s56, s2, 7
    s_lshl_b32 s56, s56, 5
    s_lshr_b32 s57, s2, 3
    s_add_u32 s56, s56, s57
    s_lshl_b32 s56, s56, 5
    s_add_u32 s56, s56, 16384
    s_cmp_eq_u32 s40, 0
    s_cselect_b32 s67, s56, 1073741824
    v_accvgpr_write_b32 a255, 1
    v_lshlrev_b32 v92, 5, v0
    buffer_load_dwordx4 v5, s[16:19], s45 offen offset:1024 lds
    s_waitcnt vmcnt(8)
    v_lshlrev_b32 v18, 16, v30
    v_mul_f32 v18, 0x3fb8aa3b, v18
    v_exp_f32 v18, v18
    v_lshlrev_b32 v16, 16, v28
    v_lshlrev_b32 v17, 16, v29
    v_cvt_pk_bf16_f32 v18, v18, v18
    v_lshlrev_b32 v18, 16, v18
    v_mul_f32 v19, v18, v16
    v_mul_f32 v20, v18, v17
    v_mul_f32 v19, 0x3fb8aa3b, v19
    v_mul_f32 v20, 0.15915494, v20
    v_exp_f32 v19, v19
    v_rndne_f32 v21, v20
    s_add_u32 m0, s44, 0
    s_mov_b32 s46, 0
    buffer_load_dwordx4 v3, s[8:11], s46 offen lds
    v_sub_f32 v20, v20, v21
    v_cos_f32 v21, v20
    v_sin_f32 v22, v20
    v_mul_f32 v23, v16, v16
    v_fmac_f32 v23, v17, v17
    v_mul_f32 v64, v19, v21
    v_mul_f32 v65, v19, v22
    v_rcp_f32 v23, v23
    v_add_f32 v24, -1.0, v64
    v_mov_b32 v25, v65
    v_add_f32 v23, v23, v23
    v_mul_f32 v26, v16, v23
    v_mul_f32 v27, -v17, v23
    v_pk_mul_f32 v[66:67], v[26:27], v[24:25] op_sel_hi:[1,0]
    v_pk_fma_f32 v[66:67], v[26:27], v[24:25], v[66:67] op_sel:[1,1,0] op_sel_hi:[0,1,1] neg_lo:[1,0,0]
    s_add_u32 m0, s43, 0
    s_mov_b32 s45, 0
    buffer_load_dwordx4 v1, s[4:7], s45 offen lds
    v_pk_mul_f32 v[16:17], v[64:65], v[64:65] op_sel_hi:[1,0]
    v_pk_fma_f32 v[16:17], v[64:65], v[64:65], v[16:17] op_sel:[1,1,0] op_sel_hi:[0,1,1] neg_lo:[1,0,0]
    v_pk_mul_f32 v[18:19], v[16:17], v[16:17] op_sel_hi:[1,0]
    v_pk_fma_f32 v[18:19], v[16:17], v[16:17], v[18:19] op_sel:[1,1,0] op_sel_hi:[0,1,1] neg_lo:[1,0,0]
    v_pk_mul_f32 v[16:17], v[18:19], v[18:19] op_sel_hi:[1,0]
    v_pk_fma_f32 v[16:17], v[18:19], v[18:19], v[16:17] op_sel:[1,1,0] op_sel_hi:[0,1,1] neg_lo:[1,0,0]
    v_pk_mul_f32 v[68:69], v[16:17], v[16:17] op_sel_hi:[1,0]
    v_pk_fma_f32 v[68:69], v[16:17], v[16:17], v[68:69] op_sel:[1,1,0] op_sel_hi:[0,1,1] neg_lo:[1,0,0]
    v_pk_mul_f32 v[18:19], v[68:69], v[68:69] op_sel_hi:[1,0]
    v_pk_fma_f32 v[18:19], v[68:69], v[68:69], v[18:19] op_sel:[1,1,0] op_sel_hi:[0,1,1] neg_lo:[1,0,0]
    v_pk_mul_f32 v[20:21], v[18:19], v[68:69] op_sel_hi:[1,0]
    v_pk_fma_f32 v[20:21], v[18:19], v[68:69], v[20:21] op_sel:[1,1,0] op_sel_hi:[0,1,1] neg_lo:[1,0,0]
    v_pk_mul_f32 v[70:71], v[18:19], v[18:19] op_sel_hi:[1,0]
    v_pk_fma_f32 v[70:71], v[18:19], v[18:19], v[70:71] op_sel:[1,1,0] op_sel_hi:[0,1,1] neg_lo:[1,0,0]
    buffer_load_dwordx4 v2, s[4:7], s45 offen offset:1024 lds
    v_pk_mul_f32 v[16:17], v[70:71], v[70:71] op_sel_hi:[1,0]
    v_pk_fma_f32 v[16:17], v[70:71], v[70:71], v[16:17] op_sel:[1,1,0] op_sel_hi:[0,1,1] neg_lo:[1,0,0]
    v_pk_mul_f32 v[22:23], v[16:17], v[16:17] op_sel_hi:[1,0]
    v_pk_fma_f32 v[22:23], v[16:17], v[16:17], v[22:23] op_sel:[1,1,0] op_sel_hi:[0,1,1] neg_lo:[1,0,0]
    v_pk_mul_f32 v[16:17], v[22:23], v[22:23] op_sel_hi:[1,0]
    v_pk_fma_f32 v[16:17], v[22:23], v[22:23], v[16:17] op_sel:[1,1,0] op_sel_hi:[0,1,1] neg_lo:[1,0,0]
    v_pk_mul_f32 v[22:23], v[16:17], v[16:17] op_sel_hi:[1,0]
    v_pk_fma_f32 v[22:23], v[16:17], v[16:17], v[22:23] op_sel:[1,1,0] op_sel_hi:[0,1,1] neg_lo:[1,0,0]
    v_pk_mul_f32 v[24:25], v[22:23], v[16:17] op_sel_hi:[1,0]
    v_pk_fma_f32 v[24:25], v[22:23], v[16:17], v[24:25] op_sel:[1,1,0] op_sel_hi:[0,1,1] neg_lo:[1,0,0]
    v_cndmask_b32 v72, 1.0, v68, s[60:61]
    v_cndmask_b32 v72, v72, v18, s[62:63]
    v_cndmask_b32 v72, v72, v20, s[96:97]
    v_cndmask_b32 v74, v24, v22, s[60:61]
    v_cndmask_b32 v74, v74, v16, s[62:63]
    v_cndmask_b32 v74, v74, 1.0, s[96:97]
    s_add_u32 m0, s43, 2048
    s_mov_b32 s46, 5120
    buffer_load_dwordx4 v1, s[4:7], s46 offen lds
    v_cndmask_b32 v73, 0, v69, s[60:61]
    v_cndmask_b32 v73, v73, v19, s[62:63]
    v_cndmask_b32 v73, v73, v21, s[96:97]
    v_cndmask_b32 v75, v25, v23, s[60:61]
    v_cndmask_b32 v75, v75, v17, s[62:63]
    v_cndmask_b32 v75, v75, 0, s[96:97]
    s_branch L_al
.p2align 12
L_al:
L_st_0:
    s_cbranch_execz L_st_1
    s_waitcnt vmcnt(10)
    s_mov_b32 s58, 0x3f803f80
    s_mov_b32 s59, 0xffff0000
    v_mov_b32 v38, 0
    v_dot2_f32_bf16 v38, v76, s58, v38
    v_dot2_f32_bf16 v38, v77, s58, v38
    v_dot2_f32_bf16 v38, v78, s58, v38
    v_dot2_f32_bf16 v38, v79, s58, v38
    v_dot2_f32_bf16 v38, v80, s58, v38
    v_dot2_f32_bf16 v38, v81, s58, v38
    v_dot2_f32_bf16 v38, v82, s58, v38
    v_dot2_f32_bf16 v38, v83, s58, v38
    v_dot2_f32_bf16 v38, v84, s58, v38
    v_dot2_f32_bf16 v38, v85, s58, v38
    v_dot2_f32_bf16 v38, v86, s58, v38
    v_dot2_f32_bf16 v38, v87, s58, v38
    buffer_load_dwordx4 v2, s[4:7], s46 offen offset:1024 lds
    s_nop 2
    v_add_f32_dpp v38, v38, v38 quad_perm:[1,0,3,2] row_mask:0xf bank_mask:0xf
    s_nop 1
    v_add_f32_dpp v38, v38, v38 quad_perm:[2,3,0,1] row_mask:0xf bank_mask:0xf
    s_nop 1
    v_add_f32_dpp v38, v38, v38 row_half_mirror row_mask:0xf bank_mask:0xf
    s_nop 1
    v_add_f32_dpp v38, v38, v38 row_mirror row_mask:0xf bank_mask:0xf
    s_nop 1
    v_mov_b32 v39, v38
    s_nop 1
    v_permlane16_swap_b32 v38, v39
    s_nop 0
    v_add_f32 v38, v38, v39
    s_add_u32 m0, s43, 4096
    s_mov_b32 s45, 10240
    buffer_load_dwordx4 v1, s[4:7], s45 offen lds
    v_mul_f32 v38, -0.0015625, v38
    v_mov_b32 v40, 0
    v_mov_b32 v41, 0
    v_mov_b32 v42, 0
    v_mov_b32 v43, 0
    v_lshlrev_b32 v44, 16, v76
    v_and_b32 v45, s59, v76
    v_pk_add_f32 v[44:45], v[44:45], v[38:39] op_sel_hi:[1,0]
    v_pk_fma_f32 v[40:41], v[44:45], v[44:45], v[40:41]
    v_lshlrev_b32 v46, 16, v77
    v_and_b32 v47, s59, v77
    v_pk_add_f32 v[46:47], v[46:47], v[38:39] op_sel_hi:[1,0]
    v_pk_fma_f32 v[40:41], v[46:47], v[46:47], v[40:41]
    v_lshlrev_b32 v44, 16, v78
    v_and_b32 v45, s59, v78
    v_pk_add_f32 v[44:45], v[44:45], v[38:39] op_sel_hi:[1,0]
    v_pk_fma_f32 v[40:41], v[44:45], v[44:45], v[40:41]
    buffer_load_dwordx4 v2, s[4:7], s45 offen offset:1024 lds
    v_lshlrev_b32 v46, 16, v79
    v_and_b32 v47, s59, v79
    v_pk_add_f32 v[46:47], v[46:47], v[38:39] op_sel_hi:[1,0]
    v_pk_fma_f32 v[40:41], v[46:47], v[46:47], v[40:41]
    v_lshlrev_b32 v44, 16, v80
    v_and_b32 v45, s59, v80
    v_pk_add_f32 v[44:45], v[44:45], v[38:39] op_sel_hi:[1,0]
    v_pk_fma_f32 v[40:41], v[44:45], v[44:45], v[40:41]
    v_lshlrev_b32 v46, 16, v81
    v_and_b32 v47, s59, v81
    v_pk_add_f32 v[46:47], v[46:47], v[38:39] op_sel_hi:[1,0]
    v_pk_fma_f32 v[40:41], v[46:47], v[46:47], v[40:41]
    v_lshlrev_b32 v44, 16, v82
    v_and_b32 v45, s59, v82
    v_pk_add_f32 v[44:45], v[44:45], v[38:39] op_sel_hi:[1,0]
    v_pk_fma_f32 v[40:41], v[44:45], v[44:45], v[40:41]
    s_add_u32 m0, s43, 6144
    s_mov_b32 s46, 15360
    buffer_load_dwordx4 v1, s[4:7], s46 offen lds
    v_lshlrev_b32 v46, 16, v83
    v_and_b32 v47, s59, v83
    v_pk_add_f32 v[46:47], v[46:47], v[38:39] op_sel_hi:[1,0]
    v_pk_fma_f32 v[40:41], v[46:47], v[46:47], v[40:41]
    v_lshlrev_b32 v44, 16, v84
    v_and_b32 v45, s59, v84
    v_pk_add_f32 v[44:45], v[44:45], v[38:39] op_sel_hi:[1,0]
    v_pk_fma_f32 v[42:43], v[44:45], v[44:45], v[42:43]
    v_lshlrev_b32 v46, 16, v85
    v_and_b32 v47, s59, v85
    v_pk_add_f32 v[46:47], v[46:47], v[38:39] op_sel_hi:[1,0]
    v_pk_fma_f32 v[42:43], v[46:47], v[46:47], v[42:43]
    v_lshlrev_b32 v44, 16, v86
    v_and_b32 v45, s59, v86
    v_pk_add_f32 v[44:45], v[44:45], v[38:39] op_sel_hi:[1,0]
    v_pk_fma_f32 v[42:43], v[44:45], v[44:45], v[42:43]
    buffer_load_dwordx4 v2, s[4:7], s46 offen offset:1024 lds
    v_lshlrev_b32 v46, 16, v87
    v_and_b32 v47, s59, v87
    v_pk_add_f32 v[46:47], v[46:47], v[38:39] op_sel_hi:[1,0]
    v_pk_fma_f32 v[42:43], v[46:47], v[46:47], v[42:43]
    v_and_b32 v44, 31, v0
    v_cmp_gt_u32 vcc, 16, v44
    v_add_f32 v42, v42, v43
    v_add_f32 v40, v40, v41
    v_cndmask_b32 v42, 0, v42, vcc
    v_add_f32 v40, v40, v42
    s_nop 2
    v_add_f32_dpp v40, v40, v40 quad_perm:[1,0,3,2] row_mask:0xf bank_mask:0xf
    s_nop 1
    v_add_f32_dpp v40, v40, v40 quad_perm:[2,3,0,1] row_mask:0xf bank_mask:0xf
    s_nop 1
    v_add_f32_dpp v40, v40, v40 row_half_mirror row_mask:0xf bank_mask:0xf
    s_nop 1
    v_add_f32_dpp v40, v40, v40 row_mirror row_mask:0xf bank_mask:0xf
    s_nop 1
    v_mov_b32 v41, v40
    s_nop 1
    v_permlane16_swap_b32 v40, v41
    s_nop 0
    v_add_f32 v40, v40, v41
    s_add_u32 m0, s48, 0
    s_mov_b32 s47, 0
    buffer_load_dwordx4 v90, s[24:27], s47 offen lds
    v_mul_f32 v40, 0.0015625, v40
    v_cvt_pk_bf16_f32 v40, v40, v38
    v_and_b32 v38, s59, v40
    v_lshlrev_b32 v40, 16, v40
    v_add_f32 v40, 0x3727c5ac, v40
    v_cvt_pk_bf16_f32 v40, v40, v40
    v_lshlrev_b32 v40, 16, v40
    v_sqrt_f32 v40, v40
    v_lshrrev_b32 v41, 5, v0
    v_cvt_pk_bf16_f32 v40, v40, v40
    v_lshlrev_b32 v40, 16, v40
    v_rcp_f32 v39, v40
    v_lshlrev_b32 v41, 3, v41
    v_lshrrev_b32 v88, 4, v0
    v_mul_u32_u24 v88, 9216, v88
    v_bfe_u32 v89, v0, 2, 2
    v_lshl_add_u32 v88, v89, 7, v88
    v_and_b32 v89, 3, v0
    v_lshl_add_u32 v88, v89, 3, v88
    v_bfe_u32 v89, v0, 3, 1
    v_xor_b32 v89, s40, v89
    v_lshl_add_u32 v88, v89, 5, v88
    v_add_u32 v88, 131072, v88
    v_lshlrev_b32 v89, 28, v0
    v_or_b32 v89, v89, v0
    s_waitcnt vmcnt(14)
    s_barrier
    ds_read_b64_tr_b16 a[200:201], v88 offset:0
    ds_read_b64_tr_b16 a[202:203], v88 offset:512
    ds_read_b64_tr_b16 a[204:205], v88 offset:1024
    ds_read_b64_tr_b16 a[206:207], v88 offset:1536
    ds_read_b64_tr_b16 a[208:209], v88 offset:2048
    ds_read_b64_tr_b16 a[210:211], v88 offset:2560
    ds_read_b64_tr_b16 a[212:213], v88 offset:3072
    ds_read_b64_tr_b16 a[214:215], v88 offset:3584
    ds_read_b64_tr_b16 a[216:217], v88 offset:4096
    ds_read_b64_tr_b16 a[218:219], v88 offset:4608
    s_lshl_b32 s56, s51, 4
    s_mov_b32 exec_lo, 1
    s_mov_b32 exec_hi, 1
    buffer_store_dwordx2 v[38:39], v41, s[20:23], s56 offen sc1
    s_mov_b64 exec, -1
    s_waitcnt lgkmcnt(8)
    v_mfma_f32_16x16x32_bf16 a[224:227], a[200:203], a[220:223], 0
    s_waitcnt lgkmcnt(6)
    v_mfma_f32_16x16x32_bf16 a[224:227], a[204:207], a[220:223], a[224:227]
    s_waitcnt lgkmcnt(4)
    v_mfma_f32_16x16x32_bf16 a[224:227], a[208:211], a[220:223], a[224:227]
    s_waitcnt lgkmcnt(2)
    v_mfma_f32_16x16x32_bf16 a[224:227], a[212:215], a[220:223], a[224:227]
    s_waitcnt lgkmcnt(0)
    v_mfma_f32_16x16x32_bf16 a[224:227], a[216:219], a[220:223], a[224:227]
    s_lshl2_add_u32 s56, s42, s40
    s_lshl_b32 s56, s56, 6
    s_lshl_b32 s57, s41, 13
    s_add_u32 s56, s56, s57
    s_add_u32 s56, s56, 655360
    s_nop 3
    buffer_store_dwordx4 a[224:227], v89, s[20:23], s56 offen sc1
    s_lshl2_add_u32 s56, s53, s40
    s_and_b32 s57, s52, 1
    s_lshl1_add_u32 s56, s56, s57
    s_mul_i32 s56, s56, 61440
    s_add_u32 s56, s56, 1048576
    s_add_u32 s36, s94, s56
    s_addc_u32 s37, s95, 0
    s_mov_b32 s38, 61440
    s_mov_b32 s39, 0x20000
    s_andn2_b32 s56, s52, 1
    s_lshl2_add_u32 s56, s56, s40
    s_and_b32 s57, s52, 1
    s_lshl1_add_u32 s56, s56, s57
    s_mul_i32 s56, s56, 49152
    s_add_u32 s56, s56, 5242880
    s_add_u32 s32, s94, s56
    s_addc_u32 s33, s95, 0
    s_mov_b32 s34, 442368
    s_mov_b32 s35, 0x20000
    s_add_u32 m0, s48, 1024
    s_mov_b32 s47, 10240
    buffer_load_dwordx4 v90, s[24:27], s47 offen lds
    s_add_u32 m0, s48, 2048
    s_mov_b32 s47, 0
    buffer_load_dwordx4 v90, s[28:31], s47 offen lds
    s_add_u32 m0, s48, 3072
    s_mov_b32 s47, 10240
    buffer_load_dwordx4 v90, s[28:31], s47 offen lds
    s_add_u32 m0, s44, 21504
    s_mov_b32 s45, 221184
    buffer_load_dwordx4 v4, s[12:15], s45 offen lds
    buffer_load_dwordx4 v5, s[12:15], s45 offen offset:1024 lds
    s_add_u32 m0, s44, 23552
    s_nop 0
    buffer_load_dwordx4 v4, s[16:19], s45 offen lds
    buffer_load_dwordx4 v5, s[16:19], s45 offen offset:1024 lds
    s_add_u32 m0, s44, 20480
    s_mov_b32 s46, 128
    buffer_load_dwordx4 v3, s[8:11], s46 offen lds
    s_add_u32 m0, s43, 8192
    s_mov_b32 s45, 128
    buffer_load_dwordx4 v1, s[4:7], s45 offen lds
    buffer_load_dwordx4 v2, s[4:7], s45 offen offset:1024 lds
    s_add_u32 m0, s43, 10240
    s_mov_b32 s46, 5248
    buffer_load_dwordx4 v1, s[4:7], s46 offen lds
    buffer_load_dwordx4 v2, s[4:7], s46 offen offset:1024 lds
    s_waitcnt vmcnt(15)
    s_barrier
    ds_read_b128 v[16:19], v6 offset:0
    ds_read_b128 v[20:23], v6 offset:2048
    ds_read_b128 v[24:27], v6 offset:4096
    ds_read_b128 v[28:31], v6 offset:6144
    ds_read_b128 v[48:51], v8 offset:0
    ds_read_b128 v[52:55], v8 offset:10240
    ds_read_b64_tr_b16 v[56:57], v10 offset:1024
    ds_read_b64_tr_b16 v[58:59], v10 offset:1536
    s_waitcnt lgkmcnt(3)
    v_mfma_f32_16x16x32_bf16 v[96:99], v[16:19], v[48:51], 0
    s_mov_b32 s45, 10368
    ds_read_b64_tr_b16 v[60:61], v10 offset:3072
    v_mfma_f32_16x16x32_bf16 v[100:103], v[20:23], v[48:51], 0
    s_add_u32 m0, s43, 12288
    ds_read_b64_tr_b16 v[62:63], v10 offset:3584
    v_mfma_f32_16x16x32_bf16 v[104:107], v[24:27], v[48:51], 0
    buffer_load_dwordx4 v1, s[4:7], s45 offen lds
    v_mfma_f32_16x16x32_bf16 v[108:111], v[28:31], v[48:51], 0
    s_waitcnt lgkmcnt(4)
    v_mfma_f32_16x16x32_bf16 v[112:115], v[16:19], v[52:55], 0
    ds_read_b64_tr_b16 v[48:49], v11 offset:1024
    v_mfma_f32_16x16x32_bf16 v[116:119], v[20:23], v[52:55], 0
    ds_read_b64_tr_b16 v[50:51], v11 offset:1536
    v_mfma_f32_16x16x32_bf16 v[120:123], v[24:27], v[52:55], 0
    buffer_load_dwordx4 v2, s[4:7], s45 offen offset:1024 lds
    v_mfma_f32_16x16x32_bf16 v[124:127], v[28:31], v[52:55], 0
    s_waitcnt lgkmcnt(4)
    v_mfma_f32_16x16x32_bf16 v[128:131], v[56:59], v[16:19], 0
    s_mov_b32 s46, 15488
    ds_read_b64_tr_b16 v[52:53], v11 offset:3072
    v_mfma_f32_16x16x32_bf16 v[132:135], v[56:59], v[20:23], 0
    s_add_u32 m0, s43, 14336
    ds_read_b64_tr_b16 v[54:55], v11 offset:3584
    v_mfma_f32_16x16x32_bf16 v[136:139], v[56:59], v[24:27], 0
    buffer_load_dwordx4 v1, s[4:7], s46 offen lds
    v_mfma_f32_16x16x32_bf16 v[140:143], v[56:59], v[28:31], 0
    s_waitcnt lgkmcnt(4)
    v_mfma_f32_16x16x32_bf16 v[144:147], v[60:63], v[16:19], 0
    ds_read_b64_tr_b16 v[56:57], v12 offset:1024
    v_mfma_f32_16x16x32_bf16 v[148:151], v[60:63], v[20:23], 0
    ds_read_b64_tr_b16 v[58:59], v12 offset:1536
    v_mfma_f32_16x16x32_bf16 v[152:155], v[60:63], v[24:27], 0
    buffer_load_dwordx4 v2, s[4:7], s46 offen offset:1024 lds
    v_mfma_f32_16x16x32_bf16 v[156:159], v[60:63], v[28:31], 0
    s_waitcnt lgkmcnt(4)
    v_mfma_f32_16x16x32_bf16 v[160:163], v[48:51], v[16:19], 0
    s_mov_b32 s45, 442368
    ds_read_b64_tr_b16 v[60:61], v12 offset:3072
    v_mfma_f32_16x16x32_bf16 v[164:167], v[48:51], v[20:23], 0
    s_add_u32 m0, s44, 41984
    ds_read_b64_tr_b16 v[62:63], v12 offset:3584
    v_mfma_f32_16x16x32_bf16 v[168:171], v[48:51], v[24:27], 0
    buffer_load_dwordx4 v4, s[12:15], s45 offen lds
    v_mfma_f32_16x16x32_bf16 v[172:175], v[48:51], v[28:31], 0
    s_waitcnt lgkmcnt(4)
    v_mfma_f32_16x16x32_bf16 v[176:179], v[52:55], v[16:19], 0
    ds_read_b64_tr_b16 v[48:49], v13 offset:1024
    v_mfma_f32_16x16x32_bf16 v[180:183], v[52:55], v[20:23], 0
    ds_read_b64_tr_b16 v[50:51], v13 offset:1536
    v_mfma_f32_16x16x32_bf16 v[184:187], v[52:55], v[24:27], 0
    buffer_load_dwordx4 v5, s[12:15], s45 offen offset:1024 lds
    v_mfma_f32_16x16x32_bf16 v[188:191], v[52:55], v[28:31], 0
    s_waitcnt lgkmcnt(4)
    v_mfma_f32_16x16x32_bf16 v[192:195], v[56:59], v[16:19], 0
    ds_read_b64_tr_b16 v[52:53], v13 offset:3072
    v_mfma_f32_16x16x32_bf16 v[196:199], v[56:59], v[20:23], 0
    s_add_u32 m0, s44, 44032
    ds_read_b64_tr_b16 v[54:55], v13 offset:3584
    v_mfma_f32_16x16x32_bf16 v[200:203], v[56:59], v[24:27], 0
    buffer_load_dwordx4 v4, s[16:19], s45 offen lds
    v_mfma_f32_16x16x32_bf16 v[204:207], v[56:59], v[28:31], 0
    s_waitcnt lgkmcnt(4)
    v_mfma_f32_16x16x32_bf16 v[208:211], v[60:63], v[16:19], 0
    ds_read_b128 v[56:59], v9 offset:0
    v_mfma_f32_16x16x32_bf16 v[212:215], v[60:63], v[20:23], 0
    buffer_load_dwordx4 v5, s[16:19], s45 offen offset:1024 lds
    v_mfma_f32_16x16x32_bf16 v[216:219], v[60:63], v[24:27], 0
    ds_read_b128 v[32:35], v7 offset:0
    v_mfma_f32_16x16x32_bf16 v[220:223], v[60:63], v[28:31], 0
    s_waitcnt lgkmcnt(4)
    s_mov_b32 s46, 256
    ds_read_b128 v[36:39], v7 offset:2048
    v_mfma_f32_16x16x32_bf16 v[224:227], v[48:51], v[16:19], 0
    s_add_u32 m0, s44, 40960
    ds_read_b128 v[60:63], v9 offset:10240
    v_mfma_f32_16x16x32_bf16 v[228:231], v[48:51], v[20:23], 0
    buffer_load_dwordx4 v3, s[8:11], s46 offen lds
    v_mfma_f32_16x16x32_bf16 v[232:235], v[48:51], v[24:27], 0
    ds_read_b128 v[40:43], v7 offset:4096
    v_mfma_f32_16x16x32_bf16 v[236:239], v[48:51], v[28:31], 0
    s_waitcnt lgkmcnt(5)
    ds_read_b128 v[44:47], v7 offset:6144
    v_mfma_f32_16x16x32_bf16 v[240:243], v[52:55], v[16:19], 0
    s_mov_b32 s45, 256
    ds_read_b64_tr_b16 v[48:49], v10 offset:11264
    v_mfma_f32_16x16x32_bf16 v[244:247], v[52:55], v[20:23], 0
    s_add_u32 m0, s43, 0
    ds_read_b64_tr_b16 v[50:51], v10 offset:11776
    v_mfma_f32_16x16x32_bf16 v[248:251], v[52:55], v[24:27], 0
    buffer_load_dwordx4 v1, s[4:7], s45 offen lds
    v_mfma_f32_16x16x32_bf16 v[252:255], v[52:55], v[28:31], 0
    s_waitcnt lgkmcnt(6)
    v_mfma_f32_16x16x32_bf16 v[96:99], v[32:35], v[56:59], v[96:99]
    s_waitcnt lgkmcnt(5)
    ds_read_b64_tr_b16 v[52:53], v10 offset:13312
    v_mfma_f32_16x16x32_bf16 v[100:103], v[36:39], v[56:59], v[100:103]
    s_waitcnt lgkmcnt(4)
    ds_read_b64_tr_b16 v[54:55], v10 offset:13824
    v_mfma_f32_16x16x32_bf16 v[104:107], v[40:43], v[56:59], v[104:107]
    s_waitcnt lgkmcnt(4)
    buffer_load_dwordx4 v2, s[4:7], s45 offen offset:1024 lds
    v_mfma_f32_16x16x32_bf16 v[108:111], v[44:47], v[56:59], v[108:111]
    v_mfma_f32_16x16x32_bf16 v[112:115], v[32:35], v[60:63], v[112:115]
    s_mov_b32 s46, 5376
    ds_read_b64_tr_b16 v[56:57], v11 offset:11264
    v_mfma_f32_16x16x32_bf16 v[116:119], v[36:39], v[60:63], v[116:119]
    s_add_u32 m0, s43, 2048
    ds_read_b64_tr_b16 v[58:59], v11 offset:11776
    v_mfma_f32_16x16x32_bf16 v[120:123], v[40:43], v[60:63], v[120:123]
    buffer_load_dwordx4 v1, s[4:7], s46 offen lds
    v_mfma_f32_16x16x32_bf16 v[124:127], v[44:47], v[60:63], v[124:127]
    s_waitcnt lgkmcnt(4)
    v_mfma_f32_16x16x32_bf16 v[128:131], v[48:51], v[32:35], v[128:131]
    ds_read_b64_tr_b16 v[60:61], v11 offset:13312
    v_mfma_f32_16x16x32_bf16 v[132:135], v[48:51], v[36:39], v[132:135]
    ds_read_b64_tr_b16 v[62:63], v11 offset:13824
    v_mfma_f32_16x16x32_bf16 v[136:139], v[48:51], v[40:43], v[136:139]
    buffer_load_dwordx4 v2, s[4:7], s46 offen offset:1024 lds
    v_mfma_f32_16x16x32_bf16 v[140:143], v[48:51], v[44:47], v[140:143]
    s_waitcnt lgkmcnt(4)
    v_mfma_f32_16x16x32_bf16 v[144:147], v[52:55], v[32:35], v[144:147]
    s_mov_b32 s45, 10496
    ds_read_b64_tr_b16 v[48:49], v12 offset:11264
    v_mfma_f32_16x16x32_bf16 v[148:151], v[52:55], v[36:39], v[148:151]
    s_add_u32 m0, s43, 4096
    ds_read_b64_tr_b16 v[50:51], v12 offset:11776
    v_mfma_f32_16x16x32_bf16 v[152:155], v[52:55], v[40:43], v[152:155]
    buffer_load_dwordx4 v1, s[4:7], s45 offen lds
    v_mfma_f32_16x16x32_bf16 v[156:159], v[52:55], v[44:47], v[156:159]
    s_waitcnt lgkmcnt(4)
    v_mfma_f32_16x16x32_bf16 v[160:163], v[56:59], v[32:35], v[160:163]
    ds_read_b64_tr_b16 v[52:53], v12 offset:13312
    v_mfma_f32_16x16x32_bf16 v[164:167], v[56:59], v[36:39], v[164:167]
    ds_read_b64_tr_b16 v[54:55], v12 offset:13824
    v_mfma_f32_16x16x32_bf16 v[168:171], v[56:59], v[40:43], v[168:171]
    buffer_load_dwordx4 v2, s[4:7], s45 offen offset:1024 lds
    v_mfma_f32_16x16x32_bf16 v[172:175], v[56:59], v[44:47], v[172:175]
    s_waitcnt lgkmcnt(4)
    v_mfma_f32_16x16x32_bf16 v[176:179], v[60:63], v[32:35], v[176:179]
    s_mov_b32 s46, 15616
    ds_read_b64_tr_b16 v[56:57], v13 offset:11264
    v_mfma_f32_16x16x32_bf16 v[180:183], v[60:63], v[36:39], v[180:183]
    s_add_u32 m0, s43, 6144
    ds_read_b64_tr_b16 v[58:59], v13 offset:11776
    v_mfma_f32_16x16x32_bf16 v[184:187], v[60:63], v[40:43], v[184:187]
    buffer_load_dwordx4 v1, s[4:7], s46 offen lds
    v_mfma_f32_16x16x32_bf16 v[188:191], v[60:63], v[44:47], v[188:191]
    s_waitcnt lgkmcnt(4)
    s_waitcnt vmcnt(25)
    s_cmp_ge_u32 s72, 540
    s_cbranch_scc1 L_rS_3
    ds_read_b64_tr_b16 a[184:185], v91 offset:0
    ds_read_b64_tr_b16 a[186:187], v91 offset:2048
    ds_read_b64_tr_b16 a[188:189], v91 offset:32
    ds_read_b64_tr_b16 a[190:191], v91 offset:2080
    ds_read_b64_tr_b16 a[192:193], v91 offset:64
    ds_read_b64_tr_b16 a[194:195], v91 offset:2112
    ds_read_b64_tr_b16 a[196:197], v91 offset:96
    ds_read_b64_tr_b16 a[198:199], v91 offset:2144
    s_branch L_rn_4
L_rS_3:
    ds_read_b64 a[184:185], v91 offset:0
    ds_read_b64 a[186:187], v91 offset:2048
    ds_read_b64 a[188:189], v91 offset:32
    ds_read_b64 a[190:191], v91 offset:2080
    ds_read_b64 a[192:193], v91 offset:64
    ds_read_b64 a[194:195], v91 offset:2112
    ds_read_b64 a[196:197], v91 offset:96
    ds_read_b64 a[198:199], v91 offset:2144
L_rn_4:
    v_mfma_f32_16x16x32_bf16 v[192:195], v[48:51], v[32:35], v[192:195]
    ds_read_b64_tr_b16 v[60:61], v13 offset:13312
    v_mfma_f32_16x16x32_bf16 v[196:199], v[48:51], v[36:39], v[196:199]
    ds_read_b64_tr_b16 v[62:63], v13 offset:13824
    v_mfma_f32_16x16x32_bf16 v[200:203], v[48:51], v[40:43], v[200:203]
    buffer_load_dwordx4 v2, s[4:7], s46 offen offset:1024 lds
    v_mfma_f32_16x16x32_bf16 v[204:207], v[48:51], v[44:47], v[204:207]
    s_waitcnt lgkmcnt(12)
    s_waitcnt vmcnt(13)
    s_barrier
    v_mfma_f32_16x16x32_bf16 v[208:211], v[52:55], v[32:35], v[208:211]
    ds_read_b128 v[48:51], v8 offset:20480
    v_mfma_f32_16x16x32_bf16 v[212:215], v[52:55], v[36:39], v[212:215]
    v_mfma_f32_16x16x32_bf16 v[216:219], v[52:55], v[40:43], v[216:219]
    ds_read_b128 v[16:19], v6 offset:8192
    v_mfma_f32_16x16x32_bf16 v[220:223], v[52:55], v[44:47], v[220:223]
    s_waitcnt lgkmcnt(12)
    ds_read_b128 v[20:23], v6 offset:10240
    v_mfma_f32_16x16x32_bf16 v[224:227], v[56:59], v[32:35], v[224:227]
    ds_read_b128 v[52:55], v8 offset:30720
    v_mfma_f32_16x16x32_bf16 v[228:231], v[56:59], v[36:39], v[228:231]
    s_waitcnt lgkmcnt(12)
    buffer_store_dwordx4 a[184:187], v14, s[20:23], s82 offen sc1
    v_mfma_f32_16x16x32_bf16 v[232:235], v[56:59], v[40:43], v[232:235]
    ds_read_b128 v[24:27], v6 offset:12288
    v_mfma_f32_16x16x32_bf16 v[236:239], v[56:59], v[44:47], v[236:239]
    s_waitcnt lgkmcnt(5)
    ds_read_b128 v[28:31], v6 offset:14336
    v_mfma_f32_16x16x32_bf16 v[240:243], v[60:63], v[32:35], v[240:243]
    ds_read_b64_tr_b16 v[56:57], v10 offset:21504
    v_mfma_f32_16x16x32_bf16 v[244:247], v[60:63], v[36:39], v[244:247]
    ds_read_b64_tr_b16 v[58:59], v10 offset:22016
    v_mfma_f32_16x16x32_bf16 v[248:251], v[60:63], v[40:43], v[248:251]
    v_mfma_f32_16x16x32_bf16 v[252:255], v[60:63], v[44:47], v[252:255]
    s_waitcnt lgkmcnt(6)
    v_mfma_f32_16x16x32_bf16 v[96:99], v[16:19], v[48:51], v[96:99]
    s_waitcnt lgkmcnt(5)
    s_mov_b32 s45, 663552
    ds_read_b64_tr_b16 v[60:61], v10 offset:23552
    v_mfma_f32_16x16x32_bf16 v[100:103], v[20:23], v[48:51], v[100:103]
    s_waitcnt lgkmcnt(4)
    s_add_u32 m0, s44, 1024
    ds_read_b64_tr_b16 v[62:63], v10 offset:24064
    v_mfma_f32_16x16x32_bf16 v[104:107], v[24:27], v[48:51], v[104:107]
    s_waitcnt lgkmcnt(4)
    buffer_load_dwordx4 v4, s[12:15], s45 offen lds
    v_mfma_f32_16x16x32_bf16 v[108:111], v[28:31], v[48:51], v[108:111]
    buffer_store_dwordx4 a[188:191], v14, s[20:23], s83 offen sc1
    v_mfma_f32_16x16x32_bf16 v[112:115], v[16:19], v[52:55], v[112:115]
    ds_read_b64_tr_b16 v[48:49], v11 offset:21504
    v_mfma_f32_16x16x32_bf16 v[116:119], v[20:23], v[52:55], v[116:119]
    ds_read_b64_tr_b16 v[50:51], v11 offset:22016
    v_mfma_f32_16x16x32_bf16 v[120:123], v[24:27], v[52:55], v[120:123]
    buffer_load_dwordx4 v5, s[12:15], s45 offen offset:1024 lds
    v_mfma_f32_16x16x32_bf16 v[124:127], v[28:31], v[52:55], v[124:127]
    s_waitcnt lgkmcnt(4)
    v_mfma_f32_16x16x32_bf16 v[128:131], v[56:59], v[16:19], v[128:131]
    ds_read_b64_tr_b16 v[52:53], v11 offset:23552
    v_mfma_f32_16x16x32_bf16 v[132:135], v[56:59], v[20:23], v[132:135]
    s_add_u32 m0, s44, 3072
    ds_read_b64_tr_b16 v[54:55], v11 offset:24064
    v_mfma_f32_16x16x32_bf16 v[136:139], v[56:59], v[24:27], v[136:139]
    buffer_load_dwordx4 v4, s[16:19], s45 offen lds
    v_mfma_f32_16x16x32_bf16 v[140:143], v[56:59], v[28:31], v[140:143]
    s_waitcnt lgkmcnt(4)
    v_mfma_f32_16x16x32_bf16 v[144:147], v[60:63], v[16:19], v[144:147]
    ds_read_b64_tr_b16 v[56:57], v12 offset:21504
    v_mfma_f32_16x16x32_bf16 v[148:151], v[60:63], v[20:23], v[148:151]
    ds_read_b64_tr_b16 v[58:59], v12 offset:22016
    v_mfma_f32_16x16x32_bf16 v[152:155], v[60:63], v[24:27], v[152:155]
    buffer_load_dwordx4 v5, s[16:19], s45 offen offset:1024 lds
    v_mfma_f32_16x16x32_bf16 v[156:159], v[60:63], v[28:31], v[156:159]
    s_waitcnt lgkmcnt(4)
    buffer_store_dwordx4 a[192:195], v14, s[20:23], s100 offen sc1
    v_mfma_f32_16x16x32_bf16 v[160:163], v[48:51], v[16:19], v[160:163]
    s_mov_b32 s46, 384
    ds_read_b64_tr_b16 v[60:61], v12 offset:23552
    v_mfma_f32_16x16x32_bf16 v[164:167], v[48:51], v[20:23], v[164:167]
    s_add_u32 m0, s44, 0
    ds_read_b64_tr_b16 v[62:63], v12 offset:24064
    v_mfma_f32_16x16x32_bf16 v[168:171], v[48:51], v[24:27], v[168:171]
    buffer_load_dwordx4 v3, s[8:11], s46 offen lds
    v_mfma_f32_16x16x32_bf16 v[172:175], v[48:51], v[28:31], v[172:175]
    s_waitcnt lgkmcnt(4)
    v_mfma_f32_16x16x32_bf16 v[176:179], v[52:55], v[16:19], v[176:179]
    ds_read_b64_tr_b16 v[48:49], v13 offset:21504
    v_mfma_f32_16x16x32_bf16 v[180:183], v[52:55], v[20:23], v[180:183]
    ds_read_b64_tr_b16 v[50:51], v13 offset:22016
    v_mfma_f32_16x16x32_bf16 v[184:187], v[52:55], v[24:27], v[184:187]
    v_mfma_f32_16x16x32_bf16 v[188:191], v[52:55], v[28:31], v[188:191]
    s_waitcnt lgkmcnt(4)
    v_mfma_f32_16x16x32_bf16 v[192:195], v[56:59], v[16:19], v[192:195]
    ds_read_b64_tr_b16 v[52:53], v13 offset:23552
    v_mfma_f32_16x16x32_bf16 v[196:199], v[56:59], v[20:23], v[196:199]
    ds_read_b64_tr_b16 v[54:55], v13 offset:24064
    v_mfma_f32_16x16x32_bf16 v[200:203], v[56:59], v[24:27], v[200:203]
    buffer_store_dwordx4 a[196:199], v14, s[20:23], s101 offen sc1
    v_mfma_f32_16x16x32_bf16 v[204:207], v[56:59], v[28:31], v[204:207]
    s_waitcnt lgkmcnt(4)
    v_mfma_f32_16x16x32_bf16 v[208:211], v[60:63], v[16:19], v[208:211]
    ds_read_b128 v[56:59], v9 offset:20480
    v_mfma_f32_16x16x32_bf16 v[212:215], v[60:63], v[20:23], v[212:215]
    v_mfma_f32_16x16x32_bf16 v[216:219], v[60:63], v[24:27], v[216:219]
    ds_read_b128 v[32:35], v7 offset:8192
    v_mfma_f32_16x16x32_bf16 v[220:223], v[60:63], v[28:31], v[220:223]
    s_waitcnt lgkmcnt(4)
    ds_read_b128 v[36:39], v7 offset:10240
    v_mfma_f32_16x16x32_bf16 v[224:227], v[48:51], v[16:19], v[224:227]
    ds_read_b128 v[60:63], v9 offset:30720
    v_mfma_f32_16x16x32_bf16 v[228:231], v[48:51], v[20:23], v[228:231]
    v_mfma_f32_16x16x32_bf16 v[232:235], v[48:51], v[24:27], v[232:235]
    ds_read_b128 v[40:43], v7 offset:12288
    v_mfma_f32_16x16x32_bf16 v[236:239], v[48:51], v[28:31], v[236:239]
    s_waitcnt lgkmcnt(5)
    ds_read_b128 v[44:47], v7 offset:14336
    v_mfma_f32_16x16x32_bf16 v[240:243], v[52:55], v[16:19], v[240:243]
    s_mov_b32 s45, 384
    ds_read_b64_tr_b16 v[48:49], v10 offset:31744
    v_mfma_f32_16x16x32_bf16 v[244:247], v[52:55], v[20:23], v[244:247]
    s_add_u32 m0, s43, 8192
    ds_read_b64_tr_b16 v[50:51], v10 offset:32256
    v_mfma_f32_16x16x32_bf16 v[248:251], v[52:55], v[24:27], v[248:251]
    buffer_load_dwordx4 v1, s[4:7], s45 offen lds
    v_mfma_f32_16x16x32_bf16 v[252:255], v[52:55], v[28:31], v[252:255]
    s_waitcnt lgkmcnt(6)
    v_mfma_f32_16x16x32_bf16 v[96:99], v[32:35], v[56:59], v[96:99]
    s_waitcnt lgkmcnt(5)
    ds_read_b64_tr_b16 v[52:53], v10 offset:33792
    v_mfma_f32_16x16x32_bf16 v[100:103], v[36:39], v[56:59], v[100:103]
    s_waitcnt lgkmcnt(4)
    ds_read_b64_tr_b16 v[54:55], v10 offset:34304
    v_mfma_f32_16x16x32_bf16 v[104:107], v[40:43], v[56:59], v[104:107]
    s_waitcnt lgkmcnt(4)
    buffer_load_dwordx4 v2, s[4:7], s45 offen offset:1024 lds
    v_mfma_f32_16x16x32_bf16 v[108:111], v[44:47], v[56:59], v[108:111]
    v_mfma_f32_16x16x32_bf16 v[112:115], v[32:35], v[60:63], v[112:115]
    s_mov_b32 s46, 5504
    ds_read_b64_tr_b16 v[56:57], v11 offset:31744
    v_mfma_f32_16x16x32_bf16 v[116:119], v[36:39], v[60:63], v[116:119]
    s_add_u32 m0, s43, 10240
    ds_read_b64_tr_b16 v[58:59], v11 offset:32256
    v_mfma_f32_16x16x32_bf16 v[120:123], v[40:43], v[60:63], v[120:123]
    buffer_load_dwordx4 v1, s[4:7], s46 offen lds
    v_mfma_f32_16x16x32_bf16 v[124:127], v[44:47], v[60:63], v[124:127]
    s_waitcnt lgkmcnt(4)
    v_mfma_f32_16x16x32_bf16 v[128:131], v[48:51], v[32:35], v[128:131]
    ds_read_b64_tr_b16 v[60:61], v11 offset:33792
    v_mfma_f32_16x16x32_bf16 v[132:135], v[48:51], v[36:39], v[132:135]
    ds_read_b64_tr_b16 v[62:63], v11 offset:34304
    v_mfma_f32_16x16x32_bf16 v[136:139], v[48:51], v[40:43], v[136:139]
    buffer_load_dwordx4 v2, s[4:7], s46 offen offset:1024 lds
    v_mfma_f32_16x16x32_bf16 v[140:143], v[48:51], v[44:47], v[140:143]
    s_waitcnt lgkmcnt(4)
    v_mfma_f32_16x16x32_bf16 v[144:147], v[52:55], v[32:35], v[144:147]
    s_mov_b32 s45, 10624
    ds_read_b64_tr_b16 v[48:49], v12 offset:31744
    v_mfma_f32_16x16x32_bf16 v[148:151], v[52:55], v[36:39], v[148:151]
    s_add_u32 m0, s43, 12288
    ds_read_b64_tr_b16 v[50:51], v12 offset:32256
    v_mfma_f32_16x16x32_bf16 v[152:155], v[52:55], v[40:43], v[152:155]
    buffer_load_dwordx4 v1, s[4:7], s45 offen lds
    v_mfma_f32_16x16x32_bf16 v[156:159], v[52:55], v[44:47], v[156:159]
    s_waitcnt lgkmcnt(4)
    v_mfma_f32_16x16x32_bf16 v[160:163], v[56:59], v[32:35], v[160:163]
    ds_read_b64_tr_b16 v[52:53], v12 offset:33792
    v_mfma_f32_16x16x32_bf16 v[164:167], v[56:59], v[36:39], v[164:167]
    ds_read_b64_tr_b16 v[54:55], v12 offset:34304
    v_mfma_f32_16x16x32_bf16 v[168:171], v[56:59], v[40:43], v[168:171]
    buffer_load_dwordx4 v2, s[4:7], s45 offen offset:1024 lds
    v_mfma_f32_16x16x32_bf16 v[172:175], v[56:59], v[44:47], v[172:175]
    s_waitcnt lgkmcnt(4)
    v_mfma_f32_16x16x32_bf16 v[176:179], v[60:63], v[32:35], v[176:179]
    s_mov_b32 s46, 15744
    ds_read_b64_tr_b16 v[56:57], v13 offset:31744
    v_mfma_f32_16x16x32_bf16 v[180:183], v[60:63], v[36:39], v[180:183]
    s_add_u32 m0, s43, 14336
    ds_read_b64_tr_b16 v[58:59], v13 offset:32256
    v_mfma_f32_16x16x32_bf16 v[184:187], v[60:63], v[40:43], v[184:187]
    buffer_load_dwordx4 v1, s[4:7], s46 offen lds
    v_mfma_f32_16x16x32_bf16 v[188:191], v[60:63], v[44:47], v[188:191]
    s_waitcnt lgkmcnt(4)
    v_mfma_f32_16x16x32_bf16 v[192:195], v[48:51], v[32:35], v[192:195]
    ds_read_b64_tr_b16 v[60:61], v13 offset:33792
    v_mfma_f32_16x16x32_bf16 v[196:199], v[48:51], v[36:39], v[196:199]
    ds_read_b64_tr_b16 v[62:63], v13 offset:34304
    v_mfma_f32_16x16x32_bf16 v[200:203], v[48:51], v[40:43], v[200:203]
    buffer_load_dwordx4 v2, s[4:7], s46 offen offset:1024 lds
L_st_1:
    s_cbranch_execz L_tr_x
    v_mfma_f32_16x16x32_bf16 v[204:207], v[48:51], v[44:47], v[204:207]
    s_waitcnt lgkmcnt(4)
    s_waitcnt vmcnt(17)
    s_barrier
    v_mfma_f32_16x16x32_bf16 v[208:211], v[52:55], v[32:35], v[208:211]
    ds_read_b128 v[48:51], v8 offset:40960
    v_mfma_f32_16x16x32_bf16 v[212:215], v[52:55], v[36:39], v[212:215]
    v_mfma_f32_16x16x32_bf16 v[216:219], v[52:55], v[40:43], v[216:219]
    ds_read_b128 v[16:19], v6 offset:0
    v_mfma_f32_16x16x32_bf16 v[220:223], v[52:55], v[44:47], v[220:223]
    s_waitcnt lgkmcnt(4)
    ds_read_b128 v[20:23], v6 offset:2048
    v_mfma_f32_16x16x32_bf16 v[224:227], v[56:59], v[32:35], v[224:227]
    ds_read_b128 v[52:55], v8 offset:51200
    v_mfma_f32_16x16x32_bf16 v[228:231], v[56:59], v[36:39], v[228:231]
    v_mfma_f32_16x16x32_bf16 v[232:235], v[56:59], v[40:43], v[232:235]
    ds_read_b128 v[24:27], v6 offset:4096
    v_mfma_f32_16x16x32_bf16 v[236:239], v[56:59], v[44:47], v[236:239]
    s_waitcnt lgkmcnt(5)
    ds_read_b128 v[28:31], v6 offset:6144
    v_mfma_f32_16x16x32_bf16 v[240:243], v[60:63], v[32:35], v[240:243]
    ds_read_b64_tr_b16 v[56:57], v10 offset:41984
    v_mfma_f32_16x16x32_bf16 v[244:247], v[60:63], v[36:39], v[244:247]
    ds_read_b64_tr_b16 v[58:59], v10 offset:42496
    v_mfma_f32_16x16x32_bf16 v[248:251], v[60:63], v[40:43], v[248:251]
    v_mfma_f32_16x16x32_bf16 v[252:255], v[60:63], v[44:47], v[252:255]
    s_waitcnt lgkmcnt(6)
    v_mfma_f32_16x16x32_bf16 v[96:99], v[16:19], v[48:51], v[96:99]
    s_waitcnt lgkmcnt(5)
    s_mov_b32 s45, 884736
    ds_read_b64_tr_b16 v[60:61], v10 offset:44032
    v_mfma_f32_16x16x32_bf16 v[100:103], v[20:23], v[48:51], v[100:103]
    s_waitcnt lgkmcnt(4)
    s_add_u32 m0, s44, 21504
    ds_read_b64_tr_b16 v[62:63], v10 offset:44544
    v_mfma_f32_16x16x32_bf16 v[104:107], v[24:27], v[48:51], v[104:107]
    s_waitcnt lgkmcnt(4)
    s_mul_i32 s56, s53, 160
    buffer_load_dwordx4 v4, s[12:15], s45 offen lds
    v_mfma_f32_16x16x32_bf16 v[108:111], v[28:31], v[48:51], v[108:111]
    v_mfma_f32_16x16x32_bf16 v[112:115], v[16:19], v[52:55], v[112:115]
    s_add_u32 s28, s80, s56
    s_addc_u32 s29, s81, 0
    ds_read_b64_tr_b16 v[48:49], v11 offset:41984
    v_mfma_f32_16x16x32_bf16 v[116:119], v[20:23], v[52:55], v[116:119]
    s_mov_b32 s30, 160
    ds_read_b64_tr_b16 v[50:51], v11 offset:42496
    v_mfma_f32_16x16x32_bf16 v[120:123], v[24:27], v[52:55], v[120:123]
    s_lshl_b32 s57, s52, 4
    buffer_load_dwordx4 v5, s[12:15], s45 offen offset:1024 lds
    v_mfma_f32_16x16x32_bf16 v[124:127], v[28:31], v[52:55], v[124:127]
    s_waitcnt lgkmcnt(4)
    v_mfma_f32_16x16x32_bf16 v[128:131], v[56:59], v[16:19], v[128:131]
    s_add_u32 s57, s57, s40
    ds_read_b64_tr_b16 v[52:53], v11 offset:44032
    v_mfma_f32_16x16x32_bf16 v[132:135], v[56:59], v[20:23], v[132:135]
    s_add_u32 m0, s44, 23552
    ds_read_b64_tr_b16 v[54:55], v11 offset:44544
    v_mfma_f32_16x16x32_bf16 v[136:139], v[56:59], v[24:27], v[136:139]
    s_mul_i32 s57, s57, 5120
    buffer_load_dwordx4 v4, s[16:19], s45 offen lds
    v_mfma_f32_16x16x32_bf16 v[140:143], v[56:59], v[28:31], v[140:143]
    s_waitcnt lgkmcnt(4)
    v_mfma_f32_16x16x32_bf16 v[144:147], v[60:63], v[16:19], v[144:147]
    s_add_u32 s56, s56, s57
    ds_read_b64_tr_b16 v[56:57], v12 offset:41984
    v_mfma_f32_16x16x32_bf16 v[148:151], v[60:63], v[20:23], v[148:151]
    s_add_u32 s24, s64, s56
    s_addc_u32 s25, s65, 0
    ds_read_b64_tr_b16 v[58:59], v12 offset:42496
    v_mfma_f32_16x16x32_bf16 v[152:155], v[60:63], v[24:27], v[152:155]
    s_mov_b32 s26, 65440
    buffer_load_dwordx4 v5, s[16:19], s45 offen offset:1024 lds
    v_mfma_f32_16x16x32_bf16 v[156:159], v[60:63], v[28:31], v[156:159]
    s_waitcnt lgkmcnt(4)
    v_add_u32 v94, 0, v0
    v_mfma_f32_16x16x32_bf16 v[160:163], v[48:51], v[16:19], v[160:163]
    s_mov_b32 s46, 512
    ds_read_b64_tr_b16 v[60:61], v12 offset:44032
    v_mul_u32_u24 v95, 6554, v94
    v_mfma_f32_16x16x32_bf16 v[164:167], v[48:51], v[20:23], v[164:167]
    s_add_u32 m0, s44, 20480
    ds_read_b64_tr_b16 v[62:63], v12 offset:44544
    v_lshrrev_b32 v95, 16, v95
    v_mfma_f32_16x16x32_bf16 v[168:171], v[48:51], v[24:27], v[168:171]
    buffer_load_dwordx4 v3, s[8:11], s46 offen lds
    v_mfma_f32_16x16x32_bf16 v[172:175], v[48:51], v[28:31], v[172:175]
    s_waitcnt lgkmcnt(4)
    v_mul_u32_u24 v88, 10, v95
    v_mfma_f32_16x16x32_bf16 v[176:179], v[52:55], v[16:19], v[176:179]
    ds_read_b64_tr_b16 v[48:49], v13 offset:41984
    v_sub_u32 v94, v94, v88
    v_mfma_f32_16x16x32_bf16 v[180:183], v[52:55], v[20:23], v[180:183]
    ds_read_b64_tr_b16 v[50:51], v13 offset:42496
    v_lshrrev_b32 v88, 2, v95
    v_mfma_f32_16x16x32_bf16 v[184:187], v[52:55], v[24:27], v[184:187]
    v_mul_u32_u24 v88, 12, v88
    v_mfma_f32_16x16x32_bf16 v[188:191], v[52:55], v[28:31], v[188:191]
    s_waitcnt lgkmcnt(4)
    v_add_u32 v95, v95, v88
    v_mfma_f32_16x16x32_bf16 v[192:195], v[56:59], v[16:19], v[192:195]
    ds_read_b64_tr_b16 v[52:53], v13 offset:44032
    v_mul_u32_u24 v95, 1280, v95
    v_mfma_f32_16x16x32_bf16 v[196:199], v[56:59], v[20:23], v[196:199]
    ds_read_b64_tr_b16 v[54:55], v13 offset:44544
    v_lshl_add_u32 v94, v94, 4, v95
    v_mfma_f32_16x16x32_bf16 v[200:203], v[56:59], v[24:27], v[200:203]
    buffer_load_dword v93, off, s[68:71], 0 sc1
    v_mfma_f32_16x16x32_bf16 v[204:207], v[56:59], v[28:31], v[204:207]
    s_waitcnt lgkmcnt(4)
    v_mfma_f32_16x16x32_bf16 v[208:211], v[60:63], v[16:19], v[208:211]
    ds_read_b128 v[56:59], v9 offset:40960
    v_mfma_f32_16x16x32_bf16 v[212:215], v[60:63], v[20:23], v[212:215]
    v_mfma_f32_16x16x32_bf16 v[216:219], v[60:63], v[24:27], v[216:219]
    ds_read_b128 v[32:35], v7 offset:0
    v_mfma_f32_16x16x32_bf16 v[220:223], v[60:63], v[28:31], v[220:223]
    s_waitcnt lgkmcnt(4)
    ds_read_b128 v[36:39], v7 offset:2048
    v_mfma_f32_16x16x32_bf16 v[224:227], v[48:51], v[16:19], v[224:227]
    s_add_u32 m0, s48, 0
    ds_read_b128 v[60:63], v9 offset:51200
    v_mfma_f32_16x16x32_bf16 v[228:231], v[48:51], v[20:23], v[228:231]
    buffer_load_dwordx4 v94, s[24:27], 0 offen lds
    v_mfma_f32_16x16x32_bf16 v[232:235], v[48:51], v[24:27], v[232:235]
    ds_read_b128 v[40:43], v7 offset:4096
    v_add_u32 v94, 64, v0
    v_mfma_f32_16x16x32_bf16 v[236:239], v[48:51], v[28:31], v[236:239]
    s_waitcnt lgkmcnt(5)
    ds_read_b128 v[44:47], v7 offset:6144
    v_mul_u32_u24 v95, 6554, v94
    v_mfma_f32_16x16x32_bf16 v[240:243], v[52:55], v[16:19], v[240:243]
    s_mov_b32 s45, 512
    ds_read_b64_tr_b16 v[48:49], v10 offset:52224
    v_lshrrev_b32 v95, 16, v95
    v_mfma_f32_16x16x32_bf16 v[244:247], v[52:55], v[20:23], v[244:247]
    s_add_u32 m0, s43, 0
    ds_read_b64_tr_b16 v[50:51], v10 offset:52736
    v_mul_u32_u24 v88, 10, v95
    v_mfma_f32_16x16x32_bf16 v[248:251], v[52:55], v[24:27], v[248:251]
    buffer_load_dwordx4 v1, s[4:7], s45 offen lds
    v_mfma_f32_16x16x32_bf16 v[252:255], v[52:55], v[28:31], v[252:255]
    s_waitcnt lgkmcnt(6)
    v_sub_u32 v94, v94, v88
    v_mfma_f32_16x16x32_bf16 v[96:99], v[32:35], v[56:59], v[96:99]
    s_waitcnt lgkmcnt(5)
    ds_read_b64_tr_b16 v[52:53], v10 offset:54272
    v_lshrrev_b32 v88, 2, v95
    v_mfma_f32_16x16x32_bf16 v[100:103], v[36:39], v[56:59], v[100:103]
    s_waitcnt lgkmcnt(4)
    ds_read_b64_tr_b16 v[54:55], v10 offset:54784
    v_mul_u32_u24 v88, 12, v88
    v_mfma_f32_16x16x32_bf16 v[104:107], v[40:43], v[56:59], v[104:107]
    s_waitcnt lgkmcnt(4)
    buffer_load_dwordx4 v2, s[4:7], s45 offen offset:1024 lds
    v_mfma_f32_16x16x32_bf16 v[108:111], v[44:47], v[56:59], v[108:111]
    v_add_u32 v95, v95, v88
    v_mfma_f32_16x16x32_bf16 v[112:115], v[32:35], v[60:63], v[112:115]
    s_mov_b32 s46, 5632
    ds_read_b64_tr_b16 v[56:57], v11 offset:52224
    v_mul_u32_u24 v95, 1280, v95
    v_mfma_f32_16x16x32_bf16 v[116:119], v[36:39], v[60:63], v[116:119]
    s_add_u32 m0, s43, 2048
    ds_read_b64_tr_b16 v[58:59], v11 offset:52736
    v_lshl_add_u32 v94, v94, 4, v95
    v_mfma_f32_16x16x32_bf16 v[120:123], v[40:43], v[60:63], v[120:123]
    buffer_load_dwordx4 v1, s[4:7], s46 offen lds
    v_mfma_f32_16x16x32_bf16 v[124:127], v[44:47], v[60:63], v[124:127]
    s_waitcnt lgkmcnt(4)
    v_mfma_f32_16x16x32_bf16 v[128:131], v[48:51], v[32:35], v[128:131]
    ds_read_b64_tr_b16 v[60:61], v11 offset:54272
    v_mfma_f32_16x16x32_bf16 v[132:135], v[48:51], v[36:39], v[132:135]
    ds_read_b64_tr_b16 v[62:63], v11 offset:54784
    v_mfma_f32_16x16x32_bf16 v[136:139], v[48:51], v[40:43], v[136:139]
    buffer_load_dwordx4 v2, s[4:7], s46 offen offset:1024 lds
    v_mfma_f32_16x16x32_bf16 v[140:143], v[48:51], v[44:47], v[140:143]
    s_waitcnt lgkmcnt(4)
    v_mfma_f32_16x16x32_bf16 v[144:147], v[52:55], v[32:35], v[144:147]
    s_mov_b32 s45, 10752
    ds_read_b64_tr_b16 v[48:49], v12 offset:52224
    v_mfma_f32_16x16x32_bf16 v[148:151], v[52:55], v[36:39], v[148:151]
    s_add_u32 m0, s43, 4096
    ds_read_b64_tr_b16 v[50:51], v12 offset:52736
    v_mfma_f32_16x16x32_bf16 v[152:155], v[52:55], v[40:43], v[152:155]
    buffer_load_dwordx4 v1, s[4:7], s45 offen lds
    v_mfma_f32_16x16x32_bf16 v[156:159], v[52:55], v[44:47], v[156:159]
    s_waitcnt lgkmcnt(4)
    v_mfma_f32_16x16x32_bf16 v[160:163], v[56:59], v[32:35], v[160:163]
    ds_read_b64_tr_b16 v[52:53], v12 offset:54272
    v_mfma_f32_16x16x32_bf16 v[164:167], v[56:59], v[36:39], v[164:167]
    ds_read_b64_tr_b16 v[54:55], v12 offset:54784
    v_mfma_f32_16x16x32_bf16 v[168:171], v[56:59], v[40:43], v[168:171]
    buffer_load_dwordx4 v2, s[4:7], s45 offen offset:1024 lds
    v_mfma_f32_16x16x32_bf16 v[172:175], v[56:59], v[44:47], v[172:175]
    s_waitcnt lgkmcnt(4)
    v_mfma_f32_16x16x32_bf16 v[176:179], v[60:63], v[32:35], v[176:179]
    s_mov_b32 s46, 15872
    ds_read_b64_tr_b16 v[56:57], v13 offset:52224
    v_mfma_f32_16x16x32_bf16 v[180:183], v[60:63], v[36:39], v[180:183]
    s_add_u32 m0, s43, 6144
    ds_read_b64_tr_b16 v[58:59], v13 offset:52736
    v_mfma_f32_16x16x32_bf16 v[184:187], v[60:63], v[40:43], v[184:187]
    buffer_load_dwordx4 v1, s[4:7], s46 offen lds
    v_mfma_f32_16x16x32_bf16 v[188:191], v[60:63], v[44:47], v[188:191]
    s_waitcnt lgkmcnt(4)
    v_mfma_f32_16x16x32_bf16 v[192:195], v[48:51], v[32:35], v[192:195]
    ds_read_b64_tr_b16 v[60:61], v13 offset:54272
    v_mfma_f32_16x16x32_bf16 v[196:199], v[48:51], v[36:39], v[196:199]
    ds_read_b64_tr_b16 v[62:63], v13 offset:54784
    v_mfma_f32_16x16x32_bf16 v[200:203], v[48:51], v[40:43], v[200:203]
    buffer_load_dwordx4 v2, s[4:7], s46 offen offset:1024 lds
    v_mfma_f32_16x16x32_bf16 v[204:207], v[48:51], v[44:47], v[204:207]
    s_waitcnt lgkmcnt(4)
    s_waitcnt vmcnt(15)
    s_waitcnt vmcnt(9)
    v_cmp_gt_u32 vcc, 40, v93
    s_mov_b32 s55, 0
    s_cbranch_vccz L_ok_5
L_sp_6:
    s_sleep 16
    buffer_load_dword v93, off, s[68:71], 0 sc1
    s_add_u32 s55, s55, 1
    s_cmp_gt_u32 s55, 200000
    s_cbranch_scc1 L_ok_5
    s_waitcnt vmcnt(0)
    v_cmp_gt_u32 vcc, 40, v93
    s_nop 0
    s_cbranch_vccnz L_sp_6
L_ok_5:
    s_barrier
    v_mfma_f32_16x16x32_bf16 v[208:211], v[52:55], v[32:35], v[208:211]
    ds_read_b128 v[48:51], v8 offset:0
    v_mfma_f32_16x16x32_bf16 v[212:215], v[52:55], v[36:39], v[212:215]
    s_mov_b64 exec, 1
    buffer_store_dword a255, off, s[20:23], s67 sc1
    s_mov_b64 exec, -1
    v_mfma_f32_16x16x32_bf16 v[216:219], v[52:55], v[40:43], v[216:219]
    ds_read_b128 v[16:19], v6 offset:8192
    v_mfma_f32_16x16x32_bf16 v[220:223], v[52:55], v[44:47], v[220:223]
    s_waitcnt lgkmcnt(4)
    ds_read_b128 v[20:23], v6 offset:10240
    v_mfma_f32_16x16x32_bf16 v[224:227], v[56:59], v[32:35], v[224:227]
    ds_read_b128 v[52:55], v8 offset:10240
    v_mfma_f32_16x16x32_bf16 v[228:231], v[56:59], v[36:39], v[228:231]
    v_mfma_f32_16x16x32_bf16 v[232:235], v[56:59], v[40:43], v[232:235]
    ds_read_b128 v[24:27], v6 offset:12288
    v_mfma_f32_16x16x32_bf16 v[236:239], v[56:59], v[44:47], v[236:239]
    s_waitcnt lgkmcnt(5)
    ds_read_b128 v[28:31], v6 offset:14336
    v_mfma_f32_16x16x32_bf16 v[240:243], v[60:63], v[32:35], v[240:243]
    ds_read_b64_tr_b16 v[56:57], v10 offset:1024
    v_mfma_f32_16x16x32_bf16 v[244:247], v[60:63], v[36:39], v[244:247]
    s_add_u32 m0, s48, 1024
    ds_read_b64_tr_b16 v[58:59], v10 offset:1536
    v_mfma_f32_16x16x32_bf16 v[248:251], v[60:63], v[40:43], v[248:251]
    buffer_load_dwordx4 v94, s[24:27], 0 offen lds
    v_mfma_f32_16x16x32_bf16 v[252:255], v[60:63], v[44:47], v[252:255]
    s_waitcnt lgkmcnt(6)
    v_add_u32 v94, 128, v0
    v_mfma_f32_16x16x32_bf16 v[96:99], v[16:19], v[48:51], v[96:99]
    s_waitcnt lgkmcnt(5)
    s_mov_b32 s45, 1105920
    ds_read_b64_tr_b16 v[60:61], v10 offset:3072
    v_mul_u32_u24 v95, 6554, v94
    v_mfma_f32_16x16x32_bf16 v[100:103], v[20:23], v[48:51], v[100:103]
    s_waitcnt lgkmcnt(4)
    s_add_u32 m0, s44, 41984
    ds_read_b64_tr_b16 v[62:63], v10 offset:3584
    v_lshrrev_b32 v95, 16, v95
    v_mfma_f32_16x16x32_bf16 v[104:107], v[24:27], v[48:51], v[104:107]
    s_waitcnt lgkmcnt(4)
    buffer_load_dwordx4 v4, s[12:15], s45 offen lds
    v_mfma_f32_16x16x32_bf16 v[108:111], v[28:31], v[48:51], v[108:111]
    v_mul_u32_u24 v88, 10, v95
    v_mfma_f32_16x16x32_bf16 v[112:115], v[16:19], v[52:55], v[112:115]
    ds_read_b64_tr_b16 v[48:49], v11 offset:1024
    v_sub_u32 v94, v94, v88
    v_mfma_f32_16x16x32_bf16 v[116:119], v[20:23], v[52:55], v[116:119]
    ds_read_b64_tr_b16 v[50:51], v11 offset:1536
    v_lshrrev_b32 v88, 2, v95
    v_mfma_f32_16x16x32_bf16 v[120:123], v[24:27], v[52:55], v[120:123]
    buffer_load_dwordx4 v5, s[12:15], s45 offen offset:1024 lds
    v_mfma_f32_16x16x32_bf16 v[124:127], v[28:31], v[52:55], v[124:127]
    s_waitcnt lgkmcnt(4)
    v_mul_u32_u24 v88, 12, v88
    v_mfma_f32_16x16x32_bf16 v[128:131], v[56:59], v[16:19], v[128:131]
    ds_read_b64_tr_b16 v[52:53], v11 offset:3072
    v_add_u32 v95, v95, v88
    v_mfma_f32_16x16x32_bf16 v[132:135], v[56:59], v[20:23], v[132:135]
    s_add_u32 m0, s44, 44032
    ds_read_b64_tr_b16 v[54:55], v11 offset:3584
    v_mul_u32_u24 v95, 1280, v95
    v_mfma_f32_16x16x32_bf16 v[136:139], v[56:59], v[24:27], v[136:139]
    buffer_load_dwordx4 v4, s[16:19], s45 offen lds
    v_mfma_f32_16x16x32_bf16 v[140:143], v[56:59], v[28:31], v[140:143]
    s_waitcnt lgkmcnt(4)
    v_lshl_add_u32 v94, v94, 4, v95
    v_mfma_f32_16x16x32_bf16 v[144:147], v[60:63], v[16:19], v[144:147]
    ds_read_b64_tr_b16 v[56:57], v12 offset:1024
    v_mfma_f32_16x16x32_bf16 v[148:151], v[60:63], v[20:23], v[148:151]
    ds_read_b64_tr_b16 v[58:59], v12 offset:1536
    v_mfma_f32_16x16x32_bf16 v[152:155], v[60:63], v[24:27], v[152:155]
    buffer_load_dwordx4 v5, s[16:19], s45 offen offset:1024 lds
    v_mfma_f32_16x16x32_bf16 v[156:159], v[60:63], v[28:31], v[156:159]
    s_waitcnt lgkmcnt(4)
    v_mfma_f32_16x16x32_bf16 v[160:163], v[48:51], v[16:19], v[160:163]
    s_mov_b32 s46, 640
    ds_read_b64_tr_b16 v[60:61], v12 offset:3072
    v_mfma_f32_16x16x32_bf16 v[164:167], v[48:51], v[20:23], v[164:167]
    s_add_u32 m0, s44, 40960
    ds_read_b64_tr_b16 v[62:63], v12 offset:3584
    v_mfma_f32_16x16x32_bf16 v[168:171], v[48:51], v[24:27], v[168:171]
    buffer_load_dwordx4 v3, s[8:11], s46 offen lds
    v_mfma_f32_16x16x32_bf16 v[172:175], v[48:51], v[28:31], v[172:175]
    s_waitcnt lgkmcnt(4)
    v_mfma_f32_16x16x32_bf16 v[176:179], v[52:55], v[16:19], v[176:179]
    ds_read_b64_tr_b16 v[48:49], v13 offset:1024
    v_mfma_f32_16x16x32_bf16 v[180:183], v[52:55], v[20:23], v[180:183]
    ds_read_b64_tr_b16 v[50:51], v13 offset:1536
    v_mfma_f32_16x16x32_bf16 v[184:187], v[52:55], v[24:27], v[184:187]
    v_mfma_f32_16x16x32_bf16 v[188:191], v[52:55], v[28:31], v[188:191]
    s_waitcnt lgkmcnt(4)
    v_mfma_f32_16x16x32_bf16 v[192:195], v[56:59], v[16:19], v[192:195]
    ds_read_b64_tr_b16 v[52:53], v13 offset:3072
    v_mfma_f32_16x16x32_bf16 v[196:199], v[56:59], v[20:23], v[196:199]
    s_add_u32 m0, s48, 2048
    ds_read_b64_tr_b16 v[54:55], v13 offset:3584
    v_mfma_f32_16x16x32_bf16 v[200:203], v[56:59], v[24:27], v[200:203]
    buffer_load_dwordx4 v94, s[24:27], 0 offen lds
    v_mfma_f32_16x16x32_bf16 v[204:207], v[56:59], v[28:31], v[204:207]
    s_waitcnt lgkmcnt(4)
    v_mfma_f32_16x16x32_bf16 v[208:211], v[60:63], v[16:19], v[208:211]
    ds_read_b128 v[56:59], v9 offset:0
    v_mfma_f32_16x16x32_bf16 v[212:215], v[60:63], v[20:23], v[212:215]
    v_mfma_f32_16x16x32_bf16 v[216:219], v[60:63], v[24:27], v[216:219]
    ds_read_b128 v[32:35], v7 offset:8192
    v_mfma_f32_16x16x32_bf16 v[220:223], v[60:63], v[28:31], v[220:223]
    s_waitcnt lgkmcnt(4)
    ds_read_b128 v[36:39], v7 offset:10240
    v_mfma_f32_16x16x32_bf16 v[224:227], v[48:51], v[16:19], v[224:227]
    s_add_u32 m0, s48, 3072
    ds_read_b128 v[60:63], v9 offset:10240
    v_mfma_f32_16x16x32_bf16 v[228:231], v[48:51], v[20:23], v[228:231]
    s_mov_b64 exec, 0xffff
    buffer_load_dwordx4 v14, s[28:31], 0 offen lds
    s_mov_b64 exec, -1
    v_mfma_f32_16x16x32_bf16 v[232:235], v[48:51], v[24:27], v[232:235]
    ds_read_b128 v[40:43], v7 offset:12288
    v_mfma_f32_16x16x32_bf16 v[236:239], v[48:51], v[28:31], v[236:239]
    s_waitcnt lgkmcnt(5)
    ds_read_b128 v[44:47], v7 offset:14336
    v_mfma_f32_16x16x32_bf16 v[240:243], v[52:55], v[16:19], v[240:243]
    s_mov_b32 s45, 640
    ds_read_b64_tr_b16 v[48:49], v10 offset:11264
    v_mfma_f32_16x16x32_bf16 v[244:247], v[52:55], v[20:23], v[244:247]
    s_add_u32 m0, s43, 8192
    ds_read_b64_tr_b16 v[50:51], v10 offset:11776
    v_mfma_f32_16x16x32_bf16 v[248:251], v[52:55], v[24:27], v[248:251]
    buffer_load_dwordx4 v1, s[4:7], s45 offen lds
    v_mfma_f32_16x16x32_bf16 v[252:255], v[52:55], v[28:31], v[252:255]
    s_waitcnt lgkmcnt(6)
    v_mfma_f32_16x16x32_bf16 v[96:99], v[32:35], v[56:59], v[96:99]
    s_waitcnt lgkmcnt(5)
    ds_read_b64_tr_b16 v[52:53], v10 offset:13312
    v_mfma_f32_16x16x32_bf16 v[100:103], v[36:39], v[56:59], v[100:103]
    s_waitcnt lgkmcnt(4)
    ds_read_b64_tr_b16 v[54:55], v10 offset:13824
    v_mfma_f32_16x16x32_bf16 v[104:107], v[40:43], v[56:59], v[104:107]
    s_waitcnt lgkmcnt(4)
    buffer_load_dwordx4 v2, s[4:7], s45 offen offset:1024 lds
    v_mfma_f32_16x16x32_bf16 v[108:111], v[44:47], v[56:59], v[108:111]
    v_mfma_f32_16x16x32_bf16 v[112:115], v[32:35], v[60:63], v[112:115]
    s_mov_b32 s46, 5760
    ds_read_b64_tr_b16 v[56:57], v11 offset:11264
    v_mfma_f32_16x16x32_bf16 v[116:119], v[36:39], v[60:63], v[116:119]
    s_add_u32 m0, s43, 10240
    ds_read_b64_tr_b16 v[58:59], v11 offset:11776
    v_mfma_f32_16x16x32_bf16 v[120:123], v[40:43], v[60:63], v[120:123]
    buffer_load_dwordx4 v1, s[4:7], s46 offen lds
    v_mfma_f32_16x16x32_bf16 v[124:127], v[44:47], v[60:63], v[124:127]
    s_waitcnt lgkmcnt(4)
    v_mfma_f32_16x16x32_bf16 v[128:131], v[48:51], v[32:35], v[128:131]
    ds_read_b64_tr_b16 v[60:61], v11 offset:13312
    v_mfma_f32_16x16x32_bf16 v[132:135], v[48:51], v[36:39], v[132:135]
    ds_read_b64_tr_b16 v[62:63], v11 offset:13824
    v_mfma_f32_16x16x32_bf16 v[136:139], v[48:51], v[40:43], v[136:139]
    buffer_load_dwordx4 v2, s[4:7], s46 offen offset:1024 lds
    v_mfma_f32_16x16x32_bf16 v[140:143], v[48:51], v[44:47], v[140:143]
    s_waitcnt lgkmcnt(4)
    v_mfma_f32_16x16x32_bf16 v[144:147], v[52:55], v[32:35], v[144:147]
    s_mov_b32 s45, 10880
    ds_read_b64_tr_b16 v[48:49], v12 offset:11264
    v_mfma_f32_16x16x32_bf16 v[148:151], v[52:55], v[36:39], v[148:151]
    s_add_u32 m0, s43, 12288
    ds_read_b64_tr_b16 v[50:51], v12 offset:11776
    v_mfma_f32_16x16x32_bf16 v[152:155], v[52:55], v[40:43], v[152:155]
    buffer_load_dwordx4 v1, s[4:7], s45 offen lds
    v_mfma_f32_16x16x32_bf16 v[156:159], v[52:55], v[44:47], v[156:159]
    s_waitcnt lgkmcnt(4)
    v_mfma_f32_16x16x32_bf16 v[160:163], v[56:59], v[32:35], v[160:163]
    ds_read_b64_tr_b16 v[52:53], v12 offset:13312
    v_mfma_f32_16x16x32_bf16 v[164:167], v[56:59], v[36:39], v[164:167]
    ds_read_b64_tr_b16 v[54:55], v12 offset:13824
    v_mfma_f32_16x16x32_bf16 v[168:171], v[56:59], v[40:43], v[168:171]
    buffer_load_dwordx4 v2, s[4:7], s45 offen offset:1024 lds
    v_mfma_f32_16x16x32_bf16 v[172:175], v[56:59], v[44:47], v[172:175]
    s_waitcnt lgkmcnt(4)
    v_mfma_f32_16x16x32_bf16 v[176:179], v[60:63], v[32:35], v[176:179]
    s_mov_b32 s46, 16000
    ds_read_b64_tr_b16 v[56:57], v13 offset:11264
    v_mfma_f32_16x16x32_bf16 v[180:183], v[60:63], v[36:39], v[180:183]
    s_add_u32 m0, s43, 14336
    ds_read_b64_tr_b16 v[58:59], v13 offset:11776
    v_mfma_f32_16x16x32_bf16 v[184:187], v[60:63], v[40:43], v[184:187]
    buffer_load_dwordx4 v1, s[4:7], s46 offen lds
    v_mfma_f32_16x16x32_bf16 v[188:191], v[60:63], v[44:47], v[188:191]
    s_waitcnt lgkmcnt(4)
    v_mfma_f32_16x16x32_bf16 v[192:195], v[48:51], v[32:35], v[192:195]
    ds_read_b64_tr_b16 v[60:61], v13 offset:13312
    v_mfma_f32_16x16x32_bf16 v[196:199], v[48:51], v[36:39], v[196:199]
    ds_read_b64_tr_b16 v[62:63], v13 offset:13824
    v_mfma_f32_16x16x32_bf16 v[200:203], v[48:51], v[40:43], v[200:203]
    buffer_load_dwordx4 v2, s[4:7], s46 offen offset:1024 lds
    v_mfma_f32_16x16x32_bf16 v[204:207], v[48:51], v[44:47], v[204:207]
    s_waitcnt lgkmcnt(4)
    s_waitcnt vmcnt(17)
    s_barrier
    v_mfma_f32_16x16x32_bf16 v[208:211], v[52:55], v[32:35], v[208:211]
    ds_read_b128 v[48:51], v8 offset:20480
    v_mfma_f32_16x16x32_bf16 v[212:215], v[52:55], v[36:39], v[212:215]
    v_mfma_f32_16x16x32_bf16 v[216:219], v[52:55], v[40:43], v[216:219]
    ds_read_b128 v[16:19], v6 offset:0
    v_mfma_f32_16x16x32_bf16 v[220:223], v[52:55], v[44:47], v[220:223]
    s_waitcnt lgkmcnt(4)
    ds_read_b128 v[20:23], v6 offset:2048
    v_mfma_f32_16x16x32_bf16 v[224:227], v[56:59], v[32:35], v[224:227]
    ds_read_b128 v[52:55], v8 offset:30720
    v_mfma_f32_16x16x32_bf16 v[228:231], v[56:59], v[36:39], v[228:231]
    v_mfma_f32_16x16x32_bf16 v[232:235], v[56:59], v[40:43], v[232:235]
    ds_read_b128 v[24:27], v6 offset:4096
    v_mfma_f32_16x16x32_bf16 v[236:239], v[56:59], v[44:47], v[236:239]
    s_waitcnt lgkmcnt(5)
    ds_read_b128 v[28:31], v6 offset:6144
    v_mfma_f32_16x16x32_bf16 v[240:243], v[60:63], v[32:35], v[240:243]
    ds_read_b64_tr_b16 v[56:57], v10 offset:21504
    v_mfma_f32_16x16x32_bf16 v[244:247], v[60:63], v[36:39], v[244:247]
    ds_read_b64_tr_b16 v[58:59], v10 offset:22016
    v_mfma_f32_16x16x32_bf16 v[248:251], v[60:63], v[40:43], v[248:251]
    v_mfma_f32_16x16x32_bf16 v[252:255], v[60:63], v[44:47], v[252:255]
    s_waitcnt lgkmcnt(6)
    v_mfma_f32_16x16x32_bf16 v[96:99], v[16:19], v[48:51], v[96:99]
    s_waitcnt lgkmcnt(5)
    s_mov_b32 s45, 1327104
    ds_read_b64_tr_b16 v[60:61], v10 offset:23552
    v_bfe_u32 v85, v0, 3, 2
    v_mfma_f32_16x16x32_bf16 v[100:103], v[20:23], v[48:51], v[100:103]
    s_waitcnt lgkmcnt(4)
    s_add_u32 m0, s44, 1024
    ds_read_b64_tr_b16 v[62:63], v10 offset:24064
    v_bfe_u32 v83, v0, 2, 1
    v_mfma_f32_16x16x32_bf16 v[104:107], v[24:27], v[48:51], v[104:107]
    s_waitcnt lgkmcnt(4)
    buffer_load_dwordx4 v4, s[12:15], s45 offen lds
    v_mfma_f32_16x16x32_bf16 v[108:111], v[28:31], v[48:51], v[108:111]
    v_lshlrev_b32 v85, 6, v85
    v_mfma_f32_16x16x32_bf16 v[112:115], v[16:19], v[52:55], v[112:115]
    ds_read_b64_tr_b16 v[48:49], v11 offset:21504
    v_lshl_add_u32 v85, v83, 12, v85
    v_mfma_f32_16x16x32_bf16 v[116:119], v[20:23], v[52:55], v[116:119]
    ds_read_b64_tr_b16 v[50:51], v11 offset:22016
    v_and_b32 v83, 3, v0
    v_mfma_f32_16x16x32_bf16 v[120:123], v[24:27], v[52:55], v[120:123]
    s_lshl_b32 s56, s50, 6
    buffer_load_dwordx4 v5, s[12:15], s45 offen offset:1024 lds
    v_mfma_f32_16x16x32_bf16 v[124:127], v[28:31], v[52:55], v[124:127]
    s_waitcnt lgkmcnt(4)
    v_lshl_add_u32 v85, v83, 4, v85
    v_mfma_f32_16x16x32_bf16 v[128:131], v[56:59], v[16:19], v[128:131]
    s_add_u32 s56, s56, 32768
    ds_read_b64_tr_b16 v[52:53], v11 offset:23552
    v_mfma_f32_16x16x32_bf16 v[132:135], v[56:59], v[20:23], v[132:135]
    s_add_u32 m0, s44, 3072
    ds_read_b64_tr_b16 v[54:55], v11 offset:24064
    v_mfma_f32_16x16x32_bf16 v[136:139], v[56:59], v[24:27], v[136:139]
    s_lshl_b32 s57, s49, 9
    buffer_load_dwordx4 v4, s[16:19], s45 offen lds
    v_mfma_f32_16x16x32_bf16 v[140:143], v[56:59], v[28:31], v[140:143]
    s_waitcnt lgkmcnt(4)
    v_add_u32 v85, s56, v85
    v_mfma_f32_16x16x32_bf16 v[144:147], v[60:63], v[16:19], v[144:147]
    ds_read_b64_tr_b16 v[56:57], v12 offset:21504
    v_add_u32 v84, s57, v14
    v_mfma_f32_16x16x32_bf16 v[148:151], v[60:63], v[20:23], v[148:151]
    ds_read_b64_tr_b16 v[58:59], v12 offset:22016
    v_cndmask_b32 v84, v84, v85, s[62:63]
    v_mfma_f32_16x16x32_bf16 v[152:155], v[60:63], v[24:27], v[152:155]
    buffer_load_dwordx4 v5, s[16:19], s45 offen offset:1024 lds
    v_mfma_f32_16x16x32_bf16 v[156:159], v[60:63], v[28:31], v[156:159]
    s_waitcnt lgkmcnt(4)
    v_cndmask_b32 v84, v84, v85, s[96:97]
    v_mfma_f32_16x16x32_bf16 v[160:163], v[48:51], v[16:19], v[160:163]
    s_mov_b32 s46, 768
    ds_read_b64_tr_b16 v[60:61], v12 offset:23552
    v_bfe_u32 v85, v0, 1, 2
    v_mfma_f32_16x16x32_bf16 v[164:167], v[48:51], v[20:23], v[164:167]
    s_add_u32 m0, s44, 0
    ds_read_b64_tr_b16 v[62:63], v12 offset:24064
    v_and_b32 v83, 1, v0
    v_mfma_f32_16x16x32_bf16 v[168:171], v[48:51], v[24:27], v[168:171]
    buffer_load_dwordx4 v3, s[8:11], s46 offen lds
    v_mfma_f32_16x16x32_bf16 v[172:175], v[48:51], v[28:31], v[172:175]
    s_waitcnt lgkmcnt(4)
    v_lshlrev_b32 v85, 7, v85
    v_mfma_f32_16x16x32_bf16 v[176:179], v[52:55], v[16:19], v[176:179]
    s_lshl_b32 s56, s52, 4
    ds_read_b64_tr_b16 v[48:49], v13 offset:21504
    v_mfma_f32_16x16x32_bf16 v[180:183], v[52:55], v[20:23], v[180:183]
    ds_read_b64_tr_b16 v[50:51], v13 offset:22016
    v_lshl_add_u32 v85, v83, 4, v85
    v_mfma_f32_16x16x32_bf16 v[184:187], v[52:55], v[24:27], v[184:187]
    s_add_u32 s56, s56, s40
    v_mfma_f32_16x16x32_bf16 v[188:191], v[52:55], v[28:31], v[188:191]
    s_waitcnt lgkmcnt(4)
    v_cmp_lt_u32 vcc, 55, v0
    v_mfma_f32_16x16x32_bf16 v[192:195], v[56:59], v[16:19], v[192:195]
    s_lshl_b32 s56, s56, 5
    ds_read_b64_tr_b16 v[52:53], v13 offset:23552
    v_mfma_f32_16x16x32_bf16 v[196:199], v[56:59], v[20:23], v[196:199]
    ds_read_b64_tr_b16 v[54:55], v13 offset:24064
    v_add_u32 v85, s56, v85
    v_mfma_f32_16x16x32_bf16 v[200:203], v[56:59], v[24:27], v[200:203]
    v_cndmask_b32 v84, v84, v85, vcc
    v_mfma_f32_16x16x32_bf16 v[204:207], v[56:59], v[28:31], v[204:207]
    s_waitcnt lgkmcnt(4)
    v_lshrrev_b32 v85, 4, v0
    v_mfma_f32_16x16x32_bf16 v[208:211], v[60:63], v[16:19], v[208:211]
    ds_read_b128 v[56:59], v9 offset:20480
    v_and_b32 v83, 15, v0
    v_mfma_f32_16x16x32_bf16 v[212:215], v[60:63], v[20:23], v[212:215]
    s_lshl_b32 s56, s42, 8
    v_mfma_f32_16x16x32_bf16 v[216:219], v[60:63], v[24:27], v[216:219]
    ds_read_b128 v[32:35], v7 offset:0
    v_lshlrev_b32 v85, 13, v85
    v_mfma_f32_16x16x32_bf16 v[220:223], v[60:63], v[28:31], v[220:223]
    s_waitcnt lgkmcnt(4)
    ds_read_b128 v[36:39], v7 offset:2048
    v_mfma_f32_16x16x32_bf16 v[224:227], v[48:51], v[16:19], v[224:227]
    s_add_u32 s56, s56, 653312
    ds_read_b128 v[60:63], v9 offset:30720
    v_mfma_f32_16x16x32_bf16 v[228:231], v[48:51], v[20:23], v[228:231]
    v_lshl_add_u32 v85, v83, 4, v85
    v_mfma_f32_16x16x32_bf16 v[232:235], v[48:51], v[24:27], v[232:235]
    ds_read_b128 v[40:43], v7 offset:4096
    v_add_u32 v85, s56, v85
    v_mfma_f32_16x16x32_bf16 v[236:239], v[48:51], v[28:31], v[236:239]
    s_waitcnt lgkmcnt(5)
    ds_read_b128 v[44:47], v7 offset:6144
    v_lshrrev_b32 v86, 5, v0
    v_mfma_f32_16x16x32_bf16 v[240:243], v[52:55], v[16:19], v[240:243]
    s_mov_b32 s45, 768
    ds_read_b64_tr_b16 v[48:49], v10 offset:31744
    v_mul_u32_u24 v86, 768, v86
    v_mfma_f32_16x16x32_bf16 v[244:247], v[52:55], v[20:23], v[244:247]
    s_add_u32 m0, s43, 0
    ds_read_b64_tr_b16 v[50:51], v10 offset:32256
    v_lshl_add_u32 v87, v0, 3, s48
    v_mfma_f32_16x16x32_bf16 v[248:251], v[52:55], v[24:27], v[248:251]
    buffer_load_dwordx4 v1, s[4:7], s45 offen lds
    v_mfma_f32_16x16x32_bf16 v[252:255], v[52:55], v[28:31], v[252:255]
    s_waitcnt lgkmcnt(6)
    v_add_u32 v86, v86, v87
    v_mfma_f32_16x16x32_bf16 v[96:99], v[32:35], v[56:59], v[96:99]
    s_waitcnt lgkmcnt(5)
    ds_read_b64_tr_b16 v[52:53], v10 offset:33792
    v_mfma_f32_16x16x32_bf16 v[100:103], v[36:39], v[56:59], v[100:103]
    s_waitcnt lgkmcnt(4)
    ds_read_b64_tr_b16 v[54:55], v10 offset:34304
    v_mfma_f32_16x16x32_bf16 v[104:107], v[40:43], v[56:59], v[104:107]
    s_waitcnt lgkmcnt(4)
    buffer_load_dwordx4 v2, s[4:7], s45 offen offset:1024 lds
    v_mfma_f32_16x16x32_bf16 v[108:111], v[44:47], v[56:59], v[108:111]
    v_mfma_f32_16x16x32_bf16 v[112:115], v[32:35], v[60:63], v[112:115]
    s_mov_b32 s46, 5888
    ds_read_b64_tr_b16 v[56:57], v11 offset:31744
L_st_2:
    s_cbranch_execz L_st_3
    v_mfma_f32_16x16x32_bf16 v[116:119], v[36:39], v[60:63], v[116:119]
    s_add_u32 m0, s43, 2048
    ds_read_b64_tr_b16 v[58:59], v11 offset:32256
    v_mfma_f32_16x16x32_bf16 v[120:123], v[40:43], v[60:63], v[120:123]
    buffer_load_dwordx4 v1, s[4:7], s46 offen lds
    v_mfma_f32_16x16x32_bf16 v[124:127], v[44:47], v[60:63], v[124:127]
    s_waitcnt lgkmcnt(4)
    v_mfma_f32_16x16x32_bf16 v[128:131], v[48:51], v[32:35], v[128:131]
    ds_read_b64_tr_b16 v[60:61], v11 offset:33792
    v_mfma_f32_16x16x32_bf16 v[132:135], v[48:51], v[36:39], v[132:135]
    ds_read_b64_tr_b16 v[62:63], v11 offset:34304
    v_mfma_f32_16x16x32_bf16 v[136:139], v[48:51], v[40:43], v[136:139]
    buffer_load_dwordx4 v2, s[4:7], s46 offen offset:1024 lds
    v_mfma_f32_16x16x32_bf16 v[140:143], v[48:51], v[44:47], v[140:143]
    s_waitcnt lgkmcnt(4)
    v_mfma_f32_16x16x32_bf16 v[144:147], v[52:55], v[32:35], v[144:147]
    s_mov_b32 s45, 11008
    ds_read_b64_tr_b16 v[48:49], v12 offset:31744
    v_mfma_f32_16x16x32_bf16 v[148:151], v[52:55], v[36:39], v[148:151]
    s_add_u32 m0, s43, 4096
    ds_read_b64_tr_b16 v[50:51], v12 offset:32256
    v_mfma_f32_16x16x32_bf16 v[152:155], v[52:55], v[40:43], v[152:155]
    buffer_load_dwordx4 v1, s[4:7], s45 offen lds
    v_mfma_f32_16x16x32_bf16 v[156:159], v[52:55], v[44:47], v[156:159]
    s_waitcnt lgkmcnt(4)
    v_mfma_f32_16x16x32_bf16 v[160:163], v[56:59], v[32:35], v[160:163]
    ds_read_b64_tr_b16 v[52:53], v12 offset:33792
    v_mfma_f32_16x16x32_bf16 v[164:167], v[56:59], v[36:39], v[164:167]
    ds_read_b64_tr_b16 v[54:55], v12 offset:34304
    v_mfma_f32_16x16x32_bf16 v[168:171], v[56:59], v[40:43], v[168:171]
    buffer_load_dwordx4 v2, s[4:7], s45 offen offset:1024 lds
    v_mfma_f32_16x16x32_bf16 v[172:175], v[56:59], v[44:47], v[172:175]
    s_waitcnt lgkmcnt(4)
    v_mfma_f32_16x16x32_bf16 v[176:179], v[60:63], v[32:35], v[176:179]
    s_mov_b32 s46, 16128
    ds_read_b64_tr_b16 v[56:57], v13 offset:31744
    v_mfma_f32_16x16x32_bf16 v[180:183], v[60:63], v[36:39], v[180:183]
    s_add_u32 m0, s43, 6144
    ds_read_b64_tr_b16 v[58:59], v13 offset:32256
    v_mfma_f32_16x16x32_bf16 v[184:187], v[60:63], v[40:43], v[184:187]
    buffer_load_dwordx4 v1, s[4:7], s46 offen lds
    v_mfma_f32_16x16x32_bf16 v[188:191], v[60:63], v[44:47], v[188:191]
    s_waitcnt lgkmcnt(4)
    v_mfma_f32_16x16x32_bf16 v[192:195], v[48:51], v[32:35], v[192:195]
    ds_read_b64_tr_b16 v[60:61], v13 offset:33792
    v_mfma_f32_16x16x32_bf16 v[196:199], v[48:51], v[36:39], v[196:199]
    ds_read_b64_tr_b16 v[62:63], v13 offset:34304
    v_mfma_f32_16x16x32_bf16 v[200:203], v[48:51], v[40:43], v[200:203]
    buffer_load_dwordx4 v2, s[4:7], s46 offen offset:1024 lds
    v_mfma_f32_16x16x32_bf16 v[204:207], v[48:51], v[44:47], v[204:207]
    s_waitcnt lgkmcnt(4)
    s_waitcnt vmcnt(13)
    s_barrier
    v_mfma_f32_16x16x32_bf16 v[208:211], v[52:55], v[32:35], v[208:211]
    ds_read_b128 v[48:51], v8 offset:40960
    v_mfma_f32_16x16x32_bf16 v[212:215], v[52:55], v[36:39], v[212:215]
    v_mfma_f32_16x16x32_bf16 v[216:219], v[52:55], v[40:43], v[216:219]
    ds_read_b128 v[16:19], v6 offset:8192
    v_mfma_f32_16x16x32_bf16 v[220:223], v[52:55], v[44:47], v[220:223]
    s_waitcnt lgkmcnt(4)
    ds_read_b128 v[20:23], v6 offset:10240
    v_mfma_f32_16x16x32_bf16 v[224:227], v[56:59], v[32:35], v[224:227]
    ds_read_b128 v[52:55], v8 offset:51200
    v_mfma_f32_16x16x32_bf16 v[228:231], v[56:59], v[36:39], v[228:231]
    v_mfma_f32_16x16x32_bf16 v[232:235], v[56:59], v[40:43], v[232:235]
    ds_read_b128 v[24:27], v6 offset:12288
    v_mfma_f32_16x16x32_bf16 v[236:239], v[56:59], v[44:47], v[236:239]
    s_waitcnt lgkmcnt(5)
    ds_read_b128 v[28:31], v6 offset:14336
    v_mfma_f32_16x16x32_bf16 v[240:243], v[60:63], v[32:35], v[240:243]
    ds_read_b64_tr_b16 v[56:57], v10 offset:41984
    v_mfma_f32_16x16x32_bf16 v[244:247], v[60:63], v[36:39], v[244:247]
    ds_read_b64_tr_b16 v[58:59], v10 offset:42496
    v_mfma_f32_16x16x32_bf16 v[248:251], v[60:63], v[40:43], v[248:251]
    v_mfma_f32_16x16x32_bf16 v[252:255], v[60:63], v[44:47], v[252:255]
    s_waitcnt lgkmcnt(6)
    v_mfma_f32_16x16x32_bf16 v[96:99], v[16:19], v[48:51], v[96:99]
    s_waitcnt lgkmcnt(5)
    s_mov_b32 s45, 1548288
    ds_read_b64_tr_b16 v[60:61], v10 offset:44032
    v_mfma_f32_16x16x32_bf16 v[100:103], v[20:23], v[48:51], v[100:103]
    s_waitcnt lgkmcnt(4)
    s_add_u32 m0, s44, 21504
    ds_read_b64_tr_b16 v[62:63], v10 offset:44544
    v_mfma_f32_16x16x32_bf16 v[104:107], v[24:27], v[48:51], v[104:107]
    s_waitcnt lgkmcnt(4)
    buffer_load_dwordx4 v4, s[12:15], s45 offen lds
    v_mfma_f32_16x16x32_bf16 v[108:111], v[28:31], v[48:51], v[108:111]
    v_mfma_f32_16x16x32_bf16 v[112:115], v[16:19], v[52:55], v[112:115]
    ds_read_b64_tr_b16 v[48:49], v11 offset:41984
    v_mfma_f32_16x16x32_bf16 v[116:119], v[20:23], v[52:55], v[116:119]
    ds_read_b64_tr_b16 v[50:51], v11 offset:42496
    v_mfma_f32_16x16x32_bf16 v[120:123], v[24:27], v[52:55], v[120:123]
    buffer_load_dwordx4 v5, s[12:15], s45 offen offset:1024 lds
    v_mfma_f32_16x16x32_bf16 v[124:127], v[28:31], v[52:55], v[124:127]
    s_waitcnt lgkmcnt(4)
    v_mfma_f32_16x16x32_bf16 v[128:131], v[56:59], v[16:19], v[128:131]
    ds_read_b64_tr_b16 v[52:53], v11 offset:44032
    v_mfma_f32_16x16x32_bf16 v[132:135], v[56:59], v[20:23], v[132:135]
    s_add_u32 m0, s44, 23552
    ds_read_b64_tr_b16 v[54:55], v11 offset:44544
    v_mfma_f32_16x16x32_bf16 v[136:139], v[56:59], v[24:27], v[136:139]
    buffer_load_dwordx4 v4, s[16:19], s45 offen lds
    v_mfma_f32_16x16x32_bf16 v[140:143], v[56:59], v[28:31], v[140:143]
    s_waitcnt lgkmcnt(4)
    v_mfma_f32_16x16x32_bf16 v[144:147], v[60:63], v[16:19], v[144:147]
    ds_read_b64_tr_b16 v[56:57], v12 offset:41984
    v_mfma_f32_16x16x32_bf16 v[148:151], v[60:63], v[20:23], v[148:151]
    ds_read_b64_tr_b16 v[58:59], v12 offset:42496
    v_mfma_f32_16x16x32_bf16 v[152:155], v[60:63], v[24:27], v[152:155]
    buffer_load_dwordx4 v5, s[16:19], s45 offen offset:1024 lds
    v_mfma_f32_16x16x32_bf16 v[156:159], v[60:63], v[28:31], v[156:159]
    s_waitcnt lgkmcnt(4)
    v_mfma_f32_16x16x32_bf16 v[160:163], v[48:51], v[16:19], v[160:163]
    s_mov_b32 s46, 896
    ds_read_b64_tr_b16 v[60:61], v12 offset:44032
    v_mfma_f32_16x16x32_bf16 v[164:167], v[48:51], v[20:23], v[164:167]
    s_add_u32 m0, s44, 20480
    ds_read_b64_tr_b16 v[62:63], v12 offset:44544
    v_mfma_f32_16x16x32_bf16 v[168:171], v[48:51], v[24:27], v[168:171]
    buffer_load_dwordx4 v3, s[8:11], s46 offen lds
    v_mfma_f32_16x16x32_bf16 v[172:175], v[48:51], v[28:31], v[172:175]
    s_waitcnt lgkmcnt(4)
    v_mfma_f32_16x16x32_bf16 v[176:179], v[52:55], v[16:19], v[176:179]
    ds_read_b64_tr_b16 v[48:49], v13 offset:41984
    v_mfma_f32_16x16x32_bf16 v[180:183], v[52:55], v[20:23], v[180:183]
    ds_read_b64_tr_b16 v[50:51], v13 offset:42496
    v_mfma_f32_16x16x32_bf16 v[184:187], v[52:55], v[24:27], v[184:187]
    v_mfma_f32_16x16x32_bf16 v[188:191], v[52:55], v[28:31], v[188:191]
    s_waitcnt lgkmcnt(4)
    v_mfma_f32_16x16x32_bf16 v[192:195], v[56:59], v[16:19], v[192:195]
    ds_read_b64_tr_b16 v[52:53], v13 offset:44032
    v_mfma_f32_16x16x32_bf16 v[196:199], v[56:59], v[20:23], v[196:199]
    ds_read_b64_tr_b16 v[54:55], v13 offset:44544
    v_mfma_f32_16x16x32_bf16 v[200:203], v[56:59], v[24:27], v[200:203]
    buffer_load_dword v93, v92, s[20:23], s66 offen sc1
    v_mfma_f32_16x16x32_bf16 v[204:207], v[56:59], v[28:31], v[204:207]
    s_waitcnt lgkmcnt(4)
    v_mfma_f32_16x16x32_bf16 v[208:211], v[60:63], v[16:19], v[208:211]
    ds_read_b128 v[56:59], v9 offset:40960
    v_mfma_f32_16x16x32_bf16 v[212:215], v[60:63], v[20:23], v[212:215]
    v_mfma_f32_16x16x32_bf16 v[216:219], v[60:63], v[24:27], v[216:219]
    ds_read_b128 v[32:35], v7 offset:8192
    v_mfma_f32_16x16x32_bf16 v[220:223], v[60:63], v[28:31], v[220:223]
    s_waitcnt lgkmcnt(4)
    ds_read_b128 v[36:39], v7 offset:10240
    v_mfma_f32_16x16x32_bf16 v[224:227], v[48:51], v[16:19], v[224:227]
    ds_read_b128 v[60:63], v9 offset:51200
    v_mfma_f32_16x16x32_bf16 v[228:231], v[48:51], v[20:23], v[228:231]
    v_mfma_f32_16x16x32_bf16 v[232:235], v[48:51], v[24:27], v[232:235]
    ds_read_b128 v[40:43], v7 offset:12288
    v_mfma_f32_16x16x32_bf16 v[236:239], v[48:51], v[28:31], v[236:239]
    s_waitcnt lgkmcnt(5)
    ds_read_b128 v[44:47], v7 offset:14336
    v_mfma_f32_16x16x32_bf16 v[240:243], v[52:55], v[16:19], v[240:243]
    s_mov_b32 s45, 896
    ds_read_b64_tr_b16 v[48:49], v10 offset:52224
    v_mfma_f32_16x16x32_bf16 v[244:247], v[52:55], v[20:23], v[244:247]
    s_add_u32 m0, s43, 8192
    ds_read_b64_tr_b16 v[50:51], v10 offset:52736
    v_mfma_f32_16x16x32_bf16 v[248:251], v[52:55], v[24:27], v[248:251]
    buffer_load_dwordx4 v1, s[4:7], s45 offen lds
    v_mfma_f32_16x16x32_bf16 v[252:255], v[52:55], v[28:31], v[252:255]
    s_waitcnt lgkmcnt(6)
    v_mfma_f32_16x16x32_bf16 v[96:99], v[32:35], v[56:59], v[96:99]
    s_waitcnt lgkmcnt(5)
    ds_read_b64_tr_b16 v[52:53], v10 offset:54272
    v_mfma_f32_16x16x32_bf16 v[100:103], v[36:39], v[56:59], v[100:103]
    s_waitcnt lgkmcnt(4)
    ds_read_b64_tr_b16 v[54:55], v10 offset:54784
    v_mfma_f32_16x16x32_bf16 v[104:107], v[40:43], v[56:59], v[104:107]
    s_waitcnt lgkmcnt(4)
    buffer_load_dwordx4 v2, s[4:7], s45 offen offset:1024 lds
    v_mfma_f32_16x16x32_bf16 v[108:111], v[44:47], v[56:59], v[108:111]
    v_mfma_f32_16x16x32_bf16 v[112:115], v[32:35], v[60:63], v[112:115]
    s_mov_b32 s46, 6016
    ds_read_b64_tr_b16 v[56:57], v11 offset:52224
    v_mfma_f32_16x16x32_bf16 v[116:119], v[36:39], v[60:63], v[116:119]
    s_add_u32 m0, s43, 10240
    ds_read_b64_tr_b16 v[58:59], v11 offset:52736
    v_mfma_f32_16x16x32_bf16 v[120:123], v[40:43], v[60:63], v[120:123]
    buffer_load_dwordx4 v1, s[4:7], s46 offen lds
    v_mfma_f32_16x16x32_bf16 v[124:127], v[44:47], v[60:63], v[124:127]
    s_waitcnt lgkmcnt(4)
    v_mfma_f32_16x16x32_bf16 v[128:131], v[48:51], v[32:35], v[128:131]
    ds_read_b64_tr_b16 v[60:61], v11 offset:54272
    v_mfma_f32_16x16x32_bf16 v[132:135], v[48:51], v[36:39], v[132:135]
    ds_read_b64_tr_b16 v[62:63], v11 offset:54784
    v_mfma_f32_16x16x32_bf16 v[136:139], v[48:51], v[40:43], v[136:139]
    buffer_load_dwordx4 v2, s[4:7], s46 offen offset:1024 lds
    v_mfma_f32_16x16x32_bf16 v[140:143], v[48:51], v[44:47], v[140:143]
    s_waitcnt lgkmcnt(4)
    v_mfma_f32_16x16x32_bf16 v[144:147], v[52:55], v[32:35], v[144:147]
    s_mov_b32 s45, 11136
    ds_read_b64_tr_b16 v[48:49], v12 offset:52224
    v_mfma_f32_16x16x32_bf16 v[148:151], v[52:55], v[36:39], v[148:151]
    s_add_u32 m0, s43, 12288
    ds_read_b64_tr_b16 v[50:51], v12 offset:52736
    v_mfma_f32_16x16x32_bf16 v[152:155], v[52:55], v[40:43], v[152:155]
    buffer_load_dwordx4 v1, s[4:7], s45 offen lds
    v_mfma_f32_16x16x32_bf16 v[156:159], v[52:55], v[44:47], v[156:159]
    s_waitcnt lgkmcnt(4)
    v_mfma_f32_16x16x32_bf16 v[160:163], v[56:59], v[32:35], v[160:163]
    ds_read_b64_tr_b16 v[52:53], v12 offset:54272
    v_mfma_f32_16x16x32_bf16 v[164:167], v[56:59], v[36:39], v[164:167]
    ds_read_b64_tr_b16 v[54:55], v12 offset:54784
    v_mfma_f32_16x16x32_bf16 v[168:171], v[56:59], v[40:43], v[168:171]
    buffer_load_dwordx4 v2, s[4:7], s45 offen offset:1024 lds
    v_mfma_f32_16x16x32_bf16 v[172:175], v[56:59], v[44:47], v[172:175]
    s_waitcnt lgkmcnt(4)
    v_mfma_f32_16x16x32_bf16 v[176:179], v[60:63], v[32:35], v[176:179]
    s_mov_b32 s46, 16256
    ds_read_b64_tr_b16 v[56:57], v13 offset:52224
    v_mfma_f32_16x16x32_bf16 v[180:183], v[60:63], v[36:39], v[180:183]
    s_add_u32 m0, s43, 14336
    ds_read_b64_tr_b16 v[58:59], v13 offset:52736
    v_mfma_f32_16x16x32_bf16 v[184:187], v[60:63], v[40:43], v[184:187]
    buffer_load_dwordx4 v1, s[4:7], s46 offen lds
    v_mfma_f32_16x16x32_bf16 v[188:191], v[60:63], v[44:47], v[188:191]
    s_waitcnt lgkmcnt(4)
    v_mfma_f32_16x16x32_bf16 v[192:195], v[48:51], v[32:35], v[192:195]
    ds_read_b64_tr_b16 v[60:61], v13 offset:54272
    v_mfma_f32_16x16x32_bf16 v[196:199], v[48:51], v[36:39], v[196:199]
    ds_read_b64_tr_b16 v[62:63], v13 offset:54784
    v_mfma_f32_16x16x32_bf16 v[200:203], v[48:51], v[40:43], v[200:203]
    buffer_load_dwordx4 v2, s[4:7], s46 offen offset:1024 lds
    v_mfma_f32_16x16x32_bf16 v[204:207], v[48:51], v[44:47], v[204:207]
    s_waitcnt lgkmcnt(4)
    s_waitcnt vmcnt(14)
    s_waitcnt vmcnt(8)
    v_cmp_ne_u32 vcc, 1, v93
    s_mov_b32 s55, 0
    s_cbranch_vccz L_ok_7
L_sp_8:
    s_sleep 16
    buffer_load_dword v93, v92, s[20:23], s66 offen sc1
    s_add_u32 s55, s55, 1
    s_cmp_gt_u32 s55, 200000
    s_cbranch_scc1 L_ok_7
    s_waitcnt vmcnt(0)
    v_cmp_ne_u32 vcc, 1, v93
    s_nop 0
    s_cbranch_vccnz L_sp_8
L_ok_7:
    s_barrier
    v_mfma_f32_16x16x32_bf16 v[208:211], v[52:55], v[32:35], v[208:211]
    s_add_u32 m0, s48, 4096
    ds_read_b128 v[48:51], v8 offset:0
    v_mfma_f32_16x16x32_bf16 v[212:215], v[52:55], v[36:39], v[212:215]
    buffer_load_dwordx4 v84, s[20:23], 0 offen sc1 lds
    v_mfma_f32_16x16x32_bf16 v[216:219], v[52:55], v[40:43], v[216:219]
    ds_read_b128 v[16:19], v6 offset:0
    v_mfma_f32_16x16x32_bf16 v[220:223], v[52:55], v[44:47], v[220:223]
    s_waitcnt lgkmcnt(4)
    ds_read_b128 v[20:23], v6 offset:2048
    v_mfma_f32_16x16x32_bf16 v[224:227], v[56:59], v[32:35], v[224:227]
    ds_read_b128 v[52:55], v8 offset:10240
    v_mfma_f32_16x16x32_bf16 v[228:231], v[56:59], v[36:39], v[228:231]
    buffer_load_dwordx4 v85, s[20:23], 0 offen offset:2048 sc1 lds
    v_mfma_f32_16x16x32_bf16 v[232:235], v[56:59], v[40:43], v[232:235]
    ds_read_b128 v[24:27], v6 offset:4096
    v_mfma_f32_16x16x32_bf16 v[236:239], v[56:59], v[44:47], v[236:239]
    s_waitcnt lgkmcnt(5)
    ds_read_b128 v[28:31], v6 offset:6144
    v_mfma_f32_16x16x32_bf16 v[240:243], v[60:63], v[32:35], v[240:243]
    ds_read_b64_tr_b16 v[56:57], v10 offset:1024
    v_mfma_f32_16x16x32_bf16 v[244:247], v[60:63], v[36:39], v[244:247]
    s_mov_b32 s59, 31744
    ds_read_b64_tr_b16 v[58:59], v10 offset:1536
    v_mfma_f32_16x16x32_bf16 v[248:251], v[60:63], v[40:43], v[248:251]
    buffer_load_dwordx4 v85, s[20:23], s59 offen offset:3072 sc1 lds
    v_mfma_f32_16x16x32_bf16 v[252:255], v[60:63], v[44:47], v[252:255]
    s_waitcnt lgkmcnt(6)
    v_mfma_f32_16x16x32_bf16 v[96:99], v[16:19], v[48:51], v[96:99]
    s_waitcnt lgkmcnt(5)
    s_mov_b32 s45, 1769472
    ds_read_b64_tr_b16 v[60:61], v10 offset:3072
    v_mfma_f32_16x16x32_bf16 v[100:103], v[20:23], v[48:51], v[100:103]
    s_waitcnt lgkmcnt(4)
    s_add_u32 m0, s44, 41984
    ds_read_b64_tr_b16 v[62:63], v10 offset:3584
    v_mfma_f32_16x16x32_bf16 v[104:107], v[24:27], v[48:51], v[104:107]
    s_waitcnt lgkmcnt(4)
    buffer_load_dwordx4 v4, s[12:15], s45 offen lds
    v_mfma_f32_16x16x32_bf16 v[108:111], v[28:31], v[48:51], v[108:111]
    v_mfma_f32_16x16x32_bf16 v[112:115], v[16:19], v[52:55], v[112:115]
    ds_read_b64_tr_b16 v[48:49], v11 offset:1024
    v_mfma_f32_16x16x32_bf16 v[116:119], v[20:23], v[52:55], v[116:119]
    ds_read_b64_tr_b16 v[50:51], v11 offset:1536
    v_mfma_f32_16x16x32_bf16 v[120:123], v[24:27], v[52:55], v[120:123]
    buffer_load_dwordx4 v5, s[12:15], s45 offen offset:1024 lds
    v_mfma_f32_16x16x32_bf16 v[124:127], v[28:31], v[52:55], v[124:127]
    s_waitcnt lgkmcnt(4)
    v_mfma_f32_16x16x32_bf16 v[128:131], v[56:59], v[16:19], v[128:131]
    ds_read_b64_tr_b16 v[52:53], v11 offset:3072
    v_mfma_f32_16x16x32_bf16 v[132:135], v[56:59], v[20:23], v[132:135]
    s_add_u32 m0, s44, 44032
    ds_read_b64_tr_b16 v[54:55], v11 offset:3584
    v_mfma_f32_16x16x32_bf16 v[136:139], v[56:59], v[24:27], v[136:139]
    buffer_load_dwordx4 v4, s[16:19], s45 offen lds
    v_mfma_f32_16x16x32_bf16 v[140:143], v[56:59], v[28:31], v[140:143]
    s_waitcnt lgkmcnt(4)
    v_mfma_f32_16x16x32_bf16 v[144:147], v[60:63], v[16:19], v[144:147]
    ds_read_b64_tr_b16 v[56:57], v12 offset:1024
    v_mfma_f32_16x16x32_bf16 v[148:151], v[60:63], v[20:23], v[148:151]
    ds_read_b64_tr_b16 v[58:59], v12 offset:1536
    v_mfma_f32_16x16x32_bf16 v[152:155], v[60:63], v[24:27], v[152:155]
    buffer_load_dwordx4 v5, s[16:19], s45 offen offset:1024 lds
    v_mfma_f32_16x16x32_bf16 v[156:159], v[60:63], v[28:31], v[156:159]
    s_waitcnt lgkmcnt(4)
    v_mfma_f32_16x16x32_bf16 v[160:163], v[48:51], v[16:19], v[160:163]
    s_mov_b32 s46, 1024
    ds_read_b64_tr_b16 v[60:61], v12 offset:3072
    v_mfma_f32_16x16x32_bf16 v[164:167], v[48:51], v[20:23], v[164:167]
    s_add_u32 m0, s44, 40960
    ds_read_b64_tr_b16 v[62:63], v12 offset:3584
    v_mfma_f32_16x16x32_bf16 v[168:171], v[48:51], v[24:27], v[168:171]
    buffer_load_dwordx4 v3, s[8:11], s46 offen lds
    v_mfma_f32_16x16x32_bf16 v[172:175], v[48:51], v[28:31], v[172:175]
    s_waitcnt lgkmcnt(4)
    v_mfma_f32_16x16x32_bf16 v[176:179], v[52:55], v[16:19], v[176:179]
    ds_read_b64_tr_b16 v[48:49], v13 offset:1024
    v_mfma_f32_16x16x32_bf16 v[180:183], v[52:55], v[20:23], v[180:183]
    s_mov_b32 s47, 0
    ds_read_b64_tr_b16 v[50:51], v13 offset:1536
    v_mfma_f32_16x16x32_bf16 v[184:187], v[52:55], v[24:27], v[184:187]
    buffer_load_dwordx4 a[0:3], v14, s[36:39], s47 offen offset:0 sc1
    v_mfma_f32_16x16x32_bf16 v[188:191], v[52:55], v[28:31], v[188:191]
    s_waitcnt lgkmcnt(4)
    v_mfma_f32_16x16x32_bf16 v[192:195], v[56:59], v[16:19], v[192:195]
    ds_read_b64_tr_b16 v[52:53], v13 offset:3072
    v_mfma_f32_16x16x32_bf16 v[196:199], v[56:59], v[20:23], v[196:199]
    ds_read_b64_tr_b16 v[54:55], v13 offset:3584
    v_mfma_f32_16x16x32_bf16 v[200:203], v[56:59], v[24:27], v[200:203]
    buffer_load_dwordx4 a[4:7], v14, s[36:39], s47 offen offset:1024 sc1
    v_mfma_f32_16x16x32_bf16 v[204:207], v[56:59], v[28:31], v[204:207]
    s_waitcnt lgkmcnt(4)
    v_mfma_f32_16x16x32_bf16 v[208:211], v[60:63], v[16:19], v[208:211]
    ds_read_b128 v[56:59], v9 offset:0
    v_mfma_f32_16x16x32_bf16 v[212:215], v[60:63], v[20:23], v[212:215]
    buffer_load_dwordx4 a[8:11], v14, s[36:39], s47 offen offset:2048 sc1
    v_mfma_f32_16x16x32_bf16 v[216:219], v[60:63], v[24:27], v[216:219]
    ds_read_b128 v[32:35], v7 offset:0
    v_mfma_f32_16x16x32_bf16 v[220:223], v[60:63], v[28:31], v[220:223]
    s_waitcnt lgkmcnt(4)
    ds_read_b128 v[36:39], v7 offset:2048
    v_mfma_f32_16x16x32_bf16 v[224:227], v[48:51], v[16:19], v[224:227]
    ds_read_b128 v[60:63], v9 offset:10240
    v_mfma_f32_16x16x32_bf16 v[228:231], v[48:51], v[20:23], v[228:231]
    buffer_load_dwordx4 a[12:15], v14, s[36:39], s47 offen offset:3072 sc1
    v_mfma_f32_16x16x32_bf16 v[232:235], v[48:51], v[24:27], v[232:235]
    ds_read_b128 v[40:43], v7 offset:4096
    v_mfma_f32_16x16x32_bf16 v[236:239], v[48:51], v[28:31], v[236:239]
    s_waitcnt lgkmcnt(5)
    ds_read_b128 v[44:47], v7 offset:6144
    v_mfma_f32_16x16x32_bf16 v[240:243], v[52:55], v[16:19], v[240:243]
    s_mov_b32 s45, 1024
    ds_read_b64_tr_b16 v[48:49], v10 offset:11264
    v_mfma_f32_16x16x32_bf16 v[244:247], v[52:55], v[20:23], v[244:247]
    s_add_u32 m0, s43, 0
    ds_read_b64_tr_b16 v[50:51], v10 offset:11776
    v_mfma_f32_16x16x32_bf16 v[248:251], v[52:55], v[24:27], v[248:251]
    buffer_load_dwordx4 v1, s[4:7], s45 offen lds
    v_mfma_f32_16x16x32_bf16 v[252:255], v[52:55], v[28:31], v[252:255]
    s_waitcnt lgkmcnt(6)
    v_mfma_f32_16x16x32_bf16 v[96:99], v[32:35], v[56:59], v[96:99]
    s_waitcnt lgkmcnt(5)
    ds_read_b64_tr_b16 v[52:53], v10 offset:13312
    s_waitcnt vmcnt(10)
    v_mfma_f32_16x16x32_bf16 v[100:103], v[36:39], v[56:59], v[100:103]
    s_waitcnt lgkmcnt(4)
    ds_read_b64_tr_b16 v[54:55], v10 offset:13824
    v_mfma_f32_16x16x32_bf16 v[104:107], v[40:43], v[56:59], v[104:107]
    s_waitcnt lgkmcnt(4)
    buffer_load_dwordx4 v2, s[4:7], s45 offen offset:1024 lds
    v_mfma_f32_16x16x32_bf16 v[108:111], v[44:47], v[56:59], v[108:111]
    ds_read_b64 v[76:77], v86 offset:6144
    v_mfma_f32_16x16x32_bf16 v[112:115], v[32:35], v[60:63], v[112:115]
    s_mov_b32 s46, 6144
    ds_read_b64_tr_b16 v[56:57], v11 offset:11264
    v_mfma_f32_16x16x32_bf16 v[116:119], v[36:39], v[60:63], v[116:119]
    s_add_u32 m0, s43, 2048
    ds_read_b64_tr_b16 v[58:59], v11 offset:11776
    v_mfma_f32_16x16x32_bf16 v[120:123], v[40:43], v[60:63], v[120:123]
    buffer_load_dwordx4 v1, s[4:7], s46 offen lds
    v_mfma_f32_16x16x32_bf16 v[124:127], v[44:47], v[60:63], v[124:127]
    s_waitcnt lgkmcnt(5)
    ds_read_b64 v[78:79], v86 offset:6400
    v_mfma_f32_16x16x32_bf16 v[128:131], v[48:51], v[32:35], v[128:131]
    ds_read_b64_tr_b16 v[60:61], v11 offset:13312
    v_mfma_f32_16x16x32_bf16 v[132:135], v[48:51], v[36:39], v[132:135]
    ds_read_b64_tr_b16 v[62:63], v11 offset:13824
    v_mfma_f32_16x16x32_bf16 v[136:139], v[48:51], v[40:43], v[136:139]
    buffer_load_dwordx4 v2, s[4:7], s46 offen offset:1024 lds
    v_mfma_f32_16x16x32_bf16 v[140:143], v[48:51], v[44:47], v[140:143]
    s_waitcnt lgkmcnt(6)
    ds_read_b64 v[80:81], v86 offset:6656
    v_mfma_f32_16x16x32_bf16 v[144:147], v[52:55], v[32:35], v[144:147]
    s_mov_b32 s45, 11264
    ds_read_b64_tr_b16 v[48:49], v12 offset:11264
    v_mfma_f32_16x16x32_bf16 v[148:151], v[52:55], v[36:39], v[148:151]
    s_add_u32 m0, s43, 4096
    ds_read_b64_tr_b16 v[50:51], v12 offset:11776
    v_mfma_f32_16x16x32_bf16 v[152:155], v[52:55], v[40:43], v[152:155]
    buffer_load_dwordx4 v1, s[4:7], s45 offen lds
    v_mfma_f32_16x16x32_bf16 v[156:159], v[52:55], v[44:47], v[156:159]
    s_waitcnt lgkmcnt(6)
    ds_read_b64 v[82:83], v86 offset:6912
    v_mfma_f32_16x16x32_bf16 v[160:163], v[56:59], v[32:35], v[160:163]
    ds_read_b64_tr_b16 v[52:53], v12 offset:13312
    v_bfe_u32 v84, v0, 2, 2
    v_mfma_f32_16x16x32_bf16 v[164:167], v[56:59], v[36:39], v[164:167]
    ds_read_b64_tr_b16 v[54:55], v12 offset:13824
    v_and_b32 v85, 3, v0
    v_mfma_f32_16x16x32_bf16 v[168:171], v[56:59], v[40:43], v[168:171]
    buffer_load_dwordx4 v2, s[4:7], s45 offen offset:1024 lds
    v_mfma_f32_16x16x32_bf16 v[172:175], v[56:59], v[44:47], v[172:175]
    s_waitcnt lgkmcnt(6)
    v_lshl_add_u32 v84, v84, 4, v85
    v_mfma_f32_16x16x32_bf16 v[176:179], v[60:63], v[32:35], v[176:179]
    s_mov_b32 s46, 16384
    ds_read_b64_tr_b16 v[56:57], v13 offset:11264
    v_lshl_add_u32 v85, v84, 3, s48
    v_mfma_f32_16x16x32_bf16 v[180:183], v[60:63], v[36:39], v[180:183]
    s_add_u32 m0, s43, 6144
    ds_read_b64_tr_b16 v[58:59], v13 offset:11776
    v_mfma_f32_16x16x32_bf16 v[184:187], v[60:63], v[40:43], v[184:187]
    buffer_load_dwordx4 v1, s[4:7], s46 offen lds
    v_mfma_f32_16x16x32_bf16 v[188:191], v[60:63], v[44:47], v[188:191]
    s_waitcnt lgkmcnt(5)
    v_mfma_f32_16x16x32_bf16 v[192:195], v[48:51], v[32:35], v[192:195]
    ds_read_b64_tr_b16 v[60:61], v13 offset:13312
    v_mfma_f32_16x16x32_bf16 v[196:199], v[48:51], v[36:39], v[196:199]
    ds_read_b64_tr_b16 v[62:63], v13 offset:13824
    v_mfma_f32_16x16x32_bf16 v[200:203], v[48:51], v[40:43], v[200:203]
    buffer_load_dwordx4 v2, s[4:7], s46 offen offset:1024 lds
    v_mfma_f32_16x16x32_bf16 v[204:207], v[48:51], v[44:47], v[204:207]
    s_waitcnt lgkmcnt(4)
    s_waitcnt vmcnt(20)
    s_barrier
    v_mfma_f32_16x16x32_bf16 v[208:211], v[52:55], v[32:35], v[208:211]
    s_add_u32 s47, s47, 1024
    ds_read_b128 v[48:51], v8 offset:20480
    v_mfma_f32_16x16x32_bf16 v[212:215], v[52:55], v[36:39], v[212:215]
    buffer_load_dwordx4 a[16:19], v14, s[36:39], s47 offen offset:3072 sc1
    v_mfma_f32_16x16x32_bf16 v[216:219], v[52:55], v[40:43], v[216:219]
    ds_read_b128 v[16:19], v6 offset:8192
    v_mfma_f32_16x16x32_bf16 v[220:223], v[52:55], v[44:47], v[220:223]
    s_waitcnt lgkmcnt(4)
    ds_read_b128 v[20:23], v6 offset:10240
    v_mfma_f32_16x16x32_bf16 v[224:227], v[56:59], v[32:35], v[224:227]
    s_mov_b32 s47, 5120
    ds_read_b128 v[52:55], v8 offset:30720
    v_mfma_f32_16x16x32_bf16 v[228:231], v[56:59], v[36:39], v[228:231]
    buffer_load_dwordx4 a[20:23], v14, s[36:39], s47 offen offset:0 sc1
    v_mfma_f32_16x16x32_bf16 v[232:235], v[56:59], v[40:43], v[232:235]
    ds_read_b128 v[24:27], v6 offset:12288
    v_mfma_f32_16x16x32_bf16 v[236:239], v[56:59], v[44:47], v[236:239]
    s_waitcnt lgkmcnt(5)
    ds_read_b128 v[28:31], v6 offset:14336
    v_mfma_f32_16x16x32_bf16 v[240:243], v[60:63], v[32:35], v[240:243]
    ds_read_b64_tr_b16 v[56:57], v10 offset:21504
    v_mfma_f32_16x16x32_bf16 v[244:247], v[60:63], v[36:39], v[244:247]
    ds_read_b64_tr_b16 v[58:59], v10 offset:22016
    v_mfma_f32_16x16x32_bf16 v[248:251], v[60:63], v[40:43], v[248:251]
    buffer_load_dwordx4 a[24:27], v14, s[36:39], s47 offen offset:1024 sc1
    v_mfma_f32_16x16x32_bf16 v[252:255], v[60:63], v[44:47], v[252:255]
    s_waitcnt lgkmcnt(6)
    v_mfma_f32_16x16x32_bf16 v[96:99], v[16:19], v[48:51], v[96:99]
    s_waitcnt lgkmcnt(5)
    s_mov_b32 s45, 1990656
    ds_read_b64_tr_b16 v[60:61], v10 offset:23552
    v_add_f32 v76, v76, v78
    v_mfma_f32_16x16x32_bf16 v[100:103], v[20:23], v[48:51], v[100:103]
    s_waitcnt lgkmcnt(4)
    s_add_u32 m0, s44, 1024
    ds_read_b64_tr_b16 v[62:63], v10 offset:24064
    v_add_f32 v77, v77, v79
    v_mfma_f32_16x16x32_bf16 v[104:107], v[24:27], v[48:51], v[104:107]
    s_waitcnt lgkmcnt(4)
    buffer_load_dwordx4 v4, s[12:15], s45 offen lds
    v_mfma_f32_16x16x32_bf16 v[108:111], v[28:31], v[48:51], v[108:111]
    v_add_f32 v80, v80, v82
    v_mfma_f32_16x16x32_bf16 v[112:115], v[16:19], v[52:55], v[112:115]
    ds_read_b64_tr_b16 v[48:49], v11 offset:21504
    v_add_f32 v81, v81, v83
    v_mfma_f32_16x16x32_bf16 v[116:119], v[20:23], v[52:55], v[116:119]
    ds_read_b64_tr_b16 v[50:51], v11 offset:22016
    v_add_f32 v76, v76, v80
    v_mfma_f32_16x16x32_bf16 v[120:123], v[24:27], v[52:55], v[120:123]
    buffer_load_dwordx4 v5, s[12:15], s45 offen offset:1024 lds
    v_mfma_f32_16x16x32_bf16 v[124:127], v[28:31], v[52:55], v[124:127]
    s_waitcnt lgkmcnt(4)
    v_add_f32 v77, v77, v81
    v_mfma_f32_16x16x32_bf16 v[128:131], v[56:59], v[16:19], v[128:131]
    ds_read_b64_tr_b16 v[52:53], v11 offset:23552
    v_mfma_f32_16x16x32_bf16 v[132:135], v[56:59], v[20:23], v[132:135]
    s_add_u32 m0, s44, 3072
    ds_read_b64_tr_b16 v[54:55], v11 offset:24064
    v_mfma_f32_16x16x32_bf16 v[136:139], v[56:59], v[24:27], v[136:139]
    buffer_load_dwordx4 v4, s[16:19], s45 offen lds
    v_mfma_f32_16x16x32_bf16 v[140:143], v[56:59], v[28:31], v[140:143]
    s_waitcnt lgkmcnt(4)
    ds_write_b64 v87, v[76:77] offset:5120
    v_mfma_f32_16x16x32_bf16 v[144:147], v[60:63], v[16:19], v[144:147]
    ds_read_b64_tr_b16 v[56:57], v12 offset:21504
    v_mfma_f32_16x16x32_bf16 v[148:151], v[60:63], v[20:23], v[148:151]
    ds_read_b64_tr_b16 v[58:59], v12 offset:22016
    v_mfma_f32_16x16x32_bf16 v[152:155], v[60:63], v[24:27], v[152:155]
    buffer_load_dwordx4 v5, s[16:19], s45 offen offset:1024 lds
    v_mfma_f32_16x16x32_bf16 v[156:159], v[60:63], v[28:31], v[156:159]
    s_waitcnt lgkmcnt(5)
    ds_read_b64 v[76:77], v85 offset:4096
    v_mfma_f32_16x16x32_bf16 v[160:163], v[48:51], v[16:19], v[160:163]
    s_mov_b32 s46, 1152
    ds_read_b64_tr_b16 v[60:61], v12 offset:23552
    v_mfma_f32_16x16x32_bf16 v[164:167], v[48:51], v[20:23], v[164:167]
    s_add_u32 m0, s44, 0
    ds_read_b64_tr_b16 v[62:63], v12 offset:24064
    v_mfma_f32_16x16x32_bf16 v[168:171], v[48:51], v[24:27], v[168:171]
    buffer_load_dwordx4 v3, s[8:11], s46 offen lds
    v_mfma_f32_16x16x32_bf16 v[172:175], v[48:51], v[28:31], v[172:175]
    s_waitcnt lgkmcnt(6)
    ds_read_b64 v[78:79], v85 offset:4128
    v_mfma_f32_16x16x32_bf16 v[176:179], v[52:55], v[16:19], v[176:179]
    ds_read_b64_tr_b16 v[48:49], v13 offset:21504
    v_mfma_f32_16x16x32_bf16 v[180:183], v[52:55], v[20:23], v[180:183]
    ds_read_b64_tr_b16 v[50:51], v13 offset:22016
    v_mfma_f32_16x16x32_bf16 v[184:187], v[52:55], v[24:27], v[184:187]
    buffer_load_dwordx4 a[28:31], v14, s[36:39], s47 offen offset:2048 sc1
    v_mfma_f32_16x16x32_bf16 v[188:191], v[52:55], v[28:31], v[188:191]
    s_waitcnt lgkmcnt(6)
    ds_read_b64 v[80:81], v85 offset:4160
    v_mfma_f32_16x16x32_bf16 v[192:195], v[56:59], v[16:19], v[192:195]
    ds_read_b64_tr_b16 v[52:53], v13 offset:23552
    v_mfma_f32_16x16x32_bf16 v[196:199], v[56:59], v[20:23], v[196:199]
    ds_read_b64_tr_b16 v[54:55], v13 offset:24064
    v_mfma_f32_16x16x32_bf16 v[200:203], v[56:59], v[24:27], v[200:203]
    buffer_load_dwordx4 a[32:35], v14, s[36:39], s47 offen offset:3072 sc1
    v_mfma_f32_16x16x32_bf16 v[204:207], v[56:59], v[28:31], v[204:207]
    s_waitcnt lgkmcnt(6)
    ds_read_b64 v[82:83], v85 offset:4192
    v_mfma_f32_16x16x32_bf16 v[208:211], v[60:63], v[16:19], v[208:211]
    s_add_u32 s47, s47, 1024
    ds_read_b128 v[56:59], v9 offset:20480
    v_mfma_f32_16x16x32_bf16 v[212:215], v[60:63], v[20:23], v[212:215]
    buffer_load_dwordx4 a[36:39], v14, s[36:39], s47 offen offset:3072 sc1
    v_mfma_f32_16x16x32_bf16 v[216:219], v[60:63], v[24:27], v[216:219]
    ds_read_b128 v[32:35], v7 offset:8192
    v_mfma_f32_16x16x32_bf16 v[220:223], v[60:63], v[28:31], v[220:223]
    s_waitcnt lgkmcnt(6)
    ds_read_b128 v[36:39], v7 offset:10240
    v_mfma_f32_16x16x32_bf16 v[224:227], v[48:51], v[16:19], v[224:227]
    s_mov_b32 s47, 10240
    ds_read_b128 v[60:63], v9 offset:30720
    v_mfma_f32_16x16x32_bf16 v[228:231], v[48:51], v[20:23], v[228:231]
    buffer_load_dwordx4 a[40:43], v14, s[36:39], s47 offen offset:0 sc1
    v_mfma_f32_16x16x32_bf16 v[232:235], v[48:51], v[24:27], v[232:235]
    ds_read_b128 v[40:43], v7 offset:12288
    v_mfma_f32_16x16x32_bf16 v[236:239], v[48:51], v[28:31], v[236:239]
    s_waitcnt lgkmcnt(6)
    ds_read_b128 v[44:47], v7 offset:14336
L_st_3:
    s_cbranch_execz L_tr_x
    v_mfma_f32_16x16x32_bf16 v[240:243], v[52:55], v[16:19], v[240:243]
    s_mov_b32 s45, 1152
    ds_read_b64_tr_b16 v[48:49], v10 offset:31744
    v_mfma_f32_16x16x32_bf16 v[244:247], v[52:55], v[20:23], v[244:247]
    s_add_u32 m0, s43, 8192
    ds_read_b64_tr_b16 v[50:51], v10 offset:32256
    v_mfma_f32_16x16x32_bf16 v[248:251], v[52:55], v[24:27], v[248:251]
    buffer_load_dwordx4 v1, s[4:7], s45 offen lds
    v_mfma_f32_16x16x32_bf16 v[252:255], v[52:55], v[28:31], v[252:255]
    s_waitcnt lgkmcnt(6)
    v_mfma_f32_16x16x32_bf16 v[96:99], v[32:35], v[56:59], v[96:99]
    s_waitcnt lgkmcnt(5)
    ds_read_b64_tr_b16 v[52:53], v10 offset:33792
    v_mul_f32 v84, v77, v77
    v_mfma_f32_16x16x32_bf16 v[100:103], v[36:39], v[56:59], v[100:103]
    s_waitcnt lgkmcnt(4)
    ds_read_b64_tr_b16 v[54:55], v10 offset:34304
    v_mul_f32 v85, v79, v79
    v_mfma_f32_16x16x32_bf16 v[104:107], v[40:43], v[56:59], v[104:107]
    s_waitcnt lgkmcnt(4)
    buffer_load_dwordx4 v2, s[4:7], s45 offen offset:1024 lds
    v_mfma_f32_16x16x32_bf16 v[108:111], v[44:47], v[56:59], v[108:111]
    v_mul_f32 v86, v81, v81
    v_mfma_f32_16x16x32_bf16 v[112:115], v[32:35], v[60:63], v[112:115]
    s_mov_b32 s46, 6272
    ds_read_b64_tr_b16 v[56:57], v11 offset:31744
    v_mul_f32 v87, v83, v83
    v_mfma_f32_16x16x32_bf16 v[116:119], v[36:39], v[60:63], v[116:119]
    s_add_u32 m0, s43, 10240
    ds_read_b64_tr_b16 v[58:59], v11 offset:32256
    v_rcp_f32 v84, v84
    v_mfma_f32_16x16x32_bf16 v[120:123], v[40:43], v[60:63], v[120:123]
    buffer_load_dwordx4 v1, s[4:7], s46 offen lds
    v_mfma_f32_16x16x32_bf16 v[124:127], v[44:47], v[60:63], v[124:127]
    s_waitcnt lgkmcnt(4)
    v_rcp_f32 v85, v85
    v_mfma_f32_16x16x32_bf16 v[128:131], v[48:51], v[32:35], v[128:131]
    ds_read_b64_tr_b16 v[60:61], v11 offset:33792
    v_rcp_f32 v86, v86
    v_mfma_f32_16x16x32_bf16 v[132:135], v[48:51], v[36:39], v[132:135]
    ds_read_b64_tr_b16 v[62:63], v11 offset:34304
    v_rcp_f32 v87, v87
    v_mfma_f32_16x16x32_bf16 v[136:139], v[48:51], v[40:43], v[136:139]
    buffer_load_dwordx4 v2, s[4:7], s46 offen offset:1024 lds
    v_mfma_f32_16x16x32_bf16 v[140:143], v[48:51], v[44:47], v[140:143]
    s_waitcnt lgkmcnt(4)
    v_mul_f32 v77, 0xbfb8aa3b, v77
    v_mfma_f32_16x16x32_bf16 v[144:147], v[52:55], v[32:35], v[144:147]
    s_mov_b32 s45, 11392
    ds_read_b64_tr_b16 v[48:49], v12 offset:31744
    v_mul_f32 v79, 0xbfb8aa3b, v79
    v_mfma_f32_16x16x32_bf16 v[148:151], v[52:55], v[36:39], v[148:151]
    s_add_u32 m0, s43, 12288
    ds_read_b64_tr_b16 v[50:51], v12 offset:32256
    v_mul_f32 v81, 0xbfb8aa3b, v81
    v_mfma_f32_16x16x32_bf16 v[152:155], v[52:55], v[40:43], v[152:155]
    buffer_load_dwordx4 v1, s[4:7], s45 offen lds
    v_mfma_f32_16x16x32_bf16 v[156:159], v[52:55], v[44:47], v[156:159]
    s_waitcnt lgkmcnt(4)
    v_mul_f32 v83, 0xbfb8aa3b, v83
    v_mfma_f32_16x16x32_bf16 v[160:163], v[56:59], v[32:35], v[160:163]
    ds_read_b64_tr_b16 v[52:53], v12 offset:33792
    v_mfma_f32_16x16x32_bf16 v[164:167], v[56:59], v[36:39], v[164:167]
    ds_read_b64_tr_b16 v[54:55], v12 offset:34304
    v_mfma_f32_16x16x32_bf16 v[168:171], v[56:59], v[40:43], v[168:171]
    buffer_load_dwordx4 v2, s[4:7], s45 offen offset:1024 lds
    v_mfma_f32_16x16x32_bf16 v[172:175], v[56:59], v[44:47], v[172:175]
    s_waitcnt lgkmcnt(4)
    v_mfma_f32_16x16x32_bf16 v[176:179], v[60:63], v[32:35], v[176:179]
    s_mov_b32 s46, 16512
    ds_read_b64_tr_b16 v[56:57], v13 offset:31744
    v_mfma_f32_16x16x32_bf16 v[180:183], v[60:63], v[36:39], v[180:183]
    s_add_u32 m0, s43, 14336
    ds_read_b64_tr_b16 v[58:59], v13 offset:32256
    v_mfma_f32_16x16x32_bf16 v[184:187], v[60:63], v[40:43], v[184:187]
    buffer_load_dwordx4 v1, s[4:7], s46 offen lds
    v_mfma_f32_16x16x32_bf16 v[188:191], v[60:63], v[44:47], v[188:191]
    s_waitcnt lgkmcnt(4)
    v_mfma_f32_16x16x32_bf16 v[192:195], v[48:51], v[32:35], v[192:195]
    ds_read_b64_tr_b16 v[60:61], v13 offset:33792
    v_mfma_f32_16x16x32_bf16 v[196:199], v[48:51], v[36:39], v[196:199]
    ds_read_b64_tr_b16 v[62:63], v13 offset:34304
    v_mfma_f32_16x16x32_bf16 v[200:203], v[48:51], v[40:43], v[200:203]
    buffer_load_dwordx4 v2, s[4:7], s46 offen offset:1024 lds
    v_mfma_f32_16x16x32_bf16 v[204:207], v[48:51], v[44:47], v[204:207]
    s_waitcnt lgkmcnt(4)
    s_waitcnt vmcnt(20)
    s_barrier
    v_mfma_f32_16x16x32_bf16 v[208:211], v[52:55], v[32:35], v[208:211]
    ds_read_b128 v[48:51], v8 offset:40960
    v_mfma_f32_16x16x32_bf16 v[212:215], v[52:55], v[36:39], v[212:215]
    buffer_load_dwordx4 a[44:47], v14, s[36:39], s47 offen offset:1024 sc1
    v_mfma_f32_16x16x32_bf16 v[216:219], v[52:55], v[40:43], v[216:219]
    ds_read_b128 v[16:19], v6 offset:0
    v_mfma_f32_16x16x32_bf16 v[220:223], v[52:55], v[44:47], v[220:223]
    s_waitcnt lgkmcnt(4)
    ds_read_b128 v[20:23], v6 offset:2048
    v_mfma_f32_16x16x32_bf16 v[224:227], v[56:59], v[32:35], v[224:227]
    ds_read_b128 v[52:55], v8 offset:51200
    v_mfma_f32_16x16x32_bf16 v[228:231], v[56:59], v[36:39], v[228:231]
    buffer_load_dwordx4 a[48:51], v14, s[36:39], s47 offen offset:2048 sc1
    v_mfma_f32_16x16x32_bf16 v[232:235], v[56:59], v[40:43], v[232:235]
    ds_read_b128 v[24:27], v6 offset:4096
    v_mfma_f32_16x16x32_bf16 v[236:239], v[56:59], v[44:47], v[236:239]
    s_waitcnt lgkmcnt(5)
    ds_read_b128 v[28:31], v6 offset:6144
    v_mfma_f32_16x16x32_bf16 v[240:243], v[60:63], v[32:35], v[240:243]
    ds_read_b64_tr_b16 v[56:57], v10 offset:41984
    v_mfma_f32_16x16x32_bf16 v[244:247], v[60:63], v[36:39], v[244:247]
    ds_read_b64_tr_b16 v[58:59], v10 offset:42496
    v_mfma_f32_16x16x32_bf16 v[248:251], v[60:63], v[40:43], v[248:251]
    buffer_load_dwordx4 a[52:55], v14, s[36:39], s47 offen offset:3072 sc1
    v_mfma_f32_16x16x32_bf16 v[252:255], v[60:63], v[44:47], v[252:255]
    s_waitcnt lgkmcnt(6)
    v_mfma_f32_16x16x32_bf16 v[96:99], v[16:19], v[48:51], v[96:99]
    s_waitcnt lgkmcnt(5)
    s_mul_i32 s43, s40, 20480
    ds_read_b64_tr_b16 v[60:61], v10 offset:44032
    v_mfma_f32_16x16x32_bf16 v[100:103], v[20:23], v[48:51], v[100:103]
    s_waitcnt lgkmcnt(4)
    s_add_u32 s47, s47, 1024
    ds_read_b64_tr_b16 v[62:63], v10 offset:44544
    v_lshrrev_b32 v3, 4, v0
    v_mfma_f32_16x16x32_bf16 v[104:107], v[24:27], v[48:51], v[104:107]
    s_waitcnt lgkmcnt(4)
    buffer_load_dwordx4 a[56:59], v14, s[36:39], s47 offen offset:3072 sc1
    v_mfma_f32_16x16x32_bf16 v[108:111], v[28:31], v[48:51], v[108:111]
    v_and_b32 v5, 15, v0
    v_mfma_f32_16x16x32_bf16 v[112:115], v[16:19], v[52:55], v[112:115]
    ds_read_b64_tr_b16 v[48:49], v11 offset:41984
    v_lshlrev_b32 v88, 7, v3
    v_mfma_f32_16x16x32_bf16 v[116:119], v[20:23], v[52:55], v[116:119]
    s_mov_b32 s47, 15360
    ds_read_b64_tr_b16 v[50:51], v11 offset:42496
    v_add_u32 v88, s48, v88
    v_mfma_f32_16x16x32_bf16 v[120:123], v[24:27], v[52:55], v[120:123]
    buffer_load_dwordx4 a[60:63], v14, s[36:39], s47 offen offset:0 sc1
    v_mfma_f32_16x16x32_bf16 v[124:127], v[28:31], v[52:55], v[124:127]
    s_waitcnt lgkmcnt(4)
    v_lshl_add_u32 v89, v5, 2, s48
    v_mfma_f32_16x16x32_bf16 v[128:131], v[56:59], v[16:19], v[128:131]
    s_sub_u32 s56, 56, s49
    ds_read_b64_tr_b16 v[52:53], v11 offset:44032
    v_mfma_f32_16x16x32_bf16 v[132:135], v[56:59], v[20:23], v[132:135]
    s_lshl_b32 s56, s56, 7
    ds_read_b64_tr_b16 v[54:55], v11 offset:44544
    v_mfma_f32_16x16x32_bf16 v[136:139], v[56:59], v[24:27], v[136:139]
    buffer_load_dwordx4 a[64:67], v14, s[36:39], s47 offen offset:1024 sc1
    v_mfma_f32_16x16x32_bf16 v[140:143], v[56:59], v[28:31], v[140:143]
    s_waitcnt lgkmcnt(4)
    v_lshl_add_u32 v91, v5, 3, s56
    v_mfma_f32_16x16x32_bf16 v[144:147], v[60:63], v[16:19], v[144:147]
    ds_read_b64_tr_b16 v[56:57], v12 offset:41984
    v_lshlrev_b32 v4, 10, v3
    v_mfma_f32_16x16x32_bf16 v[148:151], v[60:63], v[20:23], v[148:151]
    ds_read_b64_tr_b16 v[58:59], v12 offset:42496
    v_sub_u32 v91, v91, v4
    v_mfma_f32_16x16x32_bf16 v[152:155], v[60:63], v[24:27], v[152:155]
    s_sub_u32 s83, s56, 3200
    buffer_load_dwordx4 a[68:71], v14, s[36:39], s47 offen offset:2048 sc1
    v_mfma_f32_16x16x32_bf16 v[156:159], v[60:63], v[28:31], v[156:159]
    s_waitcnt lgkmcnt(4)
    v_bfe_u32 v4, v0, 2, 2
    v_mfma_f32_16x16x32_bf16 v[160:163], v[48:51], v[16:19], v[160:163]
    ds_read_b64_tr_b16 v[60:61], v12 offset:44032
    v_xor_b32 v4, v4, v3
    v_mfma_f32_16x16x32_bf16 v[164:167], v[48:51], v[20:23], v[164:167]
    ds_read_b64_tr_b16 v[62:63], v12 offset:44544
    v_lshlrev_b32 v92, 5, v5
    v_mfma_f32_16x16x32_bf16 v[168:171], v[48:51], v[24:27], v[168:171]
    buffer_load_dwordx4 a[72:75], v14, s[36:39], s47 offen offset:3072 sc1
    v_mfma_f32_16x16x32_bf16 v[172:175], v[48:51], v[28:31], v[172:175]
    s_waitcnt lgkmcnt(4)
    v_lshl_add_u32 v92, v4, 3, v92
    v_mfma_f32_16x16x32_bf16 v[176:179], v[52:55], v[16:19], v[176:179]
    ds_read_b64_tr_b16 v[48:49], v13 offset:41984
    v_add_u32 v92, s43, v92
    v_mfma_f32_16x16x32_bf16 v[180:183], v[52:55], v[20:23], v[180:183]
    s_add_u32 s47, s47, 1024
    ds_read_b64_tr_b16 v[50:51], v13 offset:42496
    v_xor_b32 v93, v0, v3
    v_mfma_f32_16x16x32_bf16 v[184:187], v[52:55], v[24:27], v[184:187]
    buffer_load_dwordx4 a[76:79], v14, s[36:39], s47 offen offset:3072 sc1
    v_mfma_f32_16x16x32_bf16 v[188:191], v[52:55], v[28:31], v[188:191]
    s_waitcnt lgkmcnt(4)
    v_lshl_add_u32 v93, v93, 3, s43
    v_mfma_f32_16x16x32_bf16 v[192:195], v[56:59], v[16:19], v[192:195]
    ds_read_b64_tr_b16 v[52:53], v13 offset:44032
    v_and_b32 v2, 7, v0
    v_mfma_f32_16x16x32_bf16 v[196:199], v[56:59], v[20:23], v[196:199]
    s_mov_b32 s47, 20480
    ds_read_b64_tr_b16 v[54:55], v13 offset:44544
    v_lshl_add_u32 v2, v2, 2, s40
    v_mfma_f32_16x16x32_bf16 v[200:203], v[56:59], v[24:27], v[200:203]
    buffer_load_dwordx4 a[80:83], v14, s[36:39], s47 offen offset:0 sc1
    v_mfma_f32_16x16x32_bf16 v[204:207], v[56:59], v[28:31], v[204:207]
    s_waitcnt lgkmcnt(4)
    v_cmp_gt_u32 vcc, 27, v2
    v_mfma_f32_16x16x32_bf16 v[208:211], v[60:63], v[16:19], v[208:211]
    ds_read_b128 v[56:59], v9 offset:40960
    v_mov_b32 v1, s40
    v_mfma_f32_16x16x32_bf16 v[212:215], v[60:63], v[20:23], v[212:215]
    buffer_load_dwordx4 a[84:87], v14, s[36:39], s47 offen offset:1024 sc1
    v_mfma_f32_16x16x32_bf16 v[216:219], v[60:63], v[24:27], v[216:219]
    ds_read_b128 v[32:35], v7 offset:0
    v_and_b32 v4, 31, v0
    v_mfma_f32_16x16x32_bf16 v[220:223], v[60:63], v[28:31], v[220:223]
    s_waitcnt lgkmcnt(4)
    ds_read_b128 v[36:39], v7 offset:2048
    v_cndmask_b32 v1, v1, v2, vcc
    v_mfma_f32_16x16x32_bf16 v[224:227], v[48:51], v[16:19], v[224:227]
    ds_read_b128 v[60:63], v9 offset:51200
    v_cmp_gt_u32 vcc, 8, v4
    v_mfma_f32_16x16x32_bf16 v[228:231], v[48:51], v[20:23], v[228:231]
    buffer_load_dwordx4 a[88:91], v14, s[36:39], s47 offen offset:2048 sc1
    v_mfma_f32_16x16x32_bf16 v[232:235], v[48:51], v[24:27], v[232:235]
    ds_read_b128 v[40:43], v7 offset:4096
    v_min_u32 v4, 12, v4
    v_mfma_f32_16x16x32_bf16 v[236:239], v[48:51], v[28:31], v[236:239]
    s_waitcnt lgkmcnt(5)
    ds_read_b128 v[44:47], v7 offset:6144
    v_add_u32 v4, 19, v4
    v_mfma_f32_16x16x32_bf16 v[240:243], v[52:55], v[16:19], v[240:243]
    ds_read_b64_tr_b16 v[48:49], v10 offset:52224
    v_cndmask_b32 v2, v4, v2, vcc
    v_mfma_f32_16x16x32_bf16 v[244:247], v[52:55], v[20:23], v[244:247]
    ds_read_b64_tr_b16 v[50:51], v10 offset:52736
    v_and_or_b32 v2, v0, 32, v2
    v_mfma_f32_16x16x32_bf16 v[248:251], v[52:55], v[24:27], v[248:251]
    buffer_load_dwordx4 a[92:95], v14, s[36:39], s47 offen offset:3072 sc1
    v_mfma_f32_16x16x32_bf16 v[252:255], v[52:55], v[28:31], v[252:255]
    s_waitcnt lgkmcnt(6)
    v_lshlrev_b32 v2, 7, v2
    v_mfma_f32_16x16x32_bf16 v[96:99], v[32:35], v[56:59], v[96:99]
    s_waitcnt lgkmcnt(5)
    ds_read_b64_tr_b16 v[52:53], v10 offset:54272
    v_lshlrev_b32 v1, 7, v1
    v_mfma_f32_16x16x32_bf16 v[100:103], v[36:39], v[56:59], v[100:103]
    s_waitcnt lgkmcnt(4)
    s_add_u32 s47, s47, 1024
    ds_read_b64_tr_b16 v[54:55], v10 offset:54784
    v_mfma_f32_16x16x32_bf16 v[104:107], v[40:43], v[56:59], v[104:107]
    s_waitcnt lgkmcnt(4)
    s_andn2_b32 s58, s52, 1
    buffer_load_dwordx4 a[96:99], v14, s[36:39], s47 offen offset:3072 sc1
    v_mfma_f32_16x16x32_bf16 v[108:111], v[44:47], v[56:59], v[108:111]
    v_mfma_f32_16x16x32_bf16 v[112:115], v[32:35], v[60:63], v[112:115]
    s_lshl_b32 s58, s58, 12
    ds_read_b64_tr_b16 v[56:57], v11 offset:52224
    v_mfma_f32_16x16x32_bf16 v[116:119], v[36:39], v[60:63], v[116:119]
    s_mov_b32 s47, 25600
    ds_read_b64_tr_b16 v[58:59], v11 offset:52736
    v_mfma_f32_16x16x32_bf16 v[120:123], v[40:43], v[60:63], v[120:123]
    s_add_u32 s44, s58, 393216
    buffer_load_dwordx4 a[100:103], v14, s[36:39], s47 offen offset:0 sc1
    v_mfma_f32_16x16x32_bf16 v[124:127], v[44:47], v[60:63], v[124:127]
    s_waitcnt lgkmcnt(4)
    v_mfma_f32_16x16x32_bf16 v[128:131], v[48:51], v[32:35], v[128:131]
    s_xor_b32 s58, s52, 1
    ds_read_b64_tr_b16 v[60:61], v11 offset:54272
    v_mfma_f32_16x16x32_bf16 v[132:135], v[48:51], v[36:39], v[132:135]
    s_lshl_b32 s58, s58, 12
    ds_read_b64_tr_b16 v[62:63], v11 offset:54784
    v_mfma_f32_16x16x32_bf16 v[136:139], v[48:51], v[40:43], v[136:139]
    s_add_u32 s100, s58, 262144
    buffer_load_dwordx4 a[104:107], v14, s[36:39], s47 offen offset:1024 sc1
    v_mfma_f32_16x16x32_bf16 v[140:143], v[48:51], v[44:47], v[140:143]
    s_waitcnt lgkmcnt(4)
    v_mfma_f32_16x16x32_bf16 v[144:147], v[52:55], v[32:35], v[144:147]
    s_andn2_b32 s56, 1, s40
    ds_read_b64_tr_b16 v[48:49], v12 offset:52224
    v_mfma_f32_16x16x32_bf16 v[148:151], v[52:55], v[36:39], v[148:151]
    s_lshl_b32 s56, s56, 7
    ds_read_b64_tr_b16 v[50:51], v12 offset:52736
    v_mfma_f32_16x16x32_bf16 v[152:155], v[52:55], v[40:43], v[152:155]
    buffer_load_dwordx4 a[108:111], v14, s[36:39], s47 offen offset:2048 sc1
    v_mfma_f32_16x16x32_bf16 v[156:159], v[52:55], v[44:47], v[156:159]
    s_waitcnt lgkmcnt(4)
    v_lshl_add_u32 v90, v3, 4, s48
    v_mfma_f32_16x16x32_bf16 v[160:163], v[56:59], v[32:35], v[160:163]
    ds_read_b64_tr_b16 v[52:53], v12 offset:54272
    v_xor_b32 v90, s56, v90
    v_mfma_f32_16x16x32_bf16 v[164:167], v[56:59], v[36:39], v[164:167]
    s_and_b32 s56, s42, 3
    ds_read_b64_tr_b16 v[54:55], v12 offset:54784
    v_mfma_f32_16x16x32_bf16 v[168:171], v[56:59], v[40:43], v[168:171]
    s_lshl2_add_u32 s56, s49, s56
    buffer_load_dwordx4 a[112:115], v14, s[36:39], s47 offen offset:3072 sc1
    v_mfma_f32_16x16x32_bf16 v[172:175], v[56:59], v[44:47], v[172:175]
    s_waitcnt lgkmcnt(4)
    v_mfma_f32_16x16x32_bf16 v[176:179], v[60:63], v[32:35], v[176:179]
    s_mul_i32 s56, s56, 24
    ds_read_b64_tr_b16 v[56:57], v13 offset:52224
    v_mfma_f32_16x16x32_bf16 v[180:183], v[60:63], v[36:39], v[180:183]
    s_add_u32 s47, s47, 1024
    ds_read_b64_tr_b16 v[58:59], v13 offset:52736
    v_mfma_f32_16x16x32_bf16 v[184:187], v[60:63], v[40:43], v[184:187]
    s_lshr_b32 s57, s42, 2
    buffer_load_dwordx4 a[116:119], v14, s[36:39], s47 offen offset:3072 sc1
    v_mfma_f32_16x16x32_bf16 v[188:191], v[60:63], v[44:47], v[188:191]
    s_waitcnt lgkmcnt(4)
    v_mfma_f32_16x16x32_bf16 v[192:195], v[48:51], v[32:35], v[192:195]
    s_add_u32 s56, s56, s57
    ds_read_b64_tr_b16 v[60:61], v13 offset:54272
    v_mfma_f32_16x16x32_bf16 v[196:199], v[48:51], v[36:39], v[196:199]
    s_add_u32 s47, s54, 30720
    ds_read_b64_tr_b16 v[62:63], v13 offset:54784
    v_mfma_f32_16x16x32_bf16 v[200:203], v[48:51], v[40:43], v[200:203]
    s_lshl_b32 s56, s56, 12
    buffer_load_dwordx4 a[120:123], v14, s[36:39], s47 offen offset:0 sc1
    v_mfma_f32_16x16x32_bf16 v[204:207], v[48:51], v[44:47], v[204:207]
    s_waitcnt lgkmcnt(4)
    s_waitcnt vmcnt(20)
    s_barrier
    v_mfma_f32_16x16x32_bf16 v[208:211], v[52:55], v[32:35], v[208:211]
    s_add_u32 s56, s56, 5242880
    ds_read_b128 v[48:51], v8 offset:0
    v_mfma_f32_16x16x32_bf16 v[212:215], v[52:55], v[36:39], v[212:215]
    s_add_u32 s57, s56, 49152
    buffer_load_dwordx4 a[124:127], v14, s[36:39], s47 offen offset:1024 sc1
    v_mfma_f32_16x16x32_bf16 v[216:219], v[52:55], v[40:43], v[216:219]
    s_bitcmp1_b32 s40, 0
    s_cselect_b32 s45, s56, s57
    s_cselect_b32 s46, s57, s56
    ds_read_b128 v[16:19], v6 offset:8192
    v_mfma_f32_16x16x32_bf16 v[220:223], v[52:55], v[44:47], v[220:223]
    s_waitcnt lgkmcnt(4)
    ds_read_b128 v[20:23], v6 offset:10240
    v_mfma_f32_16x16x32_bf16 v[224:227], v[56:59], v[32:35], v[224:227]
    s_add_u32 s56, s50, 0
    ds_read_b128 v[52:55], v8 offset:10240
    v_mfma_f32_16x16x32_bf16 v[228:231], v[56:59], v[36:39], v[228:231]
    s_and_b32 s57, s56, 3
    buffer_load_dwordx4 a[128:131], v14, s[36:39], s47 offen offset:2048 sc1
    v_mfma_f32_16x16x32_bf16 v[232:235], v[56:59], v[40:43], v[232:235]
    s_lshl2_add_u32 s57, s49, s57
    ds_read_b128 v[24:27], v6 offset:12288
    v_mfma_f32_16x16x32_bf16 v[236:239], v[56:59], v[44:47], v[236:239]
    s_waitcnt lgkmcnt(5)
    ds_read_b128 v[28:31], v6 offset:14336
    v_mfma_f32_16x16x32_bf16 v[240:243], v[60:63], v[32:35], v[240:243]
    s_mul_i32 s57, s57, 24
    ds_read_b64_tr_b16 v[56:57], v10 offset:1024
    v_mfma_f32_16x16x32_bf16 v[244:247], v[60:63], v[36:39], v[244:247]
    s_lshr_b32 s58, s56, 3
    ds_read_b64_tr_b16 v[58:59], v10 offset:1536
    v_mfma_f32_16x16x32_bf16 v[248:251], v[60:63], v[40:43], v[248:251]
    s_add_u32 s57, s58, s57
    buffer_load_dwordx4 a[132:135], v14, s[36:39], s47 offen offset:3072 sc1
    v_mfma_f32_16x16x32_bf16 v[252:255], v[60:63], v[44:47], v[252:255]
    s_waitcnt lgkmcnt(6)
    v_mfma_f32_16x16x32_bf16 v[96:99], v[16:19], v[48:51], v[96:99]
    s_waitcnt lgkmcnt(5)
    s_bfe_u32 s58, s56, 0x10002
    ds_read_b64_tr_b16 v[60:61], v10 offset:3072
    v_mfma_f32_16x16x32_bf16 v[100:103], v[20:23], v[48:51], v[100:103]
    s_waitcnt lgkmcnt(4)
    s_add_u32 s47, s47, 1024
    ds_read_b64_tr_b16 v[62:63], v10 offset:3584
    v_mfma_f32_16x16x32_bf16 v[104:107], v[24:27], v[48:51], v[104:107]
    s_waitcnt lgkmcnt(4)
    s_mul_i32 s58, s58, 12
    buffer_load_dwordx4 a[136:139], v14, s[36:39], s47 offen offset:3072 sc1
    v_mfma_f32_16x16x32_bf16 v[108:111], v[28:31], v[48:51], v[108:111]
    v_mfma_f32_16x16x32_bf16 v[112:115], v[16:19], v[52:55], v[112:115]
    s_add_u32 s57, s58, s57
    ds_read_b64_tr_b16 v[48:49], v11 offset:1024
    v_mfma_f32_16x16x32_bf16 v[116:119], v[20:23], v[52:55], v[116:119]
    s_mov_b32 s47, 35840
    ds_read_b64_tr_b16 v[50:51], v11 offset:1536
    v_mfma_f32_16x16x32_bf16 v[120:123], v[24:27], v[52:55], v[120:123]
    s_lshl_b32 s57, s57, 12
    buffer_load_dwordx4 a[140:143], v14, s[36:39], s47 offen offset:0 sc1
    v_mfma_f32_16x16x32_bf16 v[124:127], v[28:31], v[52:55], v[124:127]
    s_waitcnt lgkmcnt(4)
    v_mfma_f32_16x16x32_bf16 v[128:131], v[56:59], v[16:19], v[128:131]
    s_add_u32 s82, s57, 5271552
    ds_read_b64_tr_b16 v[52:53], v11 offset:3072
    v_mfma_f32_16x16x32_bf16 v[132:135], v[56:59], v[20:23], v[132:135]
    s_lshl_b32 s56, s50, 12
    ds_read_b64_tr_b16 v[54:55], v11 offset:3584
    v_mfma_f32_16x16x32_bf16 v[136:139], v[56:59], v[24:27], v[136:139]
    s_add_u32 s56, s56, 65536
    buffer_load_dwordx4 a[144:147], v14, s[36:39], s47 offen offset:1024 sc1
    v_mfma_f32_16x16x32_bf16 v[140:143], v[56:59], v[28:31], v[140:143]
    s_waitcnt lgkmcnt(4)
    v_mfma_f32_16x16x32_bf16 v[144:147], v[60:63], v[16:19], v[144:147]
    s_add_u32 s24, s94, s56
    s_addc_u32 s25, s95, 0
    ds_read_b64_tr_b16 v[56:57], v12 offset:1024
    v_mfma_f32_16x16x32_bf16 v[148:151], v[60:63], v[20:23], v[148:151]
    s_mov_b32 s26, 4096
    ds_read_b64_tr_b16 v[58:59], v12 offset:1536
    v_mfma_f32_16x16x32_bf16 v[152:155], v[60:63], v[24:27], v[152:155]
    s_mov_b32 s27, 0x20000
    buffer_load_dwordx4 a[148:151], v14, s[36:39], s47 offen offset:2048 sc1
    v_mfma_f32_16x16x32_bf16 v[156:159], v[60:63], v[28:31], v[156:159]
    s_waitcnt lgkmcnt(4)
    v_mfma_f32_16x16x32_bf16 v[160:163], v[48:51], v[16:19], v[160:163]
    ds_read_b64_tr_b16 v[60:61], v12 offset:3072
    v_mfma_f32_16x16x32_bf16 v[164:167], v[48:51], v[20:23], v[164:167]
    ds_read_b64_tr_b16 v[62:63], v12 offset:3584
    v_mfma_f32_16x16x32_bf16 v[168:171], v[48:51], v[24:27], v[168:171]
    buffer_load_dwordx4 a[152:155], v14, s[36:39], s47 offen offset:3072 sc1
    v_mfma_f32_16x16x32_bf16 v[172:175], v[48:51], v[28:31], v[172:175]
    s_waitcnt lgkmcnt(4)
    v_mfma_f32_16x16x32_bf16 v[176:179], v[52:55], v[16:19], v[176:179]
    ds_read_b64_tr_b16 v[48:49], v13 offset:1024
    v_mfma_f32_16x16x32_bf16 v[180:183], v[52:55], v[20:23], v[180:183]
    s_add_u32 s47, s47, 1024
    ds_read_b64_tr_b16 v[50:51], v13 offset:1536
    v_mfma_f32_16x16x32_bf16 v[184:187], v[52:55], v[24:27], v[184:187]
    buffer_load_dwordx4 a[156:159], v14, s[36:39], s47 offen offset:3072 sc1
    v_mfma_f32_16x16x32_bf16 v[188:191], v[52:55], v[28:31], v[188:191]
    s_waitcnt lgkmcnt(4)
    v_mfma_f32_16x16x32_bf16 v[192:195], v[56:59], v[16:19], v[192:195]
    ds_read_b64_tr_b16 v[52:53], v13 offset:3072
    v_mfma_f32_16x16x32_bf16 v[196:199], v[56:59], v[20:23], v[196:199]
    s_mov_b32 s47, 40960
    ds_read_b64_tr_b16 v[54:55], v13 offset:3584
    v_mfma_f32_16x16x32_bf16 v[200:203], v[56:59], v[24:27], v[200:203]
    buffer_load_dwordx4 a[160:163], v14, s[36:39], s47 offen offset:0 sc1
    v_mfma_f32_16x16x32_bf16 v[204:207], v[56:59], v[28:31], v[204:207]
    s_waitcnt lgkmcnt(4)
    v_mfma_f32_16x16x32_bf16 v[208:211], v[60:63], v[16:19], v[208:211]
    ds_read_b128 v[56:59], v9 offset:0
    v_mfma_f32_16x16x32_bf16 v[212:215], v[60:63], v[20:23], v[212:215]
    buffer_load_dwordx4 a[164:167], v14, s[36:39], s47 offen offset:1024 sc1
    v_mfma_f32_16x16x32_bf16 v[216:219], v[60:63], v[24:27], v[216:219]
    ds_read_b128 v[32:35], v7 offset:8192
    v_mfma_f32_16x16x32_bf16 v[220:223], v[60:63], v[28:31], v[220:223]
    s_waitcnt lgkmcnt(4)
    ds_read_b128 v[36:39], v7 offset:10240
    v_mfma_f32_16x16x32_bf16 v[224:227], v[48:51], v[16:19], v[224:227]
    ds_read_b128 v[60:63], v9 offset:10240
    v_mfma_f32_16x16x32_bf16 v[228:231], v[48:51], v[20:23], v[228:231]
    buffer_load_dwordx4 a[168:171], v14, s[36:39], s47 offen offset:2048 sc1
    v_mfma_f32_16x16x32_bf16 v[232:235], v[48:51], v[24:27], v[232:235]
    ds_read_b128 v[40:43], v7 offset:12288
    v_mfma_f32_16x16x32_bf16 v[236:239], v[48:51], v[28:31], v[236:239]
    s_waitcnt lgkmcnt(5)
    ds_read_b128 v[44:47], v7 offset:14336
    v_mfma_f32_16x16x32_bf16 v[240:243], v[52:55], v[16:19], v[240:243]
    ds_read_b64_tr_b16 v[48:49], v10 offset:11264
    v_mfma_f32_16x16x32_bf16 v[244:247], v[52:55], v[20:23], v[244:247]
    ds_read_b64_tr_b16 v[50:51], v10 offset:11776
    v_mfma_f32_16x16x32_bf16 v[248:251], v[52:55], v[24:27], v[248:251]
    buffer_load_dwordx4 a[172:175], v14, s[36:39], s47 offen offset:3072 sc1
    v_mfma_f32_16x16x32_bf16 v[252:255], v[52:55], v[28:31], v[252:255]
    s_waitcnt lgkmcnt(6)
    v_mfma_f32_16x16x32_bf16 v[96:99], v[32:35], v[56:59], v[96:99]
    s_waitcnt lgkmcnt(5)
    ds_read_b64_tr_b16 v[52:53], v10 offset:13312
    v_mfma_f32_16x16x32_bf16 v[100:103], v[36:39], v[56:59], v[100:103]
    s_waitcnt lgkmcnt(4)
    s_add_u32 s47, s47, 1024
    ds_read_b64_tr_b16 v[54:55], v10 offset:13824
    v_mfma_f32_16x16x32_bf16 v[104:107], v[40:43], v[56:59], v[104:107]
    s_waitcnt lgkmcnt(4)
    buffer_load_dwordx4 a[176:179], v14, s[36:39], s47 offen offset:3072 sc1
    v_mfma_f32_16x16x32_bf16 v[108:111], v[44:47], v[56:59], v[108:111]
    v_mfma_f32_16x16x32_bf16 v[112:115], v[32:35], v[60:63], v[112:115]
    ds_read_b64_tr_b16 v[56:57], v11 offset:11264
    v_mfma_f32_16x16x32_bf16 v[116:119], v[36:39], v[60:63], v[116:119]
    s_mov_b32 s47, 46080
    ds_read_b64_tr_b16 v[58:59], v11 offset:11776
    v_mfma_f32_16x16x32_bf16 v[120:123], v[40:43], v[60:63], v[120:123]
    buffer_load_dwordx4 a[180:183], v14, s[36:39], s47 offen offset:0 sc1
    v_mfma_f32_16x16x32_bf16 v[124:127], v[44:47], v[60:63], v[124:127]
    s_waitcnt lgkmcnt(4)
    v_mfma_f32_16x16x32_bf16 v[128:131], v[48:51], v[32:35], v[128:131]
    ds_read_b64_tr_b16 v[60:61], v11 offset:13312
    v_mfma_f32_16x16x32_bf16 v[132:135], v[48:51], v[36:39], v[132:135]
    ds_read_b64_tr_b16 v[62:63], v11 offset:13824
    v_mfma_f32_16x16x32_bf16 v[136:139], v[48:51], v[40:43], v[136:139]
    buffer_load_dwordx4 a[184:187], v14, s[36:39], s47 offen offset:1024 sc1
    v_mfma_f32_16x16x32_bf16 v[140:143], v[48:51], v[44:47], v[140:143]
    s_waitcnt lgkmcnt(4)
    v_mfma_f32_16x16x32_bf16 v[144:147], v[52:55], v[32:35], v[144:147]
    ds_read_b64_tr_b16 v[48:49], v12 offset:11264
    v_mfma_f32_16x16x32_bf16 v[148:151], v[52:55], v[36:39], v[148:151]
    ds_read_b64_tr_b16 v[50:51], v12 offset:11776
    v_mfma_f32_16x16x32_bf16 v[152:155], v[52:55], v[40:43], v[152:155]
    buffer_load_dwordx4 a[188:191], v14, s[36:39], s47 offen offset:2048 sc1
    v_mfma_f32_16x16x32_bf16 v[156:159], v[52:55], v[44:47], v[156:159]
    s_waitcnt lgkmcnt(4)
    v_mfma_f32_16x16x32_bf16 v[160:163], v[56:59], v[32:35], v[160:163]
    ds_read_b64_tr_b16 v[52:53], v12 offset:13312
    v_mfma_f32_16x16x32_bf16 v[164:167], v[56:59], v[36:39], v[164:167]
    ds_read_b64_tr_b16 v[54:55], v12 offset:13824
    v_mfma_f32_16x16x32_bf16 v[168:171], v[56:59], v[40:43], v[168:171]
    buffer_load_dwordx4 a[192:195], v14, s[36:39], s47 offen offset:3072 sc1
    v_mfma_f32_16x16x32_bf16 v[172:175], v[56:59], v[44:47], v[172:175]
    s_waitcnt lgkmcnt(4)
    v_mfma_f32_16x16x32_bf16 v[176:179], v[60:63], v[32:35], v[176:179]
    ds_read_b64_tr_b16 v[56:57], v13 offset:11264
    v_mfma_f32_16x16x32_bf16 v[180:183], v[60:63], v[36:39], v[180:183]
    s_add_u32 s47, s47, 1024
    ds_read_b64_tr_b16 v[58:59], v13 offset:11776
    v_mfma_f32_16x16x32_bf16 v[184:187], v[60:63], v[40:43], v[184:187]
    buffer_load_dwordx4 a[196:199], v14, s[36:39], s47 offen offset:3072 sc1
    v_mfma_f32_16x16x32_bf16 v[188:191], v[60:63], v[44:47], v[188:191]
    s_waitcnt lgkmcnt(4)
    v_mfma_f32_16x16x32_bf16 v[192:195], v[48:51], v[32:35], v[192:195]
    ds_read_b64_tr_b16 v[60:61], v13 offset:13312
    v_mfma_f32_16x16x32_bf16 v[196:199], v[48:51], v[36:39], v[196:199]
    s_mov_b32 s47, 51200
    ds_read_b64_tr_b16 v[62:63], v13 offset:13824
    v_mfma_f32_16x16x32_bf16 v[200:203], v[48:51], v[40:43], v[200:203]
    buffer_load_dwordx4 a[200:203], v14, s[36:39], s47 offen offset:0 sc1
    v_mfma_f32_16x16x32_bf16 v[204:207], v[48:51], v[44:47], v[204:207]
    s_waitcnt lgkmcnt(4)
    v_mfma_f32_16x16x32_bf16 v[208:211], v[52:55], v[32:35], v[208:211]
    v_mfma_f32_16x16x32_bf16 v[212:215], v[52:55], v[36:39], v[212:215]
    buffer_load_dwordx4 a[204:207], v14, s[36:39], s47 offen offset:1024 sc1
    v_mfma_f32_16x16x32_bf16 v[216:219], v[52:55], v[40:43], v[216:219]
    v_mfma_f32_16x16x32_bf16 v[220:223], v[52:55], v[44:47], v[220:223]
    s_waitcnt lgkmcnt(2)
    v_mfma_f32_16x16x32_bf16 v[224:227], v[56:59], v[32:35], v[224:227]
    v_mfma_f32_16x16x32_bf16 v[228:231], v[56:59], v[36:39], v[228:231]
    buffer_load_dwordx4 a[208:211], v14, s[36:39], s47 offen offset:2048 sc1
    v_mfma_f32_16x16x32_bf16 v[232:235], v[56:59], v[40:43], v[232:235]
    v_mfma_f32_16x16x32_bf16 v[236:239], v[56:59], v[44:47], v[236:239]
    s_waitcnt lgkmcnt(0)
    v_mfma_f32_16x16x32_bf16 v[240:243], v[60:63], v[32:35], v[240:243]
    v_mfma_f32_16x16x32_bf16 v[244:247], v[60:63], v[36:39], v[244:247]
    v_mfma_f32_16x16x32_bf16 v[248:251], v[60:63], v[40:43], v[248:251]
    buffer_load_dwordx4 a[212:215], v14, s[36:39], s47 offen offset:3072 sc1
    v_mfma_f32_16x16x32_bf16 v[252:255], v[60:63], v[44:47], v[252:255]
L_epi:
    s_barrier
    ds_read_b128 v[48:51], v88 offset:4096
    ds_read_b128 v[52:55], v88 offset:4112
    ds_read_b128 v[56:59], v88 offset:4128
    ds_read_b128 v[60:63], v88 offset:4144
    ds_read_b32 v6, v89 offset:4608
    ds_read_b32 v7, v89 offset:4672
    v_pk_mul_f32 v[16:17], v[66:67], v[96:97] op_sel:[0,0] op_sel_hi:[1,0]
    v_pk_mul_f32 v[18:19], v[66:67], v[96:97] op_sel:[0,1] op_sel_hi:[1,1]
    v_pk_mul_f32 v[20:21], v[66:67], v[98:99] op_sel:[0,0] op_sel_hi:[1,0]
    v_pk_mul_f32 v[22:23], v[66:67], v[98:99] op_sel:[0,1] op_sel_hi:[1,1]
    v_pk_fma_f32 v[16:17], v[66:67], v[112:113], v[16:17] op_sel:[1,0,0] op_sel_hi:[0,0,1] neg_lo:[1,0,0]
    v_pk_fma_f32 v[18:19], v[66:67], v[112:113], v[18:19] op_sel:[1,1,0] op_sel_hi:[0,1,1] neg_lo:[1,0,0]
    v_pk_fma_f32 v[20:21], v[66:67], v[114:115], v[20:21] op_sel:[1,0,0] op_sel_hi:[0,0,1] neg_lo:[1,0,0]
    v_pk_fma_f32 v[22:23], v[66:67], v[114:115], v[22:23] op_sel:[1,1,0] op_sel_hi:[0,1,1] neg_lo:[1,0,0]
    v_pk_mul_f32 v[24:25], v[66:67], v[100:101] op_sel:[0,0] op_sel_hi:[1,0]
    v_pk_mul_f32 v[26:27], v[66:67], v[100:101] op_sel:[0,1] op_sel_hi:[1,1]
    v_pk_mul_f32 v[28:29], v[66:67], v[102:103] op_sel:[0,0] op_sel_hi:[1,0]
    v_pk_mul_f32 v[30:31], v[66:67], v[102:103] op_sel:[0,1] op_sel_hi:[1,1]
    v_pk_fma_f32 v[24:25], v[66:67], v[116:117], v[24:25] op_sel:[1,0,0] op_sel_hi:[0,0,1] neg_lo:[1,0,0]
    v_pk_fma_f32 v[26:27], v[66:67], v[116:117], v[26:27] op_sel:[1,1,0] op_sel_hi:[0,1,1] neg_lo:[1,0,0]
    v_pk_fma_f32 v[28:29], v[66:67], v[118:119], v[28:29] op_sel:[1,0,0] op_sel_hi:[0,0,1] neg_lo:[1,0,0]
    v_pk_fma_f32 v[30:31], v[66:67], v[118:119], v[30:31] op_sel:[1,1,0] op_sel_hi:[0,1,1] neg_lo:[1,0,0]
    s_add_u32 s47, s47, 1024
    buffer_load_dwordx4 a[216:219], v14, s[36:39], s47 offen offset:3072 sc1
    v_pk_mul_f32 v[32:33], v[66:67], v[104:105] op_sel:[0,0] op_sel_hi:[1,0]
    v_pk_mul_f32 v[34:35], v[66:67], v[104:105] op_sel:[0,1] op_sel_hi:[1,1]
    v_pk_mul_f32 v[36:37], v[66:67], v[106:107] op_sel:[0,0] op_sel_hi:[1,0]
    v_pk_mul_f32 v[38:39], v[66:67], v[106:107] op_sel:[0,1] op_sel_hi:[1,1]
    v_pk_fma_f32 v[32:33], v[66:67], v[120:121], v[32:33] op_sel:[1,0,0] op_sel_hi:[0,0,1] neg_lo:[1,0,0]
    v_pk_fma_f32 v[34:35], v[66:67], v[120:121], v[34:35] op_sel:[1,1,0] op_sel_hi:[0,1,1] neg_lo:[1,0,0]
    v_pk_fma_f32 v[36:37], v[66:67], v[122:123], v[36:37] op_sel:[1,0,0] op_sel_hi:[0,0,1] neg_lo:[1,0,0]
    v_pk_fma_f32 v[38:39], v[66:67], v[122:123], v[38:39] op_sel:[1,1,0] op_sel_hi:[0,1,1] neg_lo:[1,0,0]
    v_pk_mul_f32 v[40:41], v[66:67], v[108:109] op_sel:[0,0] op_sel_hi:[1,0]
    v_pk_mul_f32 v[42:43], v[66:67], v[108:109] op_sel:[0,1] op_sel_hi:[1,1]
    v_pk_mul_f32 v[44:45], v[66:67], v[110:111] op_sel:[0,0] op_sel_hi:[1,0]
    v_pk_mul_f32 v[46:47], v[66:67], v[110:111] op_sel:[0,1] op_sel_hi:[1,1]
    v_pk_fma_f32 v[40:41], v[66:67], v[124:125], v[40:41] op_sel:[1,0,0] op_sel_hi:[0,0,1] neg_lo:[1,0,0]
    v_pk_fma_f32 v[42:43], v[66:67], v[124:125], v[42:43] op_sel:[1,1,0] op_sel_hi:[0,1,1] neg_lo:[1,0,0]
    v_pk_fma_f32 v[44:45], v[66:67], v[126:127], v[44:45] op_sel:[1,0,0] op_sel_hi:[0,0,1] neg_lo:[1,0,0]
    v_pk_fma_f32 v[46:47], v[66:67], v[126:127], v[46:47] op_sel:[1,1,0] op_sel_hi:[0,1,1] neg_lo:[1,0,0]
    s_waitcnt lgkmcnt(0)
    ds_read_b128 v[96:99], v88 offset:4160
    ds_read_b128 v[100:103], v88 offset:4176
    ds_read_b128 v[104:107], v88 offset:4192
L_st_4:
    s_cbranch_execz L_st_5
    ds_read_b128 v[108:111], v88 offset:4208
    ds_read_b128 v[112:115], v90 offset:5120
    ds_read_b128 v[116:119], v90 offset:5376
    ds_read_b128 v[120:123], v90 offset:5184
    ds_read_b128 v[124:127], v90 offset:5440
    v_pk_mul_f32 v[8:9], v[6:7], v[66:67] op_sel_hi:[1,0]
    v_pk_fma_f32 v[8:9], v[6:7], v[66:67], v[8:9] op_sel:[1,1,0] op_sel_hi:[0,1,1] neg_lo:[1,0,0]
    s_mov_b32 s47, 56320
    buffer_load_dwordx4 a[220:223], v14, s[36:39], s47 offen offset:0 sc1
    v_pk_fma_f32 v[16:17], v[8:9], v[48:49], v[16:17] op_sel_hi:[1,0,1]
    v_pk_fma_f32 v[18:19], v[8:9], v[50:51], v[18:19] op_sel_hi:[1,0,1]
    v_pk_fma_f32 v[20:21], v[8:9], v[52:53], v[20:21] op_sel_hi:[1,0,1]
    v_pk_fma_f32 v[22:23], v[8:9], v[54:55], v[22:23] op_sel_hi:[1,0,1]
    v_pk_mul_f32 v[16:17], v[16:17], v[48:49] op_sel:[0,1] op_sel_hi:[1,1]
    v_pk_mul_f32 v[18:19], v[18:19], v[50:51] op_sel:[0,1] op_sel_hi:[1,1]
    v_pk_mul_f32 v[20:21], v[20:21], v[52:53] op_sel:[0,1] op_sel_hi:[1,1]
    v_pk_mul_f32 v[22:23], v[22:23], v[54:55] op_sel:[0,1] op_sel_hi:[1,1]
    v_pk_fma_f32 v[24:25], v[8:9], v[56:57], v[24:25] op_sel_hi:[1,0,1]
    v_pk_fma_f32 v[26:27], v[8:9], v[58:59], v[26:27] op_sel_hi:[1,0,1]
    v_pk_fma_f32 v[28:29], v[8:9], v[60:61], v[28:29] op_sel_hi:[1,0,1]
    v_pk_fma_f32 v[30:31], v[8:9], v[62:63], v[30:31] op_sel_hi:[1,0,1]
    v_pk_mul_f32 v[24:25], v[24:25], v[56:57] op_sel:[0,1] op_sel_hi:[1,1]
    v_pk_mul_f32 v[26:27], v[26:27], v[58:59] op_sel:[0,1] op_sel_hi:[1,1]
    v_pk_mul_f32 v[28:29], v[28:29], v[60:61] op_sel:[0,1] op_sel_hi:[1,1]
    v_pk_mul_f32 v[30:31], v[30:31], v[62:63] op_sel:[0,1] op_sel_hi:[1,1]
    s_waitcnt lgkmcnt(6)
    v_pk_fma_f32 v[32:33], v[8:9], v[96:97], v[32:33] op_sel_hi:[1,0,1]
    v_pk_fma_f32 v[34:35], v[8:9], v[98:99], v[34:35] op_sel_hi:[1,0,1]
    v_pk_fma_f32 v[36:37], v[8:9], v[100:101], v[36:37] op_sel_hi:[1,0,1]
    v_pk_fma_f32 v[38:39], v[8:9], v[102:103], v[38:39] op_sel_hi:[1,0,1]
    v_pk_mul_f32 v[32:33], v[32:33], v[96:97] op_sel:[0,1] op_sel_hi:[1,1]
    v_pk_mul_f32 v[34:35], v[34:35], v[98:99] op_sel:[0,1] op_sel_hi:[1,1]
    v_pk_mul_f32 v[36:37], v[36:37], v[100:101] op_sel:[0,1] op_sel_hi:[1,1]
    v_pk_mul_f32 v[38:39], v[38:39], v[102:103] op_sel:[0,1] op_sel_hi:[1,1]
    buffer_load_dwordx4 a[224:227], v14, s[36:39], s47 offen offset:1024 sc1
    s_waitcnt lgkmcnt(4)
    v_pk_fma_f32 v[40:41], v[8:9], v[104:105], v[40:41] op_sel_hi:[1,0,1]
    v_pk_fma_f32 v[42:43], v[8:9], v[106:107], v[42:43] op_sel_hi:[1,0,1]
    v_pk_fma_f32 v[44:45], v[8:9], v[108:109], v[44:45] op_sel_hi:[1,0,1]
    v_pk_fma_f32 v[46:47], v[8:9], v[110:111], v[46:47] op_sel_hi:[1,0,1]
    v_pk_mul_f32 v[40:41], v[40:41], v[104:105] op_sel:[0,1] op_sel_hi:[1,1]
    v_pk_mul_f32 v[42:43], v[42:43], v[106:107] op_sel:[0,1] op_sel_hi:[1,1]
    v_pk_mul_f32 v[44:45], v[44:45], v[108:109] op_sel:[0,1] op_sel_hi:[1,1]
    v_pk_mul_f32 v[46:47], v[46:47], v[110:111] op_sel:[0,1] op_sel_hi:[1,1]
    v_pk_fma_f32 v[8:9], v[16:17], v[64:65], v[18:19] op_sel:[1,1,0] op_sel_hi:[0,1,1] neg_lo:[1,0,0]
    v_pk_fma_f32 v[8:9], v[16:17], v[64:65], v[8:9] op_sel_hi:[1,0,1]
    v_pk_fma_f32 v[6:7], v[8:9], v[64:65], v[20:21] op_sel:[1,1,0] op_sel_hi:[0,1,1] neg_lo:[1,0,0]
    v_pk_fma_f32 v[6:7], v[8:9], v[64:65], v[6:7] op_sel_hi:[1,0,1]
    v_pk_fma_f32 v[8:9], v[6:7], v[64:65], v[22:23] op_sel:[1,1,0] op_sel_hi:[0,1,1] neg_lo:[1,0,0]
    v_pk_fma_f32 v[8:9], v[6:7], v[64:65], v[8:9] op_sel_hi:[1,0,1]
    v_pk_fma_f32 v[6:7], v[8:9], v[64:65], v[24:25] op_sel:[1,1,0] op_sel_hi:[0,1,1] neg_lo:[1,0,0]
    v_pk_fma_f32 v[6:7], v[8:9], v[64:65], v[6:7] op_sel_hi:[1,0,1]
    v_pk_fma_f32 v[8:9], v[6:7], v[64:65], v[26:27] op_sel:[1,1,0] op_sel_hi:[0,1,1] neg_lo:[1,0,0]
    v_pk_fma_f32 v[8:9], v[6:7], v[64:65], v[8:9] op_sel_hi:[1,0,1]
    buffer_load_dwordx4 a[228:231], v14, s[36:39], s47 offen offset:2048 sc1
    v_pk_fma_f32 v[6:7], v[8:9], v[64:65], v[28:29] op_sel:[1,1,0] op_sel_hi:[0,1,1] neg_lo:[1,0,0]
    v_pk_fma_f32 v[6:7], v[8:9], v[64:65], v[6:7] op_sel_hi:[1,0,1]
    v_pk_fma_f32 v[8:9], v[6:7], v[64:65], v[30:31] op_sel:[1,1,0] op_sel_hi:[0,1,1] neg_lo:[1,0,0]
    v_pk_fma_f32 v[8:9], v[6:7], v[64:65], v[8:9] op_sel_hi:[1,0,1]
    v_pk_fma_f32 v[6:7], v[8:9], v[64:65], v[32:33] op_sel:[1,1,0] op_sel_hi:[0,1,1] neg_lo:[1,0,0]
    v_pk_fma_f32 v[6:7], v[8:9], v[64:65], v[6:7] op_sel_hi:[1,0,1]
    v_pk_fma_f32 v[8:9], v[6:7], v[64:65], v[34:35] op_sel:[1,1,0] op_sel_hi:[0,1,1] neg_lo:[1,0,0]
    v_pk_fma_f32 v[8:9], v[6:7], v[64:65], v[8:9] op_sel_hi:[1,0,1]
    v_pk_fma_f32 v[6:7], v[8:9], v[64:65], v[36:37] op_sel:[1,1,0] op_sel_hi:[0,1,1] neg_lo:[1,0,0]
    v_pk_fma_f32 v[6:7], v[8:9], v[64:65], v[6:7] op_sel_hi:[1,0,1]
    v_pk_fma_f32 v[8:9], v[6:7], v[64:65], v[38:39] op_sel:[1,1,0] op_sel_hi:[0,1,1] neg_lo:[1,0,0]
    v_pk_fma_f32 v[8:9], v[6:7], v[64:65], v[8:9] op_sel_hi:[1,0,1]
    v_pk_fma_f32 v[6:7], v[8:9], v[64:65], v[40:41] op_sel:[1,1,0] op_sel_hi:[0,1,1] neg_lo:[1,0,0]
    v_pk_fma_f32 v[6:7], v[8:9], v[64:65], v[6:7] op_sel_hi:[1,0,1]
    v_pk_fma_f32 v[8:9], v[6:7], v[64:65], v[42:43] op_sel:[1,1,0] op_sel_hi:[0,1,1] neg_lo:[1,0,0]
    v_pk_fma_f32 v[8:9], v[6:7], v[64:65], v[8:9] op_sel_hi:[1,0,1]
    v_pk_fma_f32 v[6:7], v[8:9], v[64:65], v[44:45] op_sel:[1,1,0] op_sel_hi:[0,1,1] neg_lo:[1,0,0]
    v_pk_fma_f32 v[6:7], v[8:9], v[64:65], v[6:7] op_sel_hi:[1,0,1]
    buffer_load_dwordx4 a[232:235], v14, s[36:39], s47 offen offset:3072 sc1
    v_pk_fma_f32 v[8:9], v[6:7], v[64:65], v[46:47] op_sel:[1,1,0] op_sel_hi:[0,1,1] neg_lo:[1,0,0]
    v_pk_fma_f32 v[8:9], v[6:7], v[64:65], v[8:9] op_sel_hi:[1,0,1]
    v_mov_b32 v48, v8
    v_mov_b32 v49, v9
    v_lshlrev_b32 v6, 3, v0
    v_permlane16_swap_b32 v8, v48
    v_permlane16_swap_b32 v9, v49
    v_mov_b32 v50, v8
    v_mov_b32 v52, v48
    v_mov_b32 v51, v9
    v_mov_b32 v53, v49
    v_permlane32_swap_b32 v8, v50
    v_permlane32_swap_b32 v48, v52
    v_permlane32_swap_b32 v9, v51
    v_permlane32_swap_b32 v49, v53
    v_pk_fma_f32 v[48:49], v[8:9], v[68:69], v[48:49] op_sel:[1,1,0] op_sel_hi:[0,1,1] neg_lo:[1,0,0]
    v_pk_fma_f32 v[48:49], v[8:9], v[68:69], v[48:49] op_sel_hi:[1,0,1]
    v_pk_fma_f32 v[50:51], v[48:49], v[68:69], v[50:51] op_sel:[1,1,0] op_sel_hi:[0,1,1] neg_lo:[1,0,0]
    v_pk_fma_f32 v[50:51], v[48:49], v[68:69], v[50:51] op_sel_hi:[1,0,1]
    v_pk_fma_f32 v[52:53], v[50:51], v[68:69], v[52:53] op_sel:[1,1,0] op_sel_hi:[0,1,1] neg_lo:[1,0,0]
    v_pk_fma_f32 v[52:53], v[50:51], v[68:69], v[52:53] op_sel_hi:[1,0,1]
    s_mov_b64 exec, 0xffff
    buffer_store_dwordx2 v[52:53], v6, s[24:27], s83 offen sc1
    s_mov_b64 exec, -1
    v_cndmask_b32 v4, 0, v8, s[60:61]
    v_cndmask_b32 v4, v4, v48, s[62:63]
    v_cndmask_b32 v4, v4, v50, s[96:97]
    v_cndmask_b32 v5, 0, v9, s[60:61]
    v_cndmask_b32 v5, v5, v49, s[62:63]
    v_cndmask_b32 v5, v5, v51, s[96:97]
    v_xor_b32 v90, 0x80, v90
    ds_read_b128 v[48:51], v90 offset:5120
    ds_read_b128 v[52:55], v90 offset:5376
    ds_read_b128 v[56:59], v90 offset:5184
    ds_read_b128 v[60:63], v90 offset:5440
    s_waitcnt lgkmcnt(4)
    v_pk_fma_f32 v[128:129], v[112:113], v[76:77], v[128:129] op_sel_hi:[1,0,1]
    v_pk_fma_f32 v[130:131], v[114:115], v[76:77], v[130:131] op_sel_hi:[1,0,1]
    v_pk_fma_f32 v[160:161], v[120:121], v[76:77], v[160:161] op_sel_hi:[1,0,1]
    v_pk_fma_f32 v[162:163], v[122:123], v[76:77], v[162:163] op_sel_hi:[1,0,1]
    v_pk_mul_f32 v[96:97], v[128:129], v[76:77] op_sel:[0,1] op_sel_hi:[1,1]
    v_pk_mul_f32 v[98:99], v[130:131], v[76:77] op_sel:[0,1] op_sel_hi:[1,1]
    v_pk_mul_f32 v[100:101], v[160:161], v[76:77] op_sel:[0,1] op_sel_hi:[1,1]
    v_pk_mul_f32 v[102:103], v[162:163], v[76:77] op_sel:[0,1] op_sel_hi:[1,1]
    v_exp_f32 v96, v96
    s_add_u32 s47, s47, 1024
    buffer_load_dwordx4 a[236:239], v14, s[36:39], s47 offen offset:3072 sc1
    v_exp_f32 v97, v97
    v_exp_f32 v98, v98
    v_exp_f32 v99, v99
    v_exp_f32 v100, v100
    v_exp_f32 v101, v101
    v_exp_f32 v102, v102
    v_exp_f32 v103, v103
    v_pk_fma_f32 v[144:145], v[116:117], v[76:77], v[144:145] op_sel_hi:[1,0,1]
    v_pk_fma_f32 v[146:147], v[118:119], v[76:77], v[146:147] op_sel_hi:[1,0,1]
    v_pk_fma_f32 v[176:177], v[124:125], v[76:77], v[176:177] op_sel_hi:[1,0,1]
    v_pk_fma_f32 v[178:179], v[126:127], v[76:77], v[178:179] op_sel_hi:[1,0,1]
    v_pk_fma_f32 v[96:97], v[96:97], v[84:85], v[84:85] op_sel:[0,0,0] op_sel_hi:[1,0,0]
    v_pk_fma_f32 v[98:99], v[98:99], v[84:85], v[84:85] op_sel:[0,0,0] op_sel_hi:[1,0,0]
    v_pk_fma_f32 v[100:101], v[100:101], v[84:85], v[84:85] op_sel:[0,0,0] op_sel_hi:[1,0,0]
    v_pk_fma_f32 v[102:103], v[102:103], v[84:85], v[84:85] op_sel:[0,0,0] op_sel_hi:[1,0,0]
    v_pk_fma_f32 v[132:133], v[112:113], v[78:79], v[132:133] op_sel_hi:[1,0,1]
    v_rcp_f32 v96, v96
    v_pk_fma_f32 v[134:135], v[114:115], v[78:79], v[134:135] op_sel_hi:[1,0,1]
    v_rcp_f32 v97, v97
    v_pk_fma_f32 v[164:165], v[120:121], v[78:79], v[164:165] op_sel_hi:[1,0,1]
    v_rcp_f32 v98, v98
    v_pk_fma_f32 v[166:167], v[122:123], v[78:79], v[166:167] op_sel_hi:[1,0,1]
    v_rcp_f32 v99, v99
    v_pk_mul_f32 v[104:105], v[132:133], v[78:79] op_sel:[0,1] op_sel_hi:[1,1]
    v_rcp_f32 v100, v100
    v_pk_mul_f32 v[106:107], v[134:135], v[78:79] op_sel:[0,1] op_sel_hi:[1,1]
    v_rcp_f32 v101, v101
    v_pk_mul_f32 v[108:109], v[164:165], v[78:79] op_sel:[0,1] op_sel_hi:[1,1]
    v_rcp_f32 v102, v102
    v_pk_mul_f32 v[110:111], v[166:167], v[78:79] op_sel:[0,1] op_sel_hi:[1,1]
    v_rcp_f32 v103, v103
    v_pk_mul_f32 v[144:145], v[144:145], v[128:129]
    v_exp_f32 v104, v104
    v_pk_mul_f32 v[146:147], v[146:147], v[130:131]
    v_pk_mul_f32 v[176:177], v[176:177], v[160:161]
    v_exp_f32 v105, v105
    v_pk_mul_f32 v[178:179], v[178:179], v[162:163]
    v_exp_f32 v106, v106
    v_pk_mul_f32 v[144:145], v[144:145], v[96:97]
    v_pk_mul_f32 v[146:147], v[146:147], v[98:99]
    v_exp_f32 v107, v107
    v_pk_mul_f32 v[176:177], v[176:177], v[100:101]
    v_exp_f32 v108, v108
    v_pk_mul_f32 v[178:179], v[178:179], v[102:103]
    v_cvt_pk_bf16_f32 v128, v144, v145
    v_exp_f32 v109, v109
    v_cvt_pk_bf16_f32 v129, v146, v147
    v_exp_f32 v110, v110
    v_cvt_pk_bf16_f32 v130, v176, v177
    v_cvt_pk_bf16_f32 v131, v178, v179
    v_exp_f32 v111, v111
    buffer_store_dwordx4 v[128:131], v14, s[20:23], s45 offen offset:0 sc1
    v_pk_fma_f32 v[148:149], v[116:117], v[78:79], v[148:149] op_sel_hi:[1,0,1]
    v_pk_fma_f32 v[150:151], v[118:119], v[78:79], v[150:151] op_sel_hi:[1,0,1]
    v_pk_fma_f32 v[180:181], v[124:125], v[78:79], v[180:181] op_sel_hi:[1,0,1]
    v_pk_fma_f32 v[182:183], v[126:127], v[78:79], v[182:183] op_sel_hi:[1,0,1]
    v_pk_fma_f32 v[104:105], v[104:105], v[84:85], v[84:85] op_sel:[0,1,1] op_sel_hi:[1,1,1]
    v_pk_fma_f32 v[106:107], v[106:107], v[84:85], v[84:85] op_sel:[0,1,1] op_sel_hi:[1,1,1]
    v_pk_fma_f32 v[108:109], v[108:109], v[84:85], v[84:85] op_sel:[0,1,1] op_sel_hi:[1,1,1]
    v_pk_fma_f32 v[110:111], v[110:111], v[84:85], v[84:85] op_sel:[0,1,1] op_sel_hi:[1,1,1]
    v_pk_fma_f32 v[136:137], v[112:113], v[80:81], v[136:137] op_sel_hi:[1,0,1]
    v_rcp_f32 v104, v104
    v_pk_fma_f32 v[138:139], v[114:115], v[80:81], v[138:139] op_sel_hi:[1,0,1]
    v_rcp_f32 v105, v105
    v_pk_fma_f32 v[168:169], v[120:121], v[80:81], v[168:169] op_sel_hi:[1,0,1]
    v_rcp_f32 v106, v106
    v_pk_fma_f32 v[170:171], v[122:123], v[80:81], v[170:171] op_sel_hi:[1,0,1]
    v_rcp_f32 v107, v107
    v_pk_mul_f32 v[96:97], v[136:137], v[80:81] op_sel:[0,1] op_sel_hi:[1,1]
    v_rcp_f32 v108, v108
    v_pk_mul_f32 v[98:99], v[138:139], v[80:81] op_sel:[0,1] op_sel_hi:[1,1]
    v_rcp_f32 v109, v109
    v_pk_mul_f32 v[100:101], v[168:169], v[80:81] op_sel:[0,1] op_sel_hi:[1,1]
    v_rcp_f32 v110, v110
    v_pk_mul_f32 v[102:103], v[170:171], v[80:81] op_sel:[0,1] op_sel_hi:[1,1]
    v_rcp_f32 v111, v111
    v_pk_mul_f32 v[148:149], v[148:149], v[132:133]
    v_exp_f32 v96, v96
    v_pk_mul_f32 v[150:151], v[150:151], v[134:135]
    v_pk_mul_f32 v[180:181], v[180:181], v[164:165]
    v_exp_f32 v97, v97
    v_pk_mul_f32 v[182:183], v[182:183], v[166:167]
    v_exp_f32 v98, v98
    v_pk_mul_f32 v[148:149], v[148:149], v[104:105]
    v_pk_mul_f32 v[150:151], v[150:151], v[106:107]
    v_exp_f32 v99, v99
    v_pk_mul_f32 v[180:181], v[180:181], v[108:109]
    v_exp_f32 v100, v100
    v_pk_mul_f32 v[182:183], v[182:183], v[110:111]
    v_cvt_pk_bf16_f32 v132, v148, v149
    v_exp_f32 v101, v101
    v_cvt_pk_bf16_f32 v133, v150, v151
    v_exp_f32 v102, v102
    v_cvt_pk_bf16_f32 v134, v180, v181
    v_cvt_pk_bf16_f32 v135, v182, v183
    v_exp_f32 v103, v103
    buffer_store_dwordx4 v[132:135], v14, s[20:23], s45 offen offset:1024 sc1
    v_pk_fma_f32 v[152:153], v[116:117], v[80:81], v[152:153] op_sel_hi:[1,0,1]
    v_pk_fma_f32 v[154:155], v[118:119], v[80:81], v[154:155] op_sel_hi:[1,0,1]
    v_pk_fma_f32 v[184:185], v[124:125], v[80:81], v[184:185] op_sel_hi:[1,0,1]
    v_pk_fma_f32 v[186:187], v[126:127], v[80:81], v[186:187] op_sel_hi:[1,0,1]
    v_pk_fma_f32 v[96:97], v[96:97], v[86:87], v[86:87] op_sel:[0,0,0] op_sel_hi:[1,0,0]
    v_pk_fma_f32 v[98:99], v[98:99], v[86:87], v[86:87] op_sel:[0,0,0] op_sel_hi:[1,0,0]
    v_pk_fma_f32 v[100:101], v[100:101], v[86:87], v[86:87] op_sel:[0,0,0] op_sel_hi:[1,0,0]
    v_pk_fma_f32 v[102:103], v[102:103], v[86:87], v[86:87] op_sel:[0,0,0] op_sel_hi:[1,0,0]
    v_pk_fma_f32 v[140:141], v[112:113], v[82:83], v[140:141] op_sel_hi:[1,0,1]
    v_rcp_f32 v96, v96
    v_pk_fma_f32 v[142:143], v[114:115], v[82:83], v[142:143] op_sel_hi:[1,0,1]
    v_rcp_f32 v97, v97
    v_pk_fma_f32 v[172:173], v[120:121], v[82:83], v[172:173] op_sel_hi:[1,0,1]
    v_rcp_f32 v98, v98
    v_pk_fma_f32 v[174:175], v[122:123], v[82:83], v[174:175] op_sel_hi:[1,0,1]
    v_rcp_f32 v99, v99
    v_pk_mul_f32 v[104:105], v[140:141], v[82:83] op_sel:[0,1] op_sel_hi:[1,1]
    v_rcp_f32 v100, v100
    v_pk_mul_f32 v[106:107], v[142:143], v[82:83] op_sel:[0,1] op_sel_hi:[1,1]
    v_rcp_f32 v101, v101
    v_pk_mul_f32 v[108:109], v[172:173], v[82:83] op_sel:[0,1] op_sel_hi:[1,1]
    v_rcp_f32 v102, v102
    v_pk_mul_f32 v[110:111], v[174:175], v[82:83] op_sel:[0,1] op_sel_hi:[1,1]
    v_rcp_f32 v103, v103
    v_pk_mul_f32 v[152:153], v[152:153], v[136:137]
    v_exp_f32 v104, v104
    v_pk_mul_f32 v[154:155], v[154:155], v[138:139]
    v_pk_mul_f32 v[184:185], v[184:185], v[168:169]
    v_exp_f32 v105, v105
    v_pk_mul_f32 v[186:187], v[186:187], v[170:171]
    v_exp_f32 v106, v106
    v_pk_mul_f32 v[152:153], v[152:153], v[96:97]
    v_pk_mul_f32 v[154:155], v[154:155], v[98:99]
    v_exp_f32 v107, v107
    v_pk_mul_f32 v[184:185], v[184:185], v[100:101]
    v_exp_f32 v108, v108
    v_pk_mul_f32 v[186:187], v[186:187], v[102:103]
    v_cvt_pk_bf16_f32 v136, v152, v153
    v_exp_f32 v109, v109
    v_cvt_pk_bf16_f32 v137, v154, v155
    v_exp_f32 v110, v110
    v_cvt_pk_bf16_f32 v138, v184, v185
    v_cvt_pk_bf16_f32 v139, v186, v187
    v_exp_f32 v111, v111
    buffer_store_dwordx4 v[136:139], v14, s[20:23], s45 offen offset:2048 sc1
    v_pk_fma_f32 v[156:157], v[116:117], v[82:83], v[156:157] op_sel_hi:[1,0,1]
    v_pk_fma_f32 v[158:159], v[118:119], v[82:83], v[158:159] op_sel_hi:[1,0,1]
    v_pk_fma_f32 v[188:189], v[124:125], v[82:83], v[188:189] op_sel_hi:[1,0,1]
    v_pk_fma_f32 v[190:191], v[126:127], v[82:83], v[190:191] op_sel_hi:[1,0,1]
    v_pk_fma_f32 v[104:105], v[104:105], v[86:87], v[86:87] op_sel:[0,1,1] op_sel_hi:[1,1,1]
    v_pk_fma_f32 v[106:107], v[106:107], v[86:87], v[86:87] op_sel:[0,1,1] op_sel_hi:[1,1,1]
    v_pk_fma_f32 v[108:109], v[108:109], v[86:87], v[86:87] op_sel:[0,1,1] op_sel_hi:[1,1,1]
    v_pk_fma_f32 v[110:111], v[110:111], v[86:87], v[86:87] op_sel:[0,1,1] op_sel_hi:[1,1,1]
    s_waitcnt lgkmcnt(0)
    v_pk_fma_f32 v[192:193], v[48:49], v[76:77], v[192:193] op_sel_hi:[1,0,1]
    v_rcp_f32 v104, v104
    buffer_load_dwordx2 v[144:145], v91, s[24:27], 0 offen offset:896 sc1
    v_pk_fma_f32 v[194:195], v[50:51], v[76:77], v[194:195] op_sel_hi:[1,0,1]
    v_rcp_f32 v105, v105
    v_pk_fma_f32 v[224:225], v[56:57], v[76:77], v[224:225] op_sel_hi:[1,0,1]
    v_rcp_f32 v106, v106
    v_pk_fma_f32 v[226:227], v[58:59], v[76:77], v[226:227] op_sel_hi:[1,0,1]
    v_rcp_f32 v107, v107
    v_pk_mul_f32 v[96:97], v[192:193], v[76:77] op_sel:[0,1] op_sel_hi:[1,1]
    v_rcp_f32 v108, v108
    buffer_load_dwordx2 v[146:147], v91, s[24:27], 0 offen offset:768 sc1
    v_pk_mul_f32 v[98:99], v[194:195], v[76:77] op_sel:[0,1] op_sel_hi:[1,1]
    v_rcp_f32 v109, v109
    v_pk_mul_f32 v[100:101], v[224:225], v[76:77] op_sel:[0,1] op_sel_hi:[1,1]
    v_rcp_f32 v110, v110
    v_pk_mul_f32 v[102:103], v[226:227], v[76:77] op_sel:[0,1] op_sel_hi:[1,1]
    v_rcp_f32 v111, v111
    v_pk_mul_f32 v[156:157], v[156:157], v[140:141]
    v_exp_f32 v96, v96
    buffer_load_dwordx2 v[160:161], v91, s[24:27], 0 offen offset:640 sc1
    v_pk_mul_f32 v[158:159], v[158:159], v[142:143]
    v_pk_mul_f32 v[188:189], v[188:189], v[172:173]
    v_exp_f32 v97, v97
    v_pk_mul_f32 v[190:191], v[190:191], v[174:175]
    v_exp_f32 v98, v98
    v_pk_mul_f32 v[156:157], v[156:157], v[104:105]
    v_pk_mul_f32 v[158:159], v[158:159], v[106:107]
    v_exp_f32 v99, v99
    v_pk_mul_f32 v[188:189], v[188:189], v[108:109]
    v_exp_f32 v100, v100
    buffer_load_dwordx2 v[162:163], v91, s[24:27], 0 offen offset:512 sc1
    v_pk_mul_f32 v[190:191], v[190:191], v[110:111]
    v_cvt_pk_bf16_f32 v140, v156, v157
    v_exp_f32 v101, v101
    v_cvt_pk_bf16_f32 v141, v158, v159
    v_exp_f32 v102, v102
    v_cvt_pk_bf16_f32 v142, v188, v189
    v_cvt_pk_bf16_f32 v143, v190, v191
    v_exp_f32 v103, v103
    buffer_store_dwordx4 v[140:143], v14, s[20:23], s45 offen offset:3072 sc1
    v_pk_fma_f32 v[208:209], v[52:53], v[76:77], v[208:209] op_sel_hi:[1,0,1]
    v_pk_fma_f32 v[210:211], v[54:55], v[76:77], v[210:211] op_sel_hi:[1,0,1]
    v_pk_fma_f32 v[240:241], v[60:61], v[76:77], v[240:241] op_sel_hi:[1,0,1]
    v_pk_fma_f32 v[242:243], v[62:63], v[76:77], v[242:243] op_sel_hi:[1,0,1]
    v_pk_fma_f32 v[96:97], v[96:97], v[84:85], v[84:85] op_sel:[0,0,0] op_sel_hi:[1,0,0]
    v_pk_fma_f32 v[98:99], v[98:99], v[84:85], v[84:85] op_sel:[0,0,0] op_sel_hi:[1,0,0]
    v_pk_fma_f32 v[100:101], v[100:101], v[84:85], v[84:85] op_sel:[0,0,0] op_sel_hi:[1,0,0]
    v_pk_fma_f32 v[102:103], v[102:103], v[84:85], v[84:85] op_sel:[0,0,0] op_sel_hi:[1,0,0]
    v_pk_fma_f32 v[196:197], v[48:49], v[78:79], v[196:197] op_sel_hi:[1,0,1]
    v_rcp_f32 v96, v96
    v_pk_fma_f32 v[198:199], v[50:51], v[78:79], v[198:199] op_sel_hi:[1,0,1]
    v_rcp_f32 v97, v97
    buffer_load_dwordx2 v[148:149], v91, s[24:27], 0 offen offset:384 sc1
    v_pk_fma_f32 v[228:229], v[56:57], v[78:79], v[228:229] op_sel_hi:[1,0,1]
    v_rcp_f32 v98, v98
    v_pk_fma_f32 v[230:231], v[58:59], v[78:79], v[230:231] op_sel_hi:[1,0,1]
    v_rcp_f32 v99, v99
    v_pk_mul_f32 v[104:105], v[196:197], v[78:79] op_sel:[0,1] op_sel_hi:[1,1]
    v_rcp_f32 v100, v100
    v_pk_mul_f32 v[106:107], v[198:199], v[78:79] op_sel:[0,1] op_sel_hi:[1,1]
    v_rcp_f32 v101, v101
    buffer_load_dwordx2 v[150:151], v91, s[24:27], 0 offen offset:256 sc1
    v_pk_mul_f32 v[108:109], v[228:229], v[78:79] op_sel:[0,1] op_sel_hi:[1,1]
    v_rcp_f32 v102, v102
    v_pk_mul_f32 v[110:111], v[230:231], v[78:79] op_sel:[0,1] op_sel_hi:[1,1]
    v_rcp_f32 v103, v103
    v_pk_mul_f32 v[208:209], v[208:209], v[192:193]
    v_exp_f32 v104, v104
    v_pk_mul_f32 v[210:211], v[210:211], v[194:195]
    v_pk_mul_f32 v[240:241], v[240:241], v[224:225]
    v_exp_f32 v105, v105
    buffer_load_dwordx2 v[164:165], v91, s[24:27], 0 offen offset:128 sc1
    v_pk_mul_f32 v[242:243], v[242:243], v[226:227]
    v_exp_f32 v106, v106
    v_pk_mul_f32 v[208:209], v[208:209], v[96:97]
    v_pk_mul_f32 v[210:211], v[210:211], v[98:99]
    v_exp_f32 v107, v107
    v_pk_mul_f32 v[240:241], v[240:241], v[100:101]
    v_exp_f32 v108, v108
    v_pk_mul_f32 v[242:243], v[242:243], v[102:103]
    v_cvt_pk_bf16_f32 v192, v208, v209
    v_exp_f32 v109, v109
    buffer_load_dwordx2 v[166:167], v91, s[24:27], 0 offen offset:0 sc1
    v_cvt_pk_bf16_f32 v193, v210, v211
    v_exp_f32 v110, v110
    v_cvt_pk_bf16_f32 v194, v240, v241
    v_cvt_pk_bf16_f32 v195, v242, v243
    v_exp_f32 v111, v111
    buffer_store_dwordx4 v[192:195], v14, s[20:23], s46 offen offset:0 sc1
    s_waitcnt vmcnt(5)
    s_mov_b64 exec, 1
    buffer_store_dword a255, off, s[20:23], s3 sc1
    s_mov_b64 exec, -1
    v_pk_fma_f32 v[212:213], v[52:53], v[78:79], v[212:213] op_sel_hi:[1,0,1]
    v_pk_fma_f32 v[214:215], v[54:55], v[78:79], v[214:215] op_sel_hi:[1,0,1]
    v_pk_fma_f32 v[244:245], v[60:61], v[78:79], v[244:245] op_sel_hi:[1,0,1]
    v_pk_fma_f32 v[246:247], v[62:63], v[78:79], v[246:247] op_sel_hi:[1,0,1]
    v_pk_fma_f32 v[104:105], v[104:105], v[84:85], v[84:85] op_sel:[0,1,1] op_sel_hi:[1,1,1]
    v_pk_fma_f32 v[106:107], v[106:107], v[84:85], v[84:85] op_sel:[0,1,1] op_sel_hi:[1,1,1]
    v_pk_fma_f32 v[108:109], v[108:109], v[84:85], v[84:85] op_sel:[0,1,1] op_sel_hi:[1,1,1]
    v_pk_fma_f32 v[110:111], v[110:111], v[84:85], v[84:85] op_sel:[0,1,1] op_sel_hi:[1,1,1]
    v_pk_fma_f32 v[200:201], v[48:49], v[80:81], v[200:201] op_sel_hi:[1,0,1]
    v_rcp_f32 v104, v104
    v_pk_fma_f32 v[202:203], v[50:51], v[80:81], v[202:203] op_sel_hi:[1,0,1]
    v_rcp_f32 v105, v105
    v_pk_fma_f32 v[232:233], v[56:57], v[80:81], v[232:233] op_sel_hi:[1,0,1]
    v_rcp_f32 v106, v106
    v_pk_fma_f32 v[234:235], v[58:59], v[80:81], v[234:235] op_sel_hi:[1,0,1]
    v_rcp_f32 v107, v107
    v_pk_mul_f32 v[96:97], v[200:201], v[80:81] op_sel:[0,1] op_sel_hi:[1,1]
    v_rcp_f32 v108, v108
    v_pk_mul_f32 v[98:99], v[202:203], v[80:81] op_sel:[0,1] op_sel_hi:[1,1]
    v_rcp_f32 v109, v109
    v_pk_mul_f32 v[100:101], v[232:233], v[80:81] op_sel:[0,1] op_sel_hi:[1,1]
    v_rcp_f32 v110, v110
    v_pk_mul_f32 v[102:103], v[234:235], v[80:81] op_sel:[0,1] op_sel_hi:[1,1]
    v_rcp_f32 v111, v111
    v_pk_mul_f32 v[212:213], v[212:213], v[196:197]
    v_exp_f32 v96, v96
    v_pk_mul_f32 v[214:215], v[214:215], v[198:199]
    v_pk_mul_f32 v[244:245], v[244:245], v[228:229]
    v_exp_f32 v97, v97
    v_pk_mul_f32 v[246:247], v[246:247], v[230:231]
    v_exp_f32 v98, v98
    v_pk_mul_f32 v[212:213], v[212:213], v[104:105]
    v_pk_mul_f32 v[214:215], v[214:215], v[106:107]
    v_exp_f32 v99, v99
    v_pk_mul_f32 v[244:245], v[244:245], v[108:109]
    v_exp_f32 v100, v100
    v_pk_mul_f32 v[246:247], v[246:247], v[110:111]
    v_cvt_pk_bf16_f32 v196, v212, v213
    v_exp_f32 v101, v101
    v_cvt_pk_bf16_f32 v197, v214, v215
    v_exp_f32 v102, v102
    v_cvt_pk_bf16_f32 v198, v244, v245
    v_cvt_pk_bf16_f32 v199, v246, v247
    v_exp_f32 v103, v103
    buffer_store_dwordx4 v[196:199], v14, s[20:23], s46 offen offset:1024 sc1
    v_pk_fma_f32 v[216:217], v[52:53], v[80:81], v[216:217] op_sel_hi:[1,0,1]
    v_pk_fma_f32 v[218:219], v[54:55], v[80:81], v[218:219] op_sel_hi:[1,0,1]
    v_pk_fma_f32 v[248:249], v[60:61], v[80:81], v[248:249] op_sel_hi:[1,0,1]
    v_pk_fma_f32 v[250:251], v[62:63], v[80:81], v[250:251] op_sel_hi:[1,0,1]
    v_pk_fma_f32 v[96:97], v[96:97], v[86:87], v[86:87] op_sel:[0,0,0] op_sel_hi:[1,0,0]
    v_pk_fma_f32 v[98:99], v[98:99], v[86:87], v[86:87] op_sel:[0,0,0] op_sel_hi:[1,0,0]
    v_pk_fma_f32 v[100:101], v[100:101], v[86:87], v[86:87] op_sel:[0,0,0] op_sel_hi:[1,0,0]
    v_pk_fma_f32 v[102:103], v[102:103], v[86:87], v[86:87] op_sel:[0,0,0] op_sel_hi:[1,0,0]
    v_pk_fma_f32 v[204:205], v[48:49], v[82:83], v[204:205] op_sel_hi:[1,0,1]
    v_rcp_f32 v96, v96
    v_pk_fma_f32 v[206:207], v[50:51], v[82:83], v[206:207] op_sel_hi:[1,0,1]
    v_rcp_f32 v97, v97
    v_pk_fma_f32 v[236:237], v[56:57], v[82:83], v[236:237] op_sel_hi:[1,0,1]
    v_rcp_f32 v98, v98
    v_pk_fma_f32 v[238:239], v[58:59], v[82:83], v[238:239] op_sel_hi:[1,0,1]
    v_rcp_f32 v99, v99
    v_pk_mul_f32 v[104:105], v[204:205], v[82:83] op_sel:[0,1] op_sel_hi:[1,1]
    v_rcp_f32 v100, v100
    v_pk_mul_f32 v[106:107], v[206:207], v[82:83] op_sel:[0,1] op_sel_hi:[1,1]
    v_rcp_f32 v101, v101
    v_pk_mul_f32 v[108:109], v[236:237], v[82:83] op_sel:[0,1] op_sel_hi:[1,1]
    v_rcp_f32 v102, v102
    v_pk_mul_f32 v[110:111], v[238:239], v[82:83] op_sel:[0,1] op_sel_hi:[1,1]
    v_rcp_f32 v103, v103
    v_pk_mul_f32 v[216:217], v[216:217], v[200:201]
    v_exp_f32 v104, v104
    v_pk_mul_f32 v[218:219], v[218:219], v[202:203]
    v_pk_mul_f32 v[248:249], v[248:249], v[232:233]
    v_exp_f32 v105, v105
    v_pk_mul_f32 v[250:251], v[250:251], v[234:235]
    v_exp_f32 v106, v106
    v_pk_mul_f32 v[216:217], v[216:217], v[96:97]
    v_pk_mul_f32 v[218:219], v[218:219], v[98:99]
    v_exp_f32 v107, v107
    v_pk_mul_f32 v[248:249], v[248:249], v[100:101]
    v_exp_f32 v108, v108
    v_pk_mul_f32 v[250:251], v[250:251], v[102:103]
    v_cvt_pk_bf16_f32 v200, v216, v217
    v_exp_f32 v109, v109
    v_cvt_pk_bf16_f32 v201, v218, v219
    v_exp_f32 v110, v110
    v_cvt_pk_bf16_f32 v202, v248, v249
    v_cvt_pk_bf16_f32 v203, v250, v251
    v_exp_f32 v111, v111
    buffer_store_dwordx4 v[200:203], v14, s[20:23], s46 offen offset:2048 sc1
    v_pk_fma_f32 v[220:221], v[52:53], v[82:83], v[220:221] op_sel_hi:[1,0,1]
    v_pk_fma_f32 v[222:223], v[54:55], v[82:83], v[222:223] op_sel_hi:[1,0,1]
    v_pk_fma_f32 v[252:253], v[60:61], v[82:83], v[252:253] op_sel_hi:[1,0,1]
    v_pk_fma_f32 v[254:255], v[62:63], v[82:83], v[254:255] op_sel_hi:[1,0,1]
    v_pk_fma_f32 v[104:105], v[104:105], v[86:87], v[86:87] op_sel:[0,1,1] op_sel_hi:[1,1,1]
    v_pk_fma_f32 v[106:107], v[106:107], v[86:87], v[86:87] op_sel:[0,1,1] op_sel_hi:[1,1,1]
    v_pk_fma_f32 v[108:109], v[108:109], v[86:87], v[86:87] op_sel:[0,1,1] op_sel_hi:[1,1,1]
    v_pk_fma_f32 v[110:111], v[110:111], v[86:87], v[86:87] op_sel:[0,1,1] op_sel_hi:[1,1,1]
    v_rcp_f32 v104, v104
    v_rcp_f32 v105, v105
    v_rcp_f32 v106, v106
    v_rcp_f32 v107, v107
    v_rcp_f32 v108, v108
    v_rcp_f32 v109, v109
    v_rcp_f32 v110, v110
    v_rcp_f32 v111, v111
    v_pk_mul_f32 v[220:221], v[220:221], v[204:205]
    v_pk_mul_f32 v[222:223], v[222:223], v[206:207]
    v_pk_mul_f32 v[252:253], v[252:253], v[236:237]
    v_pk_mul_f32 v[254:255], v[254:255], v[238:239]
    v_pk_mul_f32 v[220:221], v[220:221], v[104:105]
    v_pk_mul_f32 v[222:223], v[222:223], v[106:107]
    v_pk_mul_f32 v[252:253], v[252:253], v[108:109]
    v_pk_mul_f32 v[254:255], v[254:255], v[110:111]
    v_cvt_pk_bf16_f32 v204, v220, v221
    v_cvt_pk_bf16_f32 v205, v222, v223
    v_cvt_pk_bf16_f32 v206, v252, v253
    v_cvt_pk_bf16_f32 v207, v254, v255
    buffer_store_dwordx4 v[204:207], v14, s[20:23], s46 offen offset:3072 sc1
    s_waitcnt vmcnt(5)
    s_mov_b32 s55, 0
L_fh_9:
    v_pk_fma_f32 v[8:9], v[144:145], v[70:71], v[146:147] op_sel:[1,1,0] op_sel_hi:[0,1,1] neg_lo:[1,0,0]
    v_pk_fma_f32 v[8:9], v[144:145], v[70:71], v[8:9] op_sel_hi:[1,0,1]
    v_pk_fma_f32 v[6:7], v[8:9], v[70:71], v[160:161] op_sel:[1,1,0] op_sel_hi:[0,1,1] neg_lo:[1,0,0]
    v_pk_fma_f32 v[6:7], v[8:9], v[70:71], v[6:7] op_sel_hi:[1,0,1]
    v_pk_fma_f32 v[8:9], v[6:7], v[70:71], v[162:163] op_sel:[1,1,0] op_sel_hi:[0,1,1] neg_lo:[1,0,0]
    v_pk_fma_f32 v[8:9], v[6:7], v[70:71], v[8:9] op_sel_hi:[1,0,1]
    v_pk_fma_f32 v[6:7], v[8:9], v[70:71], v[148:149] op_sel:[1,1,0] op_sel_hi:[0,1,1] neg_lo:[1,0,0]
    v_pk_fma_f32 v[6:7], v[8:9], v[70:71], v[6:7] op_sel_hi:[1,0,1]
    v_pk_fma_f32 v[8:9], v[6:7], v[70:71], v[150:151] op_sel:[1,1,0] op_sel_hi:[0,1,1] neg_lo:[1,0,0]
    v_pk_fma_f32 v[8:9], v[6:7], v[70:71], v[8:9] op_sel_hi:[1,0,1]
    v_pk_fma_f32 v[6:7], v[8:9], v[70:71], v[164:165] op_sel:[1,1,0] op_sel_hi:[0,1,1] neg_lo:[1,0,0]
    v_pk_fma_f32 v[6:7], v[8:9], v[70:71], v[6:7] op_sel_hi:[1,0,1]
    v_pk_fma_f32 v[8:9], v[6:7], v[70:71], v[166:167] op_sel:[1,1,0] op_sel_hi:[0,1,1] neg_lo:[1,0,0]
    v_pk_fma_f32 v[8:9], v[6:7], v[70:71], v[8:9] op_sel_hi:[1,0,1]
    v_cmp_u_f32 vcc, v8, v9
    s_nop 0
    s_cbranch_vccnz L_fs_11
L_fok_10:
    v_pk_mul_f32 v[6:7], v[8:9], v[74:75] op_sel_hi:[1,0]
    v_pk_fma_f32 v[6:7], v[8:9], v[74:75], v[6:7] op_sel:[1,1,0] op_sel_hi:[0,1,1] neg_lo:[1,0,0]
    v_mov_b32 v10, v6
    v_mov_b32 v11, v7
    s_nop 0
    v_permlane16_swap_b32 v6, v10
    v_permlane16_swap_b32 v7, v11
    v_pk_add_f32 v[6:7], v[6:7], v[10:11]
    v_mov_b32 v10, v6
    v_mov_b32 v11, v7
    s_nop 0
    v_permlane32_swap_b32 v6, v10
    v_permlane32_swap_b32 v7, v11
    v_pk_add_f32 v[6:7], v[6:7], v[10:11]
    v_pk_fma_f32 v[4:5], v[6:7], v[72:73], v[4:5] op_sel:[1,1,0] op_sel_hi:[0,1,1] neg_lo:[1,0,0]
    v_pk_fma_f32 v[4:5], v[6:7], v[72:73], v[4:5] op_sel_hi:[1,0,1]
    v_pk_fma_f32 v[16:17], v[4:5], v[64:65], v[16:17] op_sel:[1,1,0] op_sel_hi:[0,1,1] neg_lo:[1,0,0]
    v_pk_fma_f32 v[16:17], v[4:5], v[64:65], v[16:17] op_sel_hi:[1,0,1]
    v_pk_fma_f32 v[18:19], v[16:17], v[64:65], v[18:19] op_sel:[1,1,0] op_sel_hi:[0,1,1] neg_lo:[1,0,0]
    v_pk_fma_f32 v[18:19], v[16:17], v[64:65], v[18:19] op_sel_hi:[1,0,1]
    v_pk_fma_f32 v[20:21], v[18:19], v[64:65], v[20:21] op_sel:[1,1,0] op_sel_hi:[0,1,1] neg_lo:[1,0,0]
    v_pk_fma_f32 v[20:21], v[18:19], v[64:65], v[20:21] op_sel_hi:[1,0,1]
    v_pk_fma_f32 v[22:23], v[20:21], v[64:65], v[22:23] op_sel:[1,1,0] op_sel_hi:[0,1,1] neg_lo:[1,0,0]
    v_pk_fma_f32 v[22:23], v[20:21], v[64:65], v[22:23] op_sel_hi:[1,0,1]
    v_cvt_pk_bf16_f32 v176, v16, v18
    v_cvt_pk_bf16_f32 v177, v20, v22
    v_cvt_pk_bf16_f32 v178, -v17, -v19
    v_cvt_pk_bf16_f32 v179, -v21, -v23
    ds_write_b64 v92, v[176:177] offset:0
    ds_write_b64 v92, v[178:179] offset:512
    ds_read_b64_tr_b16 v[16:17], v93 offset:0
    ds_read_b64_tr_b16 v[18:19], v93 offset:512
    buffer_load_dword v13, v1, s[20:23], s100 offen sc1
    v_pk_fma_f32 v[24:25], v[22:23], v[64:65], v[24:25] op_sel:[1,1,0] op_sel_hi:[0,1,1] neg_lo:[1,0,0]
    v_pk_fma_f32 v[24:25], v[22:23], v[64:65], v[24:25] op_sel_hi:[1,0,1]
    v_pk_fma_f32 v[26:27], v[24:25], v[64:65], v[26:27] op_sel:[1,1,0] op_sel_hi:[0,1,1] neg_lo:[1,0,0]
    v_pk_fma_f32 v[26:27], v[24:25], v[64:65], v[26:27] op_sel_hi:[1,0,1]
    v_pk_fma_f32 v[28:29], v[26:27], v[64:65], v[28:29] op_sel:[1,1,0] op_sel_hi:[0,1,1] neg_lo:[1,0,0]
    v_pk_fma_f32 v[28:29], v[26:27], v[64:65], v[28:29] op_sel_hi:[1,0,1]
    v_pk_fma_f32 v[30:31], v[28:29], v[64:65], v[30:31] op_sel:[1,1,0] op_sel_hi:[0,1,1] neg_lo:[1,0,0]
    v_pk_fma_f32 v[30:31], v[28:29], v[64:65], v[30:31] op_sel_hi:[1,0,1]
    v_cvt_pk_bf16_f32 v180, v24, v26
    v_cvt_pk_bf16_f32 v181, v28, v30
    v_cvt_pk_bf16_f32 v182, -v25, -v27
    v_cvt_pk_bf16_f32 v183, -v29, -v31
    ds_write_b64 v92, v[180:181] offset:1024
    ds_write_b64 v92, v[182:183] offset:1536
    ds_read_b64_tr_b16 v[24:25], v93 offset:1024
    ds_read_b64_tr_b16 v[26:27], v93 offset:1536
    s_waitcnt lgkmcnt(4)
    buffer_store_dwordx4 v[16:19], v14, s[20:23], s82 offen offset:0 sc1
    v_pk_fma_f32 v[32:33], v[30:31], v[64:65], v[32:33] op_sel:[1,1,0] op_sel_hi:[0,1,1] neg_lo:[1,0,0]
    v_pk_fma_f32 v[32:33], v[30:31], v[64:65], v[32:33] op_sel_hi:[1,0,1]
    v_pk_fma_f32 v[34:35], v[32:33], v[64:65], v[34:35] op_sel:[1,1,0] op_sel_hi:[0,1,1] neg_lo:[1,0,0]
    v_pk_fma_f32 v[34:35], v[32:33], v[64:65], v[34:35] op_sel_hi:[1,0,1]
    v_pk_fma_f32 v[36:37], v[34:35], v[64:65], v[36:37] op_sel:[1,1,0] op_sel_hi:[0,1,1] neg_lo:[1,0,0]
    v_pk_fma_f32 v[36:37], v[34:35], v[64:65], v[36:37] op_sel_hi:[1,0,1]
    v_pk_fma_f32 v[38:39], v[36:37], v[64:65], v[38:39] op_sel:[1,1,0] op_sel_hi:[0,1,1] neg_lo:[1,0,0]
    v_pk_fma_f32 v[38:39], v[36:37], v[64:65], v[38:39] op_sel_hi:[1,0,1]
    v_cvt_pk_bf16_f32 v184, v32, v34
    v_cvt_pk_bf16_f32 v185, v36, v38
    v_cvt_pk_bf16_f32 v186, -v33, -v35
    v_cvt_pk_bf16_f32 v187, -v37, -v39
    ds_write_b64 v92, v[184:185] offset:2048
    ds_write_b64 v92, v[186:187] offset:2560
    ds_read_b64_tr_b16 v[32:33], v93 offset:2048
    ds_read_b64_tr_b16 v[34:35], v93 offset:2560
    s_waitcnt lgkmcnt(4)
    buffer_store_dwordx4 v[24:27], v14, s[20:23], s82 offen offset:1024 sc1
    v_pk_fma_f32 v[40:41], v[38:39], v[64:65], v[40:41] op_sel:[1,1,0] op_sel_hi:[0,1,1] neg_lo:[1,0,0]
    v_pk_fma_f32 v[40:41], v[38:39], v[64:65], v[40:41] op_sel_hi:[1,0,1]
    v_pk_fma_f32 v[42:43], v[40:41], v[64:65], v[42:43] op_sel:[1,1,0] op_sel_hi:[0,1,1] neg_lo:[1,0,0]
    v_pk_fma_f32 v[42:43], v[40:41], v[64:65], v[42:43] op_sel_hi:[1,0,1]
    v_pk_fma_f32 v[44:45], v[42:43], v[64:65], v[44:45] op_sel:[1,1,0] op_sel_hi:[0,1,1] neg_lo:[1,0,0]
    v_pk_fma_f32 v[44:45], v[42:43], v[64:65], v[44:45] op_sel_hi:[1,0,1]
    v_pk_fma_f32 v[46:47], v[44:45], v[64:65], v[46:47] op_sel:[1,1,0] op_sel_hi:[0,1,1] neg_lo:[1,0,0]
    v_pk_fma_f32 v[46:47], v[44:45], v[64:65], v[46:47] op_sel_hi:[1,0,1]
    v_cvt_pk_bf16_f32 v188, v40, v42
    v_cvt_pk_bf16_f32 v189, v44, v46
    v_cvt_pk_bf16_f32 v190, -v41, -v43
    v_cvt_pk_bf16_f32 v191, -v45, -v47
    ds_write_b64 v92, v[188:189] offset:3072
    ds_write_b64 v92, v[190:191] offset:3584
    ds_read_b64_tr_b16 v[40:41], v93 offset:3072
    ds_read_b64_tr_b16 v[42:43], v93 offset:3584
    s_waitcnt lgkmcnt(4)
    buffer_store_dwordx4 v[32:35], v14, s[20:23], s82 offen offset:2048 sc1
    s_waitcnt lgkmcnt(0)
    buffer_store_dwordx4 v[40:43], v14, s[20:23], s82 offen offset:3072 sc1
    s_add_u32 s3, s3, 131072
    s_waitcnt vmcnt(4)
L_p2:
L_st_q:
    s_cbranch_execz L_st_p5
L_st_5:
    s_cbranch_execz L_tr_x
L_st_p5:
    s_cbranch_execz L_st_p6
    s_and_b32 s56, s52, 1
    s_mul_i32 s49, s56, 393216
    s_sub_u32 s41, 393216, s49
    v_cmp_ne_u32 vcc, 1, v13
    s_mov_b32 s55, 0
    s_cbranch_vccz L_ok_12
    s_waitcnt vmcnt(0)
    s_mov_b64 exec, 1
    buffer_store_dword a255, off, s[20:23], s3 sc1
    s_mov_b64 exec, -1
L_sp_13:
    buffer_load_dword v13, v1, s[20:23], s100 offen sc1
    s_add_u32 s55, s55, 1
    s_cmp_gt_u32 s55, 200000
    s_cbranch_scc1 L_ok_12
    s_waitcnt vmcnt(0)
    v_cmp_ne_u32 vcc, 1, v13
    s_nop 0
    s_cbranch_vccnz L_sp_13
L_ok_12:
    s_add_u32 s45, s41, 0
    buffer_load_dwordx4 v[32:35], v14, s[32:35], s45 offen offset:0 sc1
    buffer_load_dwordx4 v[36:39], v14, s[32:35], s45 offen offset:1024 sc1
    buffer_load_dwordx4 v[40:43], v14, s[32:35], s45 offen offset:2048 sc1
    buffer_load_dwordx4 v[44:47], v14, s[32:35], s45 offen offset:3072 sc1
    s_add_u32 s46, s41, 4096
    buffer_load_dwordx4 v[48:51], v14, s[32:35], s46 offen offset:0 sc1
    buffer_load_dwordx4 v[52:55], v14, s[32:35], s46 offen offset:1024 sc1
    buffer_load_dwordx4 v[56:59], v14, s[32:35], s46 offen offset:2048 sc1
    buffer_load_dwordx4 v[60:63], v14, s[32:35], s46 offen offset:3072 sc1
    s_mov_b32 s24, s90
    s_mov_b32 s25, s91
    s_mov_b32 s26, 5242880
    s_mov_b32 s27, 0x20000
    v_bfe_u32 v3, v0, 2, 2
    v_lshrrev_b32 v11, 4, v0
    v_lshl_add_u32 v6, v3, 2, v11
    v_and_b32 v7, 3, v0
    v_lshl_add_u32 v3, v3, 4, v11
    s_lshl_b32 s57, s52, 6
    s_lshl2_add_u32 s56, s40, s57
    v_add_u32 v3, s56, v3
    v_lshl_add_u32 v5, v7, 3, s48
    v_mul_u32_u24 v4, 160, v6
    v_add_u32 v4, v4, v5
    v_lshl_add_u32 v8, v6, 3, s48
    ds_read_b64 v[128:129], v8 offset:4992
    ds_read_b64 v[132:133], v4 offset:0
    ds_read_b64 v[142:143], v5 offset:3072
    ds_read_b64 v[134:135], v4 offset:32
    ds_read_b64 v[144:145], v5 offset:3104
    ds_read_b64 v[136:137], v4 offset:64
    ds_read_b64 v[146:147], v5 offset:3136
    ds_read_b64 v[138:139], v4 offset:96
    ds_read_b64 v[148:149], v5 offset:3168
    ds_read_b64 v[140:141], v4 offset:128
    ds_read_b64 v[150:151], v5 offset:3200
    s_mul_i32 s56, s53, 320
    v_lshl_add_u32 v8, v7, 4, s56
    v_mul_u32_u24 v3, 2560, v3
    v_add_u32 v8, v8, v3
    v_lshlrev_b32 v9, 3, v0
    s_mov_b32 m0, s43
    s_mul_i32 s56, s40, 5120
    v_add_u32 v11, s56, v14
    v_add_u32 v12, 40960, v11
    s_waitcnt vmcnt(8)
    s_mov_b64 exec, 1
    buffer_store_dword a255, off, s[20:23], s3 sc1
    s_mov_b64 exec, -1
    s_add_u32 s45, s41, 8192
    buffer_load_dwordx4 v[64:67], v14, s[32:35], s45 offen offset:0 sc1
    buffer_load_dwordx4 v[68:71], v14, s[32:35], s45 offen offset:1024 sc1
    buffer_load_dwordx4 v[72:75], v14, s[32:35], s45 offen offset:2048 sc1
    buffer_load_dwordx4 v[76:79], v14, s[32:35], s45 offen offset:3072 sc1
    s_lshl3_add_u32 s56, s52, s53
    s_lshl2_add_u32 s56, s56, s40
    s_xor_b32 s57, s56, 32
    s_mul_i32 s48, s56, 2560
    s_add_u32 s48, s48, 19922944
    s_mul_i32 s50, s57, 2560
    s_add_u32 s50, s50, 19922944
    s_lshl_b32 s83, s56, 7
    s_add_u32 s83, s83, 524288
    s_lshl_b32 s3, s57, 7
    s_add_u32 s3, s3, 524288
    s_mov_b32 s59, 0xffff0000
    s_waitcnt lgkmcnt(0)
    v_lshlrev_b32 v16, 16, v132
    v_and_b32 v17, s59, v132
    v_lshlrev_b32 v152, 16, v142
    v_and_b32 v153, s59, v142
    v_pk_add_f32 v[154:155], v[16:17], v[128:129] op_sel_hi:[1,0]
    v_pk_mul_f32 v[154:155], v[154:155], v[128:129] op_sel:[0,1] op_sel_hi:[1,1]
    v_pk_fma_f32 v[16:17], v[154:155], v[152:153], v[16:17]
    v_lshlrev_b32 v18, 16, v133
    v_and_b32 v19, s59, v133
    v_lshlrev_b32 v152, 16, v143
    v_and_b32 v153, s59, v143
    v_pk_add_f32 v[154:155], v[18:19], v[128:129] op_sel_hi:[1,0]
    v_pk_mul_f32 v[154:155], v[154:155], v[128:129] op_sel:[0,1] op_sel_hi:[1,1]
    v_pk_fma_f32 v[18:19], v[154:155], v[152:153], v[18:19]
    v_lshlrev_b32 v20, 16, v134
    v_and_b32 v21, s59, v134
    v_lshlrev_b32 v152, 16, v144
    v_and_b32 v153, s59, v144
    v_pk_add_f32 v[154:155], v[20:21], v[128:129] op_sel_hi:[1,0]
    v_pk_mul_f32 v[154:155], v[154:155], v[128:129] op_sel:[0,1] op_sel_hi:[1,1]
    v_pk_fma_f32 v[20:21], v[154:155], v[152:153], v[20:21]
    v_lshlrev_b32 v22, 16, v135
    v_and_b32 v23, s59, v135
    v_lshlrev_b32 v152, 16, v145
    v_and_b32 v153, s59, v145
    v_pk_add_f32 v[154:155], v[22:23], v[128:129] op_sel_hi:[1,0]
    v_pk_mul_f32 v[154:155], v[154:155], v[128:129] op_sel:[0,1] op_sel_hi:[1,1]
    v_pk_fma_f32 v[22:23], v[154:155], v[152:153], v[22:23]
    v_lshlrev_b32 v24, 16, v136
    v_and_b32 v25, s59, v136
    v_lshlrev_b32 v152, 16, v146
    v_and_b32 v153, s59, v146
    v_pk_add_f32 v[154:155], v[24:25], v[128:129] op_sel_hi:[1,0]
    v_pk_mul_f32 v[154:155], v[154:155], v[128:129] op_sel:[0,1] op_sel_hi:[1,1]
    v_pk_fma_f32 v[24:25], v[154:155], v[152:153], v[24:25]
    v_lshlrev_b32 v26, 16, v137
    v_and_b32 v27, s59, v137
    v_lshlrev_b32 v152, 16, v147
    v_and_b32 v153, s59, v147
    v_pk_add_f32 v[154:155], v[26:27], v[128:129] op_sel_hi:[1,0]
    v_pk_mul_f32 v[154:155], v[154:155], v[128:129] op_sel:[0,1] op_sel_hi:[1,1]
    v_pk_fma_f32 v[26:27], v[154:155], v[152:153], v[26:27]
    v_lshlrev_b32 v28, 16, v138
    v_and_b32 v29, s59, v138
    v_lshlrev_b32 v152, 16, v148
    v_and_b32 v153, s59, v148
    v_pk_add_f32 v[154:155], v[28:29], v[128:129] op_sel_hi:[1,0]
    v_pk_mul_f32 v[154:155], v[154:155], v[128:129] op_sel:[0,1] op_sel_hi:[1,1]
    v_pk_fma_f32 v[28:29], v[154:155], v[152:153], v[28:29]
    v_lshlrev_b32 v30, 16, v139
    v_and_b32 v31, s59, v139
    v_lshlrev_b32 v152, 16, v149
    v_and_b32 v153, s59, v149
    v_pk_add_f32 v[154:155], v[30:31], v[128:129] op_sel_hi:[1,0]
    v_pk_mul_f32 v[154:155], v[154:155], v[128:129] op_sel:[0,1] op_sel_hi:[1,1]
    v_pk_fma_f32 v[30:31], v[154:155], v[152:153], v[30:31]
    v_lshlrev_b32 v4, 16, v140
    v_and_b32 v5, s59, v140
    v_lshlrev_b32 v152, 16, v150
    v_and_b32 v153, s59, v150
    v_pk_add_f32 v[154:155], v[4:5], v[128:129] op_sel_hi:[1,0]
    v_pk_mul_f32 v[154:155], v[154:155], v[128:129] op_sel:[0,1] op_sel_hi:[1,1]
    v_pk_fma_f32 v[4:5], v[154:155], v[152:153], v[4:5]
    v_lshlrev_b32 v6, 16, v141
    v_and_b32 v7, s59, v141
    v_lshlrev_b32 v152, 16, v151
    v_and_b32 v153, s59, v151
    v_pk_add_f32 v[154:155], v[6:7], v[128:129] op_sel_hi:[1,0]
    v_pk_mul_f32 v[154:155], v[154:155], v[128:129] op_sel:[0,1] op_sel_hi:[1,1]
    v_pk_fma_f32 v[6:7], v[154:155], v[152:153], v[6:7]
    s_waitcnt vmcnt(12)
    v_mfma_f32_16x16x32_bf16 v[176:179], v[32:35], a[0:3], 0
    s_add_u32 s46, s41, 12288
    v_mfma_f32_16x16x32_bf16 v[192:195], v[32:35], a[4:7], 0
    buffer_load_dwordx4 v[80:83], v14, s[32:35], s46 offen offset:0 sc1
    v_mfma_f32_16x16x32_bf16 v[208:211], v[32:35], a[8:11], 0
    v_mfma_f32_16x16x32_bf16 v[224:227], v[32:35], a[12:15], 0
    v_mfma_f32_16x16x32_bf16 v[240:243], v[32:35], a[16:19], 0
    s_waitcnt vmcnt(12)
    v_mfma_f32_16x16x32_bf16 v[180:183], v[36:39], a[0:3], 0
    v_mfma_f32_16x16x32_bf16 v[196:199], v[36:39], a[4:7], 0
    buffer_load_dwordx4 v[84:87], v14, s[32:35], s46 offen offset:1024 sc1
    v_mfma_f32_16x16x32_bf16 v[212:215], v[36:39], a[8:11], 0
    v_mfma_f32_16x16x32_bf16 v[228:231], v[36:39], a[12:15], 0
    v_mfma_f32_16x16x32_bf16 v[244:247], v[36:39], a[16:19], 0
    s_waitcnt vmcnt(12)
    v_mfma_f32_16x16x32_bf16 v[184:187], v[40:43], a[0:3], 0
    v_mfma_f32_16x16x32_bf16 v[200:203], v[40:43], a[4:7], 0
    buffer_load_dwordx4 v[88:91], v14, s[32:35], s46 offen offset:2048 sc1
    v_mfma_f32_16x16x32_bf16 v[216:219], v[40:43], a[8:11], 0
    v_mfma_f32_16x16x32_bf16 v[232:235], v[40:43], a[12:15], 0
    v_mfma_f32_16x16x32_bf16 v[248:251], v[40:43], a[16:19], 0
    s_waitcnt vmcnt(12)
    v_mfma_f32_16x16x32_bf16 v[188:191], v[44:47], a[0:3], 0
    v_mfma_f32_16x16x32_bf16 v[204:207], v[44:47], a[4:7], 0
    buffer_load_dwordx4 v[92:95], v14, s[32:35], s46 offen offset:3072 sc1
    v_mfma_f32_16x16x32_bf16 v[220:223], v[44:47], a[8:11], 0
    v_mfma_f32_16x16x32_bf16 v[236:239], v[44:47], a[12:15], 0
    v_mfma_f32_16x16x32_bf16 v[252:255], v[44:47], a[16:19], 0
    s_waitcnt vmcnt(12)
    v_mfma_f32_16x16x32_bf16 v[176:179], v[48:51], a[20:23], v[176:179]
    s_add_u32 s45, s41, 16384
    v_mfma_f32_16x16x32_bf16 v[192:195], v[48:51], a[24:27], v[192:195]
    buffer_load_dwordx4 v[32:35], v14, s[32:35], s45 offen offset:0 sc1
    v_mfma_f32_16x16x32_bf16 v[208:211], v[48:51], a[28:31], v[208:211]
    v_mfma_f32_16x16x32_bf16 v[224:227], v[48:51], a[32:35], v[224:227]
    v_mfma_f32_16x16x32_bf16 v[240:243], v[48:51], a[36:39], v[240:243]
    s_waitcnt vmcnt(12)
    v_mfma_f32_16x16x32_bf16 v[180:183], v[52:55], a[20:23], v[180:183]
    v_mfma_f32_16x16x32_bf16 v[196:199], v[52:55], a[24:27], v[196:199]
    buffer_load_dwordx4 v[36:39], v14, s[32:35], s45 offen offset:1024 sc1
    v_mfma_f32_16x16x32_bf16 v[212:215], v[52:55], a[28:31], v[212:215]
    v_mfma_f32_16x16x32_bf16 v[228:231], v[52:55], a[32:35], v[228:231]
    v_mfma_f32_16x16x32_bf16 v[244:247], v[52:55], a[36:39], v[244:247]
    s_waitcnt vmcnt(12)
    v_mfma_f32_16x16x32_bf16 v[184:187], v[56:59], a[20:23], v[184:187]
    v_mfma_f32_16x16x32_bf16 v[200:203], v[56:59], a[24:27], v[200:203]
    buffer_load_dwordx4 v[40:43], v14, s[32:35], s45 offen offset:2048 sc1
    v_mfma_f32_16x16x32_bf16 v[216:219], v[56:59], a[28:31], v[216:219]
    v_mfma_f32_16x16x32_bf16 v[232:235], v[56:59], a[32:35], v[232:235]
    v_mfma_f32_16x16x32_bf16 v[248:251], v[56:59], a[36:39], v[248:251]
    s_waitcnt vmcnt(12)
    v_mfma_f32_16x16x32_bf16 v[188:191], v[60:63], a[20:23], v[188:191]
    v_mfma_f32_16x16x32_bf16 v[204:207], v[60:63], a[24:27], v[204:207]
    buffer_load_dwordx4 v[44:47], v14, s[32:35], s45 offen offset:3072 sc1
    v_mfma_f32_16x16x32_bf16 v[220:223], v[60:63], a[28:31], v[220:223]
    v_mfma_f32_16x16x32_bf16 v[236:239], v[60:63], a[32:35], v[236:239]
    v_mfma_f32_16x16x32_bf16 v[252:255], v[60:63], a[36:39], v[252:255]
    s_waitcnt vmcnt(11)
    v_mfma_f32_16x16x32_bf16 v[176:179], v[64:67], a[40:43], v[176:179]
    s_add_u32 s46, s41, 20480
    v_mfma_f32_16x16x32_bf16 v[192:195], v[64:67], a[44:47], v[192:195]
    buffer_load_dwordx4 v[48:51], v14, s[32:35], s46 offen offset:0 sc1
    v_mfma_f32_16x16x32_bf16 v[208:211], v[64:67], a[48:51], v[208:211]
    v_mfma_f32_16x16x32_bf16 v[224:227], v[64:67], a[52:55], v[224:227]
    v_mfma_f32_16x16x32_bf16 v[240:243], v[64:67], a[56:59], v[240:243]
    s_waitcnt vmcnt(11)
    v_mfma_f32_16x16x32_bf16 v[180:183], v[68:71], a[40:43], v[180:183]
    v_mfma_f32_16x16x32_bf16 v[196:199], v[68:71], a[44:47], v[196:199]
    buffer_load_dwordx4 v[52:55], v14, s[32:35], s46 offen offset:1024 sc1
    v_mfma_f32_16x16x32_bf16 v[212:215], v[68:71], a[48:51], v[212:215]
    v_mfma_f32_16x16x32_bf16 v[228:231], v[68:71], a[52:55], v[228:231]
    v_mfma_f32_16x16x32_bf16 v[244:247], v[68:71], a[56:59], v[244:247]
    s_waitcnt vmcnt(11)
    v_mfma_f32_16x16x32_bf16 v[184:187], v[72:75], a[40:43], v[184:187]
    v_mfma_f32_16x16x32_bf16 v[200:203], v[72:75], a[44:47], v[200:203]
    buffer_load_dwordx4 v[56:59], v14, s[32:35], s46 offen offset:2048 sc1
    v_mfma_f32_16x16x32_bf16 v[216:219], v[72:75], a[48:51], v[216:219]
    v_mfma_f32_16x16x32_bf16 v[232:235], v[72:75], a[52:55], v[232:235]
    v_mfma_f32_16x16x32_bf16 v[248:251], v[72:75], a[56:59], v[248:251]
    s_waitcnt vmcnt(11)
    v_mfma_f32_16x16x32_bf16 v[188:191], v[76:79], a[40:43], v[188:191]
    v_mfma_f32_16x16x32_bf16 v[204:207], v[76:79], a[44:47], v[204:207]
    buffer_load_dwordx4 v[60:63], v14, s[32:35], s46 offen offset:3072 sc1
    v_mfma_f32_16x16x32_bf16 v[220:223], v[76:79], a[48:51], v[220:223]
    v_mfma_f32_16x16x32_bf16 v[236:239], v[76:79], a[52:55], v[236:239]
    v_mfma_f32_16x16x32_bf16 v[252:255], v[76:79], a[56:59], v[252:255]
    s_waitcnt vmcnt(11)
    v_mfma_f32_16x16x32_bf16 v[176:179], v[80:83], a[60:63], v[176:179]
    v_mfma_f32_16x16x32_bf16 v[192:195], v[80:83], a[64:67], v[192:195]
    buffer_load_dword v13, v2, s[20:23], s44 offen sc1
    v_mfma_f32_16x16x32_bf16 v[208:211], v[80:83], a[68:71], v[208:211]
    v_mfma_f32_16x16x32_bf16 v[224:227], v[80:83], a[72:75], v[224:227]
    s_add_u32 s45, s41, 24576
    s_add_u32 s45, s45, s54
    v_mfma_f32_16x16x32_bf16 v[240:243], v[80:83], a[76:79], v[240:243]
    s_waitcnt vmcnt(11)
    buffer_load_dwordx4 v[64:67], v14, s[32:35], s45 offen offset:0 sc1
    v_mfma_f32_16x16x32_bf16 v[180:183], v[84:87], a[60:63], v[180:183]
    v_mfma_f32_16x16x32_bf16 v[196:199], v[84:87], a[64:67], v[196:199]
    v_mfma_f32_16x16x32_bf16 v[212:215], v[84:87], a[68:71], v[212:215]
    buffer_load_dwordx4 v[68:71], v14, s[32:35], s45 offen offset:1024 sc1
    v_mfma_f32_16x16x32_bf16 v[228:231], v[84:87], a[72:75], v[228:231]
    v_mfma_f32_16x16x32_bf16 v[244:247], v[84:87], a[76:79], v[244:247]
    s_waitcnt vmcnt(12)
    v_mfma_f32_16x16x32_bf16 v[184:187], v[88:91], a[60:63], v[184:187]
    buffer_load_dwordx4 v[72:75], v14, s[32:35], s45 offen offset:2048 sc1
    v_mfma_f32_16x16x32_bf16 v[200:203], v[88:91], a[64:67], v[200:203]
    v_mfma_f32_16x16x32_bf16 v[216:219], v[88:91], a[68:71], v[216:219]
    v_mfma_f32_16x16x32_bf16 v[232:235], v[88:91], a[72:75], v[232:235]
    buffer_load_dwordx4 v[76:79], v14, s[32:35], s45 offen offset:3072 sc1
    v_mfma_f32_16x16x32_bf16 v[248:251], v[88:91], a[76:79], v[248:251]
    s_waitcnt vmcnt(13)
    v_mfma_f32_16x16x32_bf16 v[188:191], v[92:95], a[60:63], v[188:191]
    v_mfma_f32_16x16x32_bf16 v[204:207], v[92:95], a[64:67], v[204:207]
    v_mfma_f32_16x16x32_bf16 v[220:223], v[92:95], a[68:71], v[220:223]
    v_mfma_f32_16x16x32_bf16 v[236:239], v[92:95], a[72:75], v[236:239]
    v_mfma_f32_16x16x32_bf16 v[252:255], v[92:95], a[76:79], v[252:255]
    s_waitcnt vmcnt(12)
    v_mfma_f32_16x16x32_bf16 v[176:179], v[32:35], a[80:83], v[176:179]
    s_add_u32 s46, s41, 28672
    s_waitcnt vmcnt(4)
    v_cmp_ne_u32 vcc, 1, v13
    s_mov_b32 s55, 0
    s_cbranch_vccz L_ok_14
L_sp_15:
    buffer_load_dword v13, v2, s[20:23], s44 offen sc1
    s_add_u32 s55, s55, 1
    s_cmp_gt_u32 s55, 200000
    s_cbranch_scc1 L_ok_14
    s_waitcnt vmcnt(0)
    v_cmp_ne_u32 vcc, 1, v13
    s_nop 0
    s_cbranch_vccnz L_sp_15
L_ok_14:
    v_mfma_f32_16x16x32_bf16 v[192:195], v[32:35], a[84:87], v[192:195]
    buffer_load_dwordx4 v[80:83], v14, s[32:35], s46 offen offset:0 sc1
    v_mfma_f32_16x16x32_bf16 v[208:211], v[32:35], a[88:91], v[208:211]
    v_mfma_f32_16x16x32_bf16 v[224:227], v[32:35], a[92:95], v[224:227]
    v_mfma_f32_16x16x32_bf16 v[240:243], v[32:35], a[96:99], v[240:243]
    v_mfma_f32_16x16x32_bf16 v[180:183], v[36:39], a[80:83], v[180:183]
    v_mfma_f32_16x16x32_bf16 v[196:199], v[36:39], a[84:87], v[196:199]
    buffer_load_dwordx4 v[84:87], v14, s[32:35], s46 offen offset:1024 sc1
    v_mfma_f32_16x16x32_bf16 v[212:215], v[36:39], a[88:91], v[212:215]
    v_mfma_f32_16x16x32_bf16 v[228:231], v[36:39], a[92:95], v[228:231]
    v_mfma_f32_16x16x32_bf16 v[244:247], v[36:39], a[96:99], v[244:247]
    v_mfma_f32_16x16x32_bf16 v[184:187], v[40:43], a[80:83], v[184:187]
    v_mfma_f32_16x16x32_bf16 v[200:203], v[40:43], a[84:87], v[200:203]
    buffer_load_dwordx4 v[88:91], v14, s[32:35], s46 offen offset:2048 sc1
    v_mfma_f32_16x16x32_bf16 v[216:219], v[40:43], a[88:91], v[216:219]
    v_mfma_f32_16x16x32_bf16 v[232:235], v[40:43], a[92:95], v[232:235]
    v_mfma_f32_16x16x32_bf16 v[248:251], v[40:43], a[96:99], v[248:251]
    v_mfma_f32_16x16x32_bf16 v[188:191], v[44:47], a[80:83], v[188:191]
    v_mfma_f32_16x16x32_bf16 v[204:207], v[44:47], a[84:87], v[204:207]
    buffer_load_dwordx4 v[92:95], v14, s[32:35], s46 offen offset:3072 sc1
    v_mfma_f32_16x16x32_bf16 v[220:223], v[44:47], a[88:91], v[220:223]
    v_mfma_f32_16x16x32_bf16 v[236:239], v[44:47], a[92:95], v[236:239]
    v_mfma_f32_16x16x32_bf16 v[252:255], v[44:47], a[96:99], v[252:255]
    v_mfma_f32_16x16x32_bf16 v[176:179], v[48:51], a[100:103], v[176:179]
    s_add_u32 s45, s41, 32768
    v_mfma_f32_16x16x32_bf16 v[192:195], v[48:51], a[104:107], v[192:195]
    buffer_load_dwordx4 v[32:35], v14, s[32:35], s45 offen offset:0 sc1
    v_mfma_f32_16x16x32_bf16 v[208:211], v[48:51], a[108:111], v[208:211]
    v_mfma_f32_16x16x32_bf16 v[224:227], v[48:51], a[112:115], v[224:227]
    v_mfma_f32_16x16x32_bf16 v[240:243], v[48:51], a[116:119], v[240:243]
    v_mfma_f32_16x16x32_bf16 v[180:183], v[52:55], a[100:103], v[180:183]
    v_mfma_f32_16x16x32_bf16 v[196:199], v[52:55], a[104:107], v[196:199]
    buffer_load_dwordx4 v[36:39], v14, s[32:35], s45 offen offset:1024 sc1
    v_mfma_f32_16x16x32_bf16 v[212:215], v[52:55], a[108:111], v[212:215]
    v_mfma_f32_16x16x32_bf16 v[228:231], v[52:55], a[112:115], v[228:231]
    v_mfma_f32_16x16x32_bf16 v[244:247], v[52:55], a[116:119], v[244:247]
    v_mfma_f32_16x16x32_bf16 v[184:187], v[56:59], a[100:103], v[184:187]
    v_mfma_f32_16x16x32_bf16 v[200:203], v[56:59], a[104:107], v[200:203]
    buffer_load_dwordx4 v[40:43], v14, s[32:35], s45 offen offset:2048 sc1
    v_mfma_f32_16x16x32_bf16 v[216:219], v[56:59], a[108:111], v[216:219]
    v_mfma_f32_16x16x32_bf16 v[232:235], v[56:59], a[112:115], v[232:235]
    v_mfma_f32_16x16x32_bf16 v[248:251], v[56:59], a[116:119], v[248:251]
    v_mfma_f32_16x16x32_bf16 v[188:191], v[60:63], a[100:103], v[188:191]
    v_mfma_f32_16x16x32_bf16 v[204:207], v[60:63], a[104:107], v[204:207]
    buffer_load_dwordx4 v[44:47], v14, s[32:35], s45 offen offset:3072 sc1
    v_mfma_f32_16x16x32_bf16 v[220:223], v[60:63], a[108:111], v[220:223]
    v_mfma_f32_16x16x32_bf16 v[236:239], v[60:63], a[112:115], v[236:239]
    v_mfma_f32_16x16x32_bf16 v[252:255], v[60:63], a[116:119], v[252:255]
    s_waitcnt vmcnt(11)
    v_mfma_f32_16x16x32_bf16 v[176:179], v[64:67], a[120:123], v[176:179]
    s_add_u32 s46, s41, 36864
    v_mfma_f32_16x16x32_bf16 v[192:195], v[64:67], a[124:127], v[192:195]
    buffer_load_dwordx4 v[48:51], v14, s[32:35], s46 offen offset:0 sc1
    v_mfma_f32_16x16x32_bf16 v[208:211], v[64:67], a[128:131], v[208:211]
    v_mfma_f32_16x16x32_bf16 v[224:227], v[64:67], a[132:135], v[224:227]
    v_mfma_f32_16x16x32_bf16 v[240:243], v[64:67], a[136:139], v[240:243]
    s_waitcnt vmcnt(11)
    v_mfma_f32_16x16x32_bf16 v[180:183], v[68:71], a[120:123], v[180:183]
    v_mfma_f32_16x16x32_bf16 v[196:199], v[68:71], a[124:127], v[196:199]
    buffer_load_dwordx4 v[52:55], v14, s[32:35], s46 offen offset:1024 sc1
    v_mfma_f32_16x16x32_bf16 v[212:215], v[68:71], a[128:131], v[212:215]
    v_mfma_f32_16x16x32_bf16 v[228:231], v[68:71], a[132:135], v[228:231]
    v_mfma_f32_16x16x32_bf16 v[244:247], v[68:71], a[136:139], v[244:247]
    s_waitcnt vmcnt(11)
    v_mfma_f32_16x16x32_bf16 v[184:187], v[72:75], a[120:123], v[184:187]
    v_mfma_f32_16x16x32_bf16 v[200:203], v[72:75], a[124:127], v[200:203]
    buffer_load_dwordx4 v[56:59], v14, s[32:35], s46 offen offset:2048 sc1
    v_mfma_f32_16x16x32_bf16 v[216:219], v[72:75], a[128:131], v[216:219]
    v_mfma_f32_16x16x32_bf16 v[232:235], v[72:75], a[132:135], v[232:235]
    v_mfma_f32_16x16x32_bf16 v[248:251], v[72:75], a[136:139], v[248:251]
    s_waitcnt vmcnt(11)
    v_mfma_f32_16x16x32_bf16 v[188:191], v[76:79], a[120:123], v[188:191]
    v_mfma_f32_16x16x32_bf16 v[204:207], v[76:79], a[124:127], v[204:207]
    buffer_load_dwordx4 v[60:63], v14, s[32:35], s46 offen offset:3072 sc1
    v_mfma_f32_16x16x32_bf16 v[220:223], v[76:79], a[128:131], v[220:223]
    v_mfma_f32_16x16x32_bf16 v[236:239], v[76:79], a[132:135], v[236:239]
    v_mfma_f32_16x16x32_bf16 v[252:255], v[76:79], a[136:139], v[252:255]
    s_waitcnt vmcnt(11)
    v_mfma_f32_16x16x32_bf16 v[176:179], v[80:83], a[140:143], v[176:179]
    s_add_u32 s45, s41, 40960
    v_mfma_f32_16x16x32_bf16 v[192:195], v[80:83], a[144:147], v[192:195]
    buffer_load_dwordx4 v[64:67], v14, s[32:35], s45 offen offset:0 sc1
    v_mfma_f32_16x16x32_bf16 v[208:211], v[80:83], a[148:151], v[208:211]
    v_mfma_f32_16x16x32_bf16 v[224:227], v[80:83], a[152:155], v[224:227]
    v_mfma_f32_16x16x32_bf16 v[240:243], v[80:83], a[156:159], v[240:243]
    s_waitcnt vmcnt(11)
    v_mfma_f32_16x16x32_bf16 v[180:183], v[84:87], a[140:143], v[180:183]
    v_mfma_f32_16x16x32_bf16 v[196:199], v[84:87], a[144:147], v[196:199]
    buffer_load_dwordx4 v[68:71], v14, s[32:35], s45 offen offset:1024 sc1
    v_mfma_f32_16x16x32_bf16 v[212:215], v[84:87], a[148:151], v[212:215]
    v_mfma_f32_16x16x32_bf16 v[228:231], v[84:87], a[152:155], v[228:231]
    v_mfma_f32_16x16x32_bf16 v[244:247], v[84:87], a[156:159], v[244:247]
    s_waitcnt vmcnt(11)
    v_mfma_f32_16x16x32_bf16 v[184:187], v[88:91], a[140:143], v[184:187]
    v_mfma_f32_16x16x32_bf16 v[200:203], v[88:91], a[144:147], v[200:203]
    buffer_load_dwordx4 v[72:75], v14, s[32:35], s45 offen offset:2048 sc1
    v_mfma_f32_16x16x32_bf16 v[216:219], v[88:91], a[148:151], v[216:219]
    v_mfma_f32_16x16x32_bf16 v[232:235], v[88:91], a[152:155], v[232:235]
    v_mfma_f32_16x16x32_bf16 v[248:251], v[88:91], a[156:159], v[248:251]
    s_waitcnt vmcnt(11)
    v_mfma_f32_16x16x32_bf16 v[188:191], v[92:95], a[140:143], v[188:191]
    v_mfma_f32_16x16x32_bf16 v[204:207], v[92:95], a[144:147], v[204:207]
    buffer_load_dwordx4 v[76:79], v14, s[32:35], s45 offen offset:3072 sc1
    v_mfma_f32_16x16x32_bf16 v[220:223], v[92:95], a[148:151], v[220:223]
    v_mfma_f32_16x16x32_bf16 v[236:239], v[92:95], a[152:155], v[236:239]
    v_mfma_f32_16x16x32_bf16 v[252:255], v[92:95], a[156:159], v[252:255]
    s_waitcnt vmcnt(11)
    v_mfma_f32_16x16x32_bf16 v[176:179], v[32:35], a[160:163], v[176:179]
    s_add_u32 s46, s41, 45056
    v_mfma_f32_16x16x32_bf16 v[192:195], v[32:35], a[164:167], v[192:195]
    buffer_load_dwordx4 v[80:83], v14, s[32:35], s46 offen offset:0 sc1
    v_mfma_f32_16x16x32_bf16 v[208:211], v[32:35], a[168:171], v[208:211]
    v_mfma_f32_16x16x32_bf16 v[224:227], v[32:35], a[172:175], v[224:227]
    v_mfma_f32_16x16x32_bf16 v[240:243], v[32:35], a[176:179], v[240:243]
    s_waitcnt vmcnt(11)
    v_mfma_f32_16x16x32_bf16 v[180:183], v[36:39], a[160:163], v[180:183]
    v_mfma_f32_16x16x32_bf16 v[196:199], v[36:39], a[164:167], v[196:199]
    buffer_load_dwordx4 v[84:87], v14, s[32:35], s46 offen offset:1024 sc1
    v_mfma_f32_16x16x32_bf16 v[212:215], v[36:39], a[168:171], v[212:215]
    v_mfma_f32_16x16x32_bf16 v[228:231], v[36:39], a[172:175], v[228:231]
    v_mfma_f32_16x16x32_bf16 v[244:247], v[36:39], a[176:179], v[244:247]
    s_waitcnt vmcnt(11)
    v_mfma_f32_16x16x32_bf16 v[184:187], v[40:43], a[160:163], v[184:187]
    v_mfma_f32_16x16x32_bf16 v[200:203], v[40:43], a[164:167], v[200:203]
    buffer_load_dwordx4 v[88:91], v14, s[32:35], s46 offen offset:2048 sc1
    v_mfma_f32_16x16x32_bf16 v[216:219], v[40:43], a[168:171], v[216:219]
    v_mfma_f32_16x16x32_bf16 v[232:235], v[40:43], a[172:175], v[232:235]
    v_mfma_f32_16x16x32_bf16 v[248:251], v[40:43], a[176:179], v[248:251]
    s_waitcnt vmcnt(11)
    v_mfma_f32_16x16x32_bf16 v[188:191], v[44:47], a[160:163], v[188:191]
    v_mfma_f32_16x16x32_bf16 v[204:207], v[44:47], a[164:167], v[204:207]
    buffer_load_dwordx4 v[92:95], v14, s[32:35], s46 offen offset:3072 sc1
    v_mfma_f32_16x16x32_bf16 v[220:223], v[44:47], a[168:171], v[220:223]
    v_mfma_f32_16x16x32_bf16 v[236:239], v[44:47], a[172:175], v[236:239]
    v_mfma_f32_16x16x32_bf16 v[252:255], v[44:47], a[176:179], v[252:255]
    s_waitcnt vmcnt(11)
    v_mfma_f32_16x16x32_bf16 v[176:179], v[48:51], a[180:183], v[176:179]
    s_add_u32 s45, s49, 0
    v_mfma_f32_16x16x32_bf16 v[192:195], v[48:51], a[184:187], v[192:195]
    buffer_load_dwordx4 v[32:35], v14, s[32:35], s45 offen offset:0 sc1
    v_mfma_f32_16x16x32_bf16 v[208:211], v[48:51], a[188:191], v[208:211]
    v_mfma_f32_16x16x32_bf16 v[224:227], v[48:51], a[192:195], v[224:227]
    v_mfma_f32_16x16x32_bf16 v[240:243], v[48:51], a[196:199], v[240:243]
    s_waitcnt vmcnt(11)
    v_mfma_f32_16x16x32_bf16 v[180:183], v[52:55], a[180:183], v[180:183]
    v_mfma_f32_16x16x32_bf16 v[196:199], v[52:55], a[184:187], v[196:199]
    buffer_load_dwordx4 v[36:39], v14, s[32:35], s45 offen offset:1024 sc1
    v_mfma_f32_16x16x32_bf16 v[212:215], v[52:55], a[188:191], v[212:215]
    v_mfma_f32_16x16x32_bf16 v[228:231], v[52:55], a[192:195], v[228:231]
    v_mfma_f32_16x16x32_bf16 v[244:247], v[52:55], a[196:199], v[244:247]
    s_waitcnt vmcnt(11)
    v_mfma_f32_16x16x32_bf16 v[184:187], v[56:59], a[180:183], v[184:187]
    v_mfma_f32_16x16x32_bf16 v[200:203], v[56:59], a[184:187], v[200:203]
    buffer_load_dwordx4 v[40:43], v14, s[32:35], s45 offen offset:2048 sc1
    v_mfma_f32_16x16x32_bf16 v[216:219], v[56:59], a[188:191], v[216:219]
    v_mfma_f32_16x16x32_bf16 v[232:235], v[56:59], a[192:195], v[232:235]
    v_mfma_f32_16x16x32_bf16 v[248:251], v[56:59], a[196:199], v[248:251]
    s_waitcnt vmcnt(11)
    v_mfma_f32_16x16x32_bf16 v[188:191], v[60:63], a[180:183], v[188:191]
    v_mfma_f32_16x16x32_bf16 v[204:207], v[60:63], a[184:187], v[204:207]
    buffer_load_dwordx4 v[44:47], v14, s[32:35], s45 offen offset:3072 sc1
    v_mfma_f32_16x16x32_bf16 v[220:223], v[60:63], a[188:191], v[220:223]
    v_mfma_f32_16x16x32_bf16 v[236:239], v[60:63], a[192:195], v[236:239]
    v_mfma_f32_16x16x32_bf16 v[252:255], v[60:63], a[196:199], v[252:255]
    s_waitcnt vmcnt(11)
    v_mfma_f32_16x16x32_bf16 v[176:179], v[64:67], a[200:203], v[176:179]
    s_add_u32 s46, s49, 4096
    v_mfma_f32_16x16x32_bf16 v[192:195], v[64:67], a[204:207], v[192:195]
    buffer_load_dwordx4 v[48:51], v14, s[32:35], s46 offen offset:0 sc1
    v_mfma_f32_16x16x32_bf16 v[208:211], v[64:67], a[208:211], v[208:211]
    v_mfma_f32_16x16x32_bf16 v[224:227], v[64:67], a[212:215], v[224:227]
    v_mfma_f32_16x16x32_bf16 v[240:243], v[64:67], a[216:219], v[240:243]
    s_waitcnt vmcnt(11)
    v_mfma_f32_16x16x32_bf16 v[180:183], v[68:71], a[200:203], v[180:183]
    v_mfma_f32_16x16x32_bf16 v[196:199], v[68:71], a[204:207], v[196:199]
    buffer_load_dwordx4 v[52:55], v14, s[32:35], s46 offen offset:1024 sc1
    v_mfma_f32_16x16x32_bf16 v[212:215], v[68:71], a[208:211], v[212:215]
    v_mfma_f32_16x16x32_bf16 v[228:231], v[68:71], a[212:215], v[228:231]
    v_mfma_f32_16x16x32_bf16 v[244:247], v[68:71], a[216:219], v[244:247]
    s_waitcnt vmcnt(11)
    v_mfma_f32_16x16x32_bf16 v[184:187], v[72:75], a[200:203], v[184:187]
    v_mfma_f32_16x16x32_bf16 v[200:203], v[72:75], a[204:207], v[200:203]
    buffer_load_dwordx4 v[56:59], v14, s[32:35], s46 offen offset:2048 sc1
    v_mfma_f32_16x16x32_bf16 v[216:219], v[72:75], a[208:211], v[216:219]
    v_mfma_f32_16x16x32_bf16 v[232:235], v[72:75], a[212:215], v[232:235]
    v_mfma_f32_16x16x32_bf16 v[248:251], v[72:75], a[216:219], v[248:251]
    s_waitcnt vmcnt(11)
    v_mfma_f32_16x16x32_bf16 v[188:191], v[76:79], a[200:203], v[188:191]
    v_mfma_f32_16x16x32_bf16 v[204:207], v[76:79], a[204:207], v[204:207]
    buffer_load_dwordx4 v[60:63], v14, s[32:35], s46 offen offset:3072 sc1
    v_mfma_f32_16x16x32_bf16 v[220:223], v[76:79], a[208:211], v[220:223]
    v_mfma_f32_16x16x32_bf16 v[236:239], v[76:79], a[212:215], v[236:239]
    v_mfma_f32_16x16x32_bf16 v[252:255], v[76:79], a[216:219], v[252:255]
    s_waitcnt vmcnt(11)
    v_mfma_f32_16x16x32_bf16 v[176:179], v[80:83], a[220:223], v[176:179]
    s_add_u32 s45, s49, 8192
    v_mfma_f32_16x16x32_bf16 v[192:195], v[80:83], a[224:227], v[192:195]
    buffer_load_dwordx4 v[64:67], v14, s[32:35], s45 offen offset:0 sc1
    v_mfma_f32_16x16x32_bf16 v[208:211], v[80:83], a[228:231], v[208:211]
    v_mfma_f32_16x16x32_bf16 v[224:227], v[80:83], a[232:235], v[224:227]
    v_mfma_f32_16x16x32_bf16 v[240:243], v[80:83], a[236:239], v[240:243]
    s_waitcnt vmcnt(11)
    v_mfma_f32_16x16x32_bf16 v[180:183], v[84:87], a[220:223], v[180:183]
    v_mfma_f32_16x16x32_bf16 v[196:199], v[84:87], a[224:227], v[196:199]
    buffer_load_dwordx4 v[68:71], v14, s[32:35], s45 offen offset:1024 sc1
    v_mfma_f32_16x16x32_bf16 v[212:215], v[84:87], a[228:231], v[212:215]
    v_mfma_f32_16x16x32_bf16 v[228:231], v[84:87], a[232:235], v[228:231]
    ds_write_addtid_b32 v176 offset:0
    ds_write_addtid_b32 v177 offset:256
    v_mfma_f32_16x16x32_bf16 v[244:247], v[84:87], a[236:239], v[244:247]
    s_waitcnt vmcnt(11)
    ds_write_addtid_b32 v178 offset:512
    ds_write_addtid_b32 v179 offset:768
    v_mfma_f32_16x16x32_bf16 v[184:187], v[88:91], a[220:223], v[184:187]
    ds_write_addtid_b32 v192 offset:1024
    ds_write_addtid_b32 v193 offset:1280
    v_mfma_f32_16x16x32_bf16 v[200:203], v[88:91], a[224:227], v[200:203]
    buffer_load_dwordx4 v[72:75], v14, s[32:35], s45 offen offset:2048 sc1
    v_mfma_f32_16x16x32_bf16 v[216:219], v[88:91], a[228:231], v[216:219]
    ds_write_addtid_b32 v194 offset:1536
    ds_write_addtid_b32 v195 offset:1792
    v_mfma_f32_16x16x32_bf16 v[232:235], v[88:91], a[232:235], v[232:235]
    ds_write_addtid_b32 v208 offset:2048
    ds_write_addtid_b32 v209 offset:2304
    v_mfma_f32_16x16x32_bf16 v[248:251], v[88:91], a[236:239], v[248:251]
    s_waitcnt vmcnt(11)
    ds_write_addtid_b32 v210 offset:2560
    ds_write_addtid_b32 v211 offset:2816
    v_mfma_f32_16x16x32_bf16 v[188:191], v[92:95], a[220:223], v[188:191]
    ds_write_addtid_b32 v224 offset:3072
    ds_write_addtid_b32 v225 offset:3328
    v_mfma_f32_16x16x32_bf16 v[204:207], v[92:95], a[224:227], v[204:207]
    buffer_load_dwordx4 v[76:79], v14, s[32:35], s45 offen offset:3072 sc1
    v_mfma_f32_16x16x32_bf16 v[220:223], v[92:95], a[228:231], v[220:223]
    ds_write_addtid_b32 v226 offset:3584
    ds_write_addtid_b32 v227 offset:3840
    v_mfma_f32_16x16x32_bf16 v[236:239], v[92:95], a[232:235], v[236:239]
    ds_write_addtid_b32 v240 offset:4096
    ds_write_addtid_b32 v241 offset:4352
    v_mfma_f32_16x16x32_bf16 v[252:255], v[92:95], a[236:239], v[252:255]
    s_waitcnt vmcnt(11)
    ds_write_addtid_b32 v242 offset:4608
    ds_write_addtid_b32 v243 offset:4864
    v_mfma_f32_16x16x32_bf16 v[96:99], v[32:35], a[0:3], 0
    s_add_u32 s46, s49, 12288
    ds_write_addtid_b32 v180 offset:5120
    ds_write_addtid_b32 v181 offset:5376
    v_mfma_f32_16x16x32_bf16 v[112:115], v[32:35], a[4:7], 0
    buffer_load_dwordx4 v[80:83], v14, s[32:35], s46 offen offset:0 sc1
    v_mfma_f32_16x16x32_bf16 v[128:131], v[32:35], a[8:11], 0
    ds_write_addtid_b32 v182 offset:5632
    ds_write_addtid_b32 v183 offset:5888
    v_mfma_f32_16x16x32_bf16 v[144:147], v[32:35], a[12:15], 0
    ds_write_addtid_b32 v196 offset:6144
    ds_write_addtid_b32 v197 offset:6400
    v_mfma_f32_16x16x32_bf16 v[160:163], v[32:35], a[16:19], 0
    s_waitcnt vmcnt(11)
    ds_write_addtid_b32 v198 offset:6656
    ds_write_addtid_b32 v199 offset:6912
    v_mfma_f32_16x16x32_bf16 v[100:103], v[36:39], a[0:3], 0
    ds_write_addtid_b32 v212 offset:7168
    ds_write_addtid_b32 v213 offset:7424
    v_mfma_f32_16x16x32_bf16 v[116:119], v[36:39], a[4:7], 0
    buffer_load_dwordx4 v[84:87], v14, s[32:35], s46 offen offset:1024 sc1
    v_mfma_f32_16x16x32_bf16 v[132:135], v[36:39], a[8:11], 0
    ds_write_addtid_b32 v214 offset:7680
    ds_write_addtid_b32 v215 offset:7936
    v_mfma_f32_16x16x32_bf16 v[148:151], v[36:39], a[12:15], 0
    ds_write_addtid_b32 v228 offset:8192
    ds_write_addtid_b32 v229 offset:8448
    v_mfma_f32_16x16x32_bf16 v[164:167], v[36:39], a[16:19], 0
    s_waitcnt vmcnt(11)
    ds_write_addtid_b32 v230 offset:8704
    ds_write_addtid_b32 v231 offset:8960
    v_mfma_f32_16x16x32_bf16 v[104:107], v[40:43], a[0:3], 0
    ds_write_addtid_b32 v244 offset:9216
    ds_write_addtid_b32 v245 offset:9472
    v_mfma_f32_16x16x32_bf16 v[120:123], v[40:43], a[4:7], 0
    buffer_load_dwordx4 v[88:91], v14, s[32:35], s46 offen offset:2048 sc1
    v_mfma_f32_16x16x32_bf16 v[136:139], v[40:43], a[8:11], 0
    ds_write_addtid_b32 v246 offset:9728
    ds_write_addtid_b32 v247 offset:9984
    v_mfma_f32_16x16x32_bf16 v[152:155], v[40:43], a[12:15], 0
    ds_write_addtid_b32 v184 offset:10240
    ds_write_addtid_b32 v185 offset:10496
    v_mfma_f32_16x16x32_bf16 v[168:171], v[40:43], a[16:19], 0
    s_waitcnt vmcnt(11)
    ds_write_addtid_b32 v186 offset:10752
L_st_6:
    s_cbranch_execz L_st_7
L_st_p6:
    s_cbranch_execz L_tr_y
    ds_write_addtid_b32 v187 offset:11008
    v_mfma_f32_16x16x32_bf16 v[108:111], v[44:47], a[0:3], 0
    ds_write_addtid_b32 v200 offset:11264
    ds_write_addtid_b32 v201 offset:11520
    v_mfma_f32_16x16x32_bf16 v[124:127], v[44:47], a[4:7], 0
    buffer_load_dwordx4 v[92:95], v14, s[32:35], s46 offen offset:3072 sc1
    v_mfma_f32_16x16x32_bf16 v[140:143], v[44:47], a[8:11], 0
    ds_write_addtid_b32 v202 offset:11776
    ds_write_addtid_b32 v203 offset:12032
    v_mfma_f32_16x16x32_bf16 v[156:159], v[44:47], a[12:15], 0
    ds_write_addtid_b32 v216 offset:12288
    ds_write_addtid_b32 v217 offset:12544
    v_mfma_f32_16x16x32_bf16 v[172:175], v[44:47], a[16:19], 0
    s_waitcnt vmcnt(11)
    ds_write_addtid_b32 v218 offset:12800
    ds_write_addtid_b32 v219 offset:13056
    v_mfma_f32_16x16x32_bf16 v[96:99], v[48:51], a[20:23], v[96:99]
    s_add_u32 s45, s49, 16384
    ds_write_addtid_b32 v232 offset:13312
    ds_write_addtid_b32 v233 offset:13568
    v_mfma_f32_16x16x32_bf16 v[112:115], v[48:51], a[24:27], v[112:115]
    buffer_load_dwordx4 v[32:35], v14, s[32:35], s45 offen offset:0 sc1
    v_mfma_f32_16x16x32_bf16 v[128:131], v[48:51], a[28:31], v[128:131]
    ds_write_addtid_b32 v234 offset:13824
    ds_write_addtid_b32 v235 offset:14080
    v_mfma_f32_16x16x32_bf16 v[144:147], v[48:51], a[32:35], v[144:147]
    ds_write_addtid_b32 v248 offset:14336
    ds_write_addtid_b32 v249 offset:14592
    v_mfma_f32_16x16x32_bf16 v[160:163], v[48:51], a[36:39], v[160:163]
    s_waitcnt vmcnt(11)
    ds_write_addtid_b32 v250 offset:14848
    ds_write_addtid_b32 v251 offset:15104
    v_mfma_f32_16x16x32_bf16 v[100:103], v[52:55], a[20:23], v[100:103]
    ds_write_addtid_b32 v188 offset:15360
    ds_write_addtid_b32 v189 offset:15616
    v_mfma_f32_16x16x32_bf16 v[116:119], v[52:55], a[24:27], v[116:119]
    buffer_load_dwordx4 v[36:39], v14, s[32:35], s45 offen offset:1024 sc1
    v_mfma_f32_16x16x32_bf16 v[132:135], v[52:55], a[28:31], v[132:135]
    ds_write_addtid_b32 v190 offset:15872
    ds_write_addtid_b32 v191 offset:16128
    v_mfma_f32_16x16x32_bf16 v[148:151], v[52:55], a[32:35], v[148:151]
    ds_write_addtid_b32 v204 offset:16384
    ds_write_addtid_b32 v205 offset:16640
    v_mfma_f32_16x16x32_bf16 v[164:167], v[52:55], a[36:39], v[164:167]
    s_waitcnt vmcnt(11)
    ds_write_addtid_b32 v206 offset:16896
    ds_write_addtid_b32 v207 offset:17152
    v_mfma_f32_16x16x32_bf16 v[104:107], v[56:59], a[20:23], v[104:107]
    ds_write_addtid_b32 v220 offset:17408
    ds_write_addtid_b32 v221 offset:17664
    v_mfma_f32_16x16x32_bf16 v[120:123], v[56:59], a[24:27], v[120:123]
    buffer_load_dwordx4 v[40:43], v14, s[32:35], s45 offen offset:2048 sc1
    v_mfma_f32_16x16x32_bf16 v[136:139], v[56:59], a[28:31], v[136:139]
    ds_write_addtid_b32 v222 offset:17920
    ds_write_addtid_b32 v223 offset:18176
    v_mfma_f32_16x16x32_bf16 v[152:155], v[56:59], a[32:35], v[152:155]
    ds_write_addtid_b32 v236 offset:18432
    ds_write_addtid_b32 v237 offset:18688
    v_mfma_f32_16x16x32_bf16 v[168:171], v[56:59], a[36:39], v[168:171]
    s_waitcnt vmcnt(11)
    ds_write_addtid_b32 v238 offset:18944
    ds_write_addtid_b32 v239 offset:19200
    v_mfma_f32_16x16x32_bf16 v[108:111], v[60:63], a[20:23], v[108:111]
    ds_write_addtid_b32 v252 offset:19456
    ds_write_addtid_b32 v253 offset:19712
    v_mfma_f32_16x16x32_bf16 v[124:127], v[60:63], a[24:27], v[124:127]
    buffer_load_dwordx4 v[44:47], v14, s[32:35], s45 offen offset:3072 sc1
    v_mfma_f32_16x16x32_bf16 v[140:143], v[60:63], a[28:31], v[140:143]
    ds_write_addtid_b32 v254 offset:19968
    ds_write_addtid_b32 v255 offset:20224
    v_mfma_f32_16x16x32_bf16 v[156:159], v[60:63], a[32:35], v[156:159]
    v_mfma_f32_16x16x32_bf16 v[172:175], v[60:63], a[36:39], v[172:175]
    s_waitcnt vmcnt(11)
    v_mfma_f32_16x16x32_bf16 v[96:99], v[64:67], a[40:43], v[96:99]
    s_add_u32 s46, s49, 20480
    s_waitcnt lgkmcnt(0)
    s_barrier
    v_mfma_f32_16x16x32_bf16 v[112:115], v[64:67], a[44:47], v[112:115]
    buffer_load_dwordx4 v[48:51], v14, s[32:35], s46 offen offset:0 sc1
    v_mfma_f32_16x16x32_bf16 v[128:131], v[64:67], a[48:51], v[128:131]
    ds_read_b128 v[176:179], v11 offset:0
    v_mfma_f32_16x16x32_bf16 v[144:147], v[64:67], a[52:55], v[144:147]
    ds_read_b128 v[180:183], v11 offset:20480
    v_mfma_f32_16x16x32_bf16 v[160:163], v[64:67], a[56:59], v[160:163]
    s_waitcnt vmcnt(11)
    ds_read_b128 v[184:187], v12 offset:0
    v_mfma_f32_16x16x32_bf16 v[100:103], v[68:71], a[40:43], v[100:103]
    ds_read_b128 v[188:191], v12 offset:20480
    v_mfma_f32_16x16x32_bf16 v[116:119], v[68:71], a[44:47], v[116:119]
    buffer_load_dwordx4 v[52:55], v14, s[32:35], s46 offen offset:1024 sc1
    v_mfma_f32_16x16x32_bf16 v[132:135], v[68:71], a[48:51], v[132:135]
    ds_read_b128 v[192:195], v11 offset:1024
    v_mfma_f32_16x16x32_bf16 v[148:151], v[68:71], a[52:55], v[148:151]
    ds_read_b128 v[196:199], v11 offset:21504
    v_mfma_f32_16x16x32_bf16 v[164:167], v[68:71], a[56:59], v[164:167]
    s_waitcnt vmcnt(11)
    ds_read_b128 v[200:203], v12 offset:1024
    v_mfma_f32_16x16x32_bf16 v[104:107], v[72:75], a[40:43], v[104:107]
    ds_read_b128 v[204:207], v12 offset:21504
    v_mfma_f32_16x16x32_bf16 v[120:123], v[72:75], a[44:47], v[120:123]
    buffer_load_dwordx4 v[56:59], v14, s[32:35], s46 offen offset:2048 sc1
    v_mfma_f32_16x16x32_bf16 v[136:139], v[72:75], a[48:51], v[136:139]
    ds_read_b128 v[208:211], v11 offset:2048
    s_waitcnt lgkmcnt(5)
    v_pk_add_f32 v[176:177], v[176:177], v[180:181]
    v_pk_add_f32 v[178:179], v[178:179], v[182:183]
    v_pk_add_f32 v[184:185], v[184:185], v[188:189]
    v_pk_add_f32 v[186:187], v[186:187], v[190:191]
    v_pk_add_f32 v[176:177], v[176:177], v[184:185]
    v_pk_add_f32 v[178:179], v[178:179], v[186:187]
    v_cvt_pk_bf16_f32 v180, v176, v177
    v_cvt_pk_bf16_f32 v181, v178, v179
    v_mfma_f32_16x16x32_bf16 v[152:155], v[72:75], a[52:55], v[152:155]
    ds_read_b128 v[212:215], v11 offset:22528
    v_mfma_f32_16x16x32_bf16 v[168:171], v[72:75], a[56:59], v[168:171]
    s_waitcnt vmcnt(11)
    ds_read_b128 v[216:219], v12 offset:2048
    v_mfma_f32_16x16x32_bf16 v[108:111], v[76:79], a[40:43], v[108:111]
    ds_read_b128 v[220:223], v12 offset:22528
    v_mfma_f32_16x16x32_bf16 v[124:127], v[76:79], a[44:47], v[124:127]
    buffer_load_dwordx4 v[60:63], v14, s[32:35], s46 offen offset:3072 sc1
    v_mfma_f32_16x16x32_bf16 v[140:143], v[76:79], a[48:51], v[140:143]
    ds_read_b128 v[224:227], v11 offset:3072
    s_waitcnt lgkmcnt(5)
    v_pk_add_f32 v[192:193], v[192:193], v[196:197]
    v_pk_add_f32 v[194:195], v[194:195], v[198:199]
    v_pk_add_f32 v[200:201], v[200:201], v[204:205]
    v_pk_add_f32 v[202:203], v[202:203], v[206:207]
    v_pk_add_f32 v[192:193], v[192:193], v[200:201]
    v_pk_add_f32 v[194:195], v[194:195], v[202:203]
    v_cvt_pk_bf16_f32 v182, v192, v193
    v_cvt_pk_bf16_f32 v183, v194, v195
    buffer_store_dwordx4 v[180:183], v14, s[20:23], s50 offen offset:0 sc1
    v_mfma_f32_16x16x32_bf16 v[156:159], v[76:79], a[52:55], v[156:159]
    ds_read_b128 v[228:231], v11 offset:23552
    v_mfma_f32_16x16x32_bf16 v[172:175], v[76:79], a[56:59], v[172:175]
    s_waitcnt vmcnt(12)
    ds_read_b128 v[232:235], v12 offset:3072
    v_mfma_f32_16x16x32_bf16 v[96:99], v[80:83], a[60:63], v[96:99]
    s_add_u32 s45, s49, 24576
    s_add_u32 s45, s45, s54
    ds_read_b128 v[236:239], v12 offset:23552
    v_mfma_f32_16x16x32_bf16 v[112:115], v[80:83], a[64:67], v[112:115]
    buffer_load_dwordx4 v[64:67], v14, s[32:35], s45 offen offset:0 sc1
    v_mfma_f32_16x16x32_bf16 v[128:131], v[80:83], a[68:71], v[128:131]
    ds_read_b128 v[240:243], v11 offset:4096
    s_waitcnt lgkmcnt(5)
    v_pk_add_f32 v[208:209], v[208:209], v[212:213]
    v_pk_add_f32 v[210:211], v[210:211], v[214:215]
    v_pk_add_f32 v[216:217], v[216:217], v[220:221]
    v_pk_add_f32 v[218:219], v[218:219], v[222:223]
    v_pk_add_f32 v[208:209], v[208:209], v[216:217]
    v_pk_add_f32 v[210:211], v[210:211], v[218:219]
    v_cvt_pk_bf16_f32 v212, v208, v209
    v_cvt_pk_bf16_f32 v213, v210, v211
    v_mfma_f32_16x16x32_bf16 v[144:147], v[80:83], a[72:75], v[144:147]
    ds_read_b128 v[244:247], v11 offset:24576
    v_mfma_f32_16x16x32_bf16 v[160:163], v[80:83], a[76:79], v[160:163]
    s_waitcnt vmcnt(12)
    ds_read_b128 v[248:251], v12 offset:4096
    v_mfma_f32_16x16x32_bf16 v[100:103], v[84:87], a[60:63], v[100:103]
    ds_read_b128 v[252:255], v12 offset:24576
    v_mfma_f32_16x16x32_bf16 v[116:119], v[84:87], a[64:67], v[116:119]
    buffer_load_dwordx4 v[68:71], v14, s[32:35], s45 offen offset:1024 sc1
    v_mfma_f32_16x16x32_bf16 v[132:135], v[84:87], a[68:71], v[132:135]
    s_waitcnt lgkmcnt(4)
    v_pk_add_f32 v[224:225], v[224:225], v[228:229]
    v_pk_add_f32 v[226:227], v[226:227], v[230:231]
    v_pk_add_f32 v[232:233], v[232:233], v[236:237]
    v_pk_add_f32 v[234:235], v[234:235], v[238:239]
    v_pk_add_f32 v[224:225], v[224:225], v[232:233]
    v_pk_add_f32 v[226:227], v[226:227], v[234:235]
    v_cvt_pk_bf16_f32 v214, v224, v225
    v_cvt_pk_bf16_f32 v215, v226, v227
    buffer_store_dwordx4 v[212:215], v14, s[20:23], s50 offen offset:1024 sc1
    v_mfma_f32_16x16x32_bf16 v[148:151], v[84:87], a[72:75], v[148:151]
    v_mfma_f32_16x16x32_bf16 v[164:167], v[84:87], a[76:79], v[164:167]
    s_waitcnt vmcnt(13)
    v_mfma_f32_16x16x32_bf16 v[104:107], v[88:91], a[60:63], v[104:107]
    v_mfma_f32_16x16x32_bf16 v[120:123], v[88:91], a[64:67], v[120:123]
    buffer_load_dwordx4 v[72:75], v14, s[32:35], s45 offen offset:2048 sc1
    v_mfma_f32_16x16x32_bf16 v[136:139], v[88:91], a[68:71], v[136:139]
    s_waitcnt lgkmcnt(0)
    v_pk_add_f32 v[240:241], v[240:241], v[244:245]
    v_pk_add_f32 v[242:243], v[242:243], v[246:247]
    v_pk_add_f32 v[248:249], v[248:249], v[252:253]
    v_pk_add_f32 v[250:251], v[250:251], v[254:255]
    v_pk_add_f32 v[240:241], v[240:241], v[248:249]
    v_pk_add_f32 v[242:243], v[242:243], v[250:251]
    v_cvt_pk_bf16_f32 v244, v240, v241
    v_cvt_pk_bf16_f32 v245, v242, v243
    buffer_store_dwordx2 v[244:245], v9, s[20:23], s50 offen offset:2048 sc1
    v_mfma_f32_16x16x32_bf16 v[152:155], v[88:91], a[72:75], v[152:155]
    v_mfma_f32_16x16x32_bf16 v[168:171], v[88:91], a[76:79], v[168:171]
    s_waitcnt vmcnt(14)
    v_mfma_f32_16x16x32_bf16 v[108:111], v[92:95], a[60:63], v[108:111]
    v_mfma_f32_16x16x32_bf16 v[124:127], v[92:95], a[64:67], v[124:127]
    buffer_load_dwordx4 v[76:79], v14, s[32:35], s45 offen offset:3072 sc1
    v_mfma_f32_16x16x32_bf16 v[140:143], v[92:95], a[68:71], v[140:143]
    v_mfma_f32_16x16x32_bf16 v[156:159], v[92:95], a[72:75], v[156:159]
    v_mfma_f32_16x16x32_bf16 v[172:175], v[92:95], a[76:79], v[172:175]
    s_waitcnt vmcnt(14)
    v_mfma_f32_16x16x32_bf16 v[96:99], v[32:35], a[80:83], v[96:99]
    s_add_u32 s46, s49, 28672
    v_mfma_f32_16x16x32_bf16 v[112:115], v[32:35], a[84:87], v[112:115]
    buffer_load_dwordx4 v[80:83], v14, s[32:35], s46 offen offset:0 sc1
    v_mfma_f32_16x16x32_bf16 v[128:131], v[32:35], a[88:91], v[128:131]
    v_mfma_f32_16x16x32_bf16 v[144:147], v[32:35], a[92:95], v[144:147]
    v_mfma_f32_16x16x32_bf16 v[160:163], v[32:35], a[96:99], v[160:163]
    s_waitcnt vmcnt(14)
    s_barrier
    v_mfma_f32_16x16x32_bf16 v[100:103], v[36:39], a[80:83], v[100:103]
    v_mfma_f32_16x16x32_bf16 v[116:119], v[36:39], a[84:87], v[116:119]
    buffer_load_dwordx4 v[84:87], v14, s[32:35], s46 offen offset:1024 sc1
    v_mfma_f32_16x16x32_bf16 v[132:135], v[36:39], a[88:91], v[132:135]
    v_mfma_f32_16x16x32_bf16 v[148:151], v[36:39], a[92:95], v[148:151]
    v_mfma_f32_16x16x32_bf16 v[164:167], v[36:39], a[96:99], v[164:167]
    s_waitcnt vmcnt(14)
    v_mfma_f32_16x16x32_bf16 v[104:107], v[40:43], a[80:83], v[104:107]
    v_mfma_f32_16x16x32_bf16 v[120:123], v[40:43], a[84:87], v[120:123]
    buffer_load_dwordx4 v[88:91], v14, s[32:35], s46 offen offset:2048 sc1
    v_mfma_f32_16x16x32_bf16 v[136:139], v[40:43], a[88:91], v[136:139]
    v_mfma_f32_16x16x32_bf16 v[152:155], v[40:43], a[92:95], v[152:155]
    v_mfma_f32_16x16x32_bf16 v[168:171], v[40:43], a[96:99], v[168:171]
    s_waitcnt vmcnt(14)
    v_mfma_f32_16x16x32_bf16 v[108:111], v[44:47], a[80:83], v[108:111]
    v_mfma_f32_16x16x32_bf16 v[124:127], v[44:47], a[84:87], v[124:127]
    buffer_load_dwordx4 v[92:95], v14, s[32:35], s46 offen offset:3072 sc1
    v_mfma_f32_16x16x32_bf16 v[140:143], v[44:47], a[88:91], v[140:143]
    v_mfma_f32_16x16x32_bf16 v[156:159], v[44:47], a[92:95], v[156:159]
    v_mfma_f32_16x16x32_bf16 v[172:175], v[44:47], a[96:99], v[172:175]
    s_waitcnt vmcnt(14)
    v_mfma_f32_16x16x32_bf16 v[96:99], v[48:51], a[100:103], v[96:99]
    s_add_u32 s45, s49, 32768
    v_mfma_f32_16x16x32_bf16 v[112:115], v[48:51], a[104:107], v[112:115]
    buffer_load_dwordx4 v[32:35], v14, s[32:35], s45 offen offset:0 sc1
    v_mfma_f32_16x16x32_bf16 v[128:131], v[48:51], a[108:111], v[128:131]
    v_mfma_f32_16x16x32_bf16 v[144:147], v[48:51], a[112:115], v[144:147]
    v_mfma_f32_16x16x32_bf16 v[160:163], v[48:51], a[116:119], v[160:163]
    s_waitcnt vmcnt(14)
    v_mfma_f32_16x16x32_bf16 v[100:103], v[52:55], a[100:103], v[100:103]
    v_mfma_f32_16x16x32_bf16 v[116:119], v[52:55], a[104:107], v[116:119]
    buffer_load_dwordx4 v[36:39], v14, s[32:35], s45 offen offset:1024 sc1
    v_mfma_f32_16x16x32_bf16 v[132:135], v[52:55], a[108:111], v[132:135]
    v_mfma_f32_16x16x32_bf16 v[148:151], v[52:55], a[112:115], v[148:151]
    v_mfma_f32_16x16x32_bf16 v[164:167], v[52:55], a[116:119], v[164:167]
    s_waitcnt vmcnt(14)
    v_mfma_f32_16x16x32_bf16 v[104:107], v[56:59], a[100:103], v[104:107]
    v_mfma_f32_16x16x32_bf16 v[120:123], v[56:59], a[104:107], v[120:123]
    buffer_load_dwordx4 v[40:43], v14, s[32:35], s45 offen offset:2048 sc1
    v_mfma_f32_16x16x32_bf16 v[136:139], v[56:59], a[108:111], v[136:139]
    s_waitcnt vmcnt(8)
    s_mov_b64 exec, 1
    buffer_store_dword a255, off, s[20:23], s3 sc1
    s_mov_b64 exec, -1
    v_mfma_f32_16x16x32_bf16 v[152:155], v[56:59], a[112:115], v[152:155]
    v_mfma_f32_16x16x32_bf16 v[168:171], v[56:59], a[116:119], v[168:171]
    v_mfma_f32_16x16x32_bf16 v[108:111], v[60:63], a[100:103], v[108:111]
    v_mfma_f32_16x16x32_bf16 v[124:127], v[60:63], a[104:107], v[124:127]
    buffer_load_dwordx4 v[44:47], v14, s[32:35], s45 offen offset:3072 sc1
    v_mfma_f32_16x16x32_bf16 v[140:143], v[60:63], a[108:111], v[140:143]
    v_mfma_f32_16x16x32_bf16 v[156:159], v[60:63], a[112:115], v[156:159]
    v_mfma_f32_16x16x32_bf16 v[172:175], v[60:63], a[116:119], v[172:175]
    v_mfma_f32_16x16x32_bf16 v[96:99], v[64:67], a[120:123], v[96:99]
    s_add_u32 s46, s49, 36864
    v_mfma_f32_16x16x32_bf16 v[112:115], v[64:67], a[124:127], v[112:115]
    buffer_load_dwordx4 v[48:51], v14, s[32:35], s46 offen offset:0 sc1
    v_mfma_f32_16x16x32_bf16 v[128:131], v[64:67], a[128:131], v[128:131]
    v_mfma_f32_16x16x32_bf16 v[144:147], v[64:67], a[132:135], v[144:147]
    v_mfma_f32_16x16x32_bf16 v[160:163], v[64:67], a[136:139], v[160:163]
    v_mfma_f32_16x16x32_bf16 v[100:103], v[68:71], a[120:123], v[100:103]
    v_mfma_f32_16x16x32_bf16 v[116:119], v[68:71], a[124:127], v[116:119]
    buffer_load_dwordx4 v[52:55], v14, s[32:35], s46 offen offset:1024 sc1
    v_mfma_f32_16x16x32_bf16 v[132:135], v[68:71], a[128:131], v[132:135]
    v_mfma_f32_16x16x32_bf16 v[148:151], v[68:71], a[132:135], v[148:151]
    v_mfma_f32_16x16x32_bf16 v[164:167], v[68:71], a[136:139], v[164:167]
    v_mfma_f32_16x16x32_bf16 v[104:107], v[72:75], a[120:123], v[104:107]
    v_mfma_f32_16x16x32_bf16 v[120:123], v[72:75], a[124:127], v[120:123]
    buffer_load_dwordx4 v[56:59], v14, s[32:35], s46 offen offset:2048 sc1
    v_mfma_f32_16x16x32_bf16 v[136:139], v[72:75], a[128:131], v[136:139]
    v_mfma_f32_16x16x32_bf16 v[152:155], v[72:75], a[132:135], v[152:155]
    v_mfma_f32_16x16x32_bf16 v[168:171], v[72:75], a[136:139], v[168:171]
    s_waitcnt vmcnt(12)
    v_mfma_f32_16x16x32_bf16 v[108:111], v[76:79], a[120:123], v[108:111]
    v_mfma_f32_16x16x32_bf16 v[124:127], v[76:79], a[124:127], v[124:127]
    buffer_load_dwordx4 v[60:63], v14, s[32:35], s46 offen offset:3072 sc1
    v_mfma_f32_16x16x32_bf16 v[140:143], v[76:79], a[128:131], v[140:143]
    v_mfma_f32_16x16x32_bf16 v[156:159], v[76:79], a[132:135], v[156:159]
    v_mfma_f32_16x16x32_bf16 v[172:175], v[76:79], a[136:139], v[172:175]
    s_waitcnt vmcnt(12)
    v_mfma_f32_16x16x32_bf16 v[96:99], v[80:83], a[140:143], v[96:99]
    s_add_u32 s45, s49, 40960
    v_mfma_f32_16x16x32_bf16 v[112:115], v[80:83], a[144:147], v[112:115]
    buffer_load_dwordx4 v[64:67], v14, s[32:35], s45 offen offset:0 sc1
    v_mfma_f32_16x16x32_bf16 v[128:131], v[80:83], a[148:151], v[128:131]
    v_mfma_f32_16x16x32_bf16 v[144:147], v[80:83], a[152:155], v[144:147]
    v_mfma_f32_16x16x32_bf16 v[160:163], v[80:83], a[156:159], v[160:163]
    s_waitcnt vmcnt(12)
    v_mfma_f32_16x16x32_bf16 v[100:103], v[84:87], a[140:143], v[100:103]
    v_mfma_f32_16x16x32_bf16 v[116:119], v[84:87], a[144:147], v[116:119]
    buffer_load_dwordx4 v[68:71], v14, s[32:35], s45 offen offset:1024 sc1
    v_mfma_f32_16x16x32_bf16 v[132:135], v[84:87], a[148:151], v[132:135]
    v_mfma_f32_16x16x32_bf16 v[148:151], v[84:87], a[152:155], v[148:151]
    v_mfma_f32_16x16x32_bf16 v[164:167], v[84:87], a[156:159], v[164:167]
    s_waitcnt vmcnt(12)
    v_mfma_f32_16x16x32_bf16 v[104:107], v[88:91], a[140:143], v[104:107]
    v_mfma_f32_16x16x32_bf16 v[120:123], v[88:91], a[144:147], v[120:123]
    buffer_load_dwordx4 v[72:75], v14, s[32:35], s45 offen offset:2048 sc1
    v_mfma_f32_16x16x32_bf16 v[136:139], v[88:91], a[148:151], v[136:139]
    buffer_load_dword v13, off, s[20:23], s83 sc1
    v_mfma_f32_16x16x32_bf16 v[152:155], v[88:91], a[152:155], v[152:155]
    v_mfma_f32_16x16x32_bf16 v[168:171], v[88:91], a[156:159], v[168:171]
    s_waitcnt vmcnt(13)
    v_mfma_f32_16x16x32_bf16 v[108:111], v[92:95], a[140:143], v[108:111]
    v_mfma_f32_16x16x32_bf16 v[124:127], v[92:95], a[144:147], v[124:127]
    buffer_load_dwordx4 v[76:79], v14, s[32:35], s45 offen offset:3072 sc1
    v_mfma_f32_16x16x32_bf16 v[140:143], v[92:95], a[148:151], v[140:143]
    v_mfma_f32_16x16x32_bf16 v[156:159], v[92:95], a[152:155], v[156:159]
    v_mfma_f32_16x16x32_bf16 v[172:175], v[92:95], a[156:159], v[172:175]
    s_waitcnt vmcnt(13)
    v_mfma_f32_16x16x32_bf16 v[96:99], v[32:35], a[160:163], v[96:99]
    s_add_u32 s46, s49, 45056
    v_mfma_f32_16x16x32_bf16 v[112:115], v[32:35], a[164:167], v[112:115]
    buffer_load_dwordx4 v[80:83], v14, s[32:35], s46 offen offset:0 sc1
    v_mfma_f32_16x16x32_bf16 v[128:131], v[32:35], a[168:171], v[128:131]
    v_mfma_f32_16x16x32_bf16 v[144:147], v[32:35], a[172:175], v[144:147]
    v_mfma_f32_16x16x32_bf16 v[160:163], v[32:35], a[176:179], v[160:163]
    s_waitcnt vmcnt(13)
    v_mfma_f32_16x16x32_bf16 v[100:103], v[36:39], a[160:163], v[100:103]
    v_mfma_f32_16x16x32_bf16 v[116:119], v[36:39], a[164:167], v[116:119]
    buffer_load_dwordx4 v[84:87], v14, s[32:35], s46 offen offset:1024 sc1
    v_mfma_f32_16x16x32_bf16 v[132:135], v[36:39], a[168:171], v[132:135]
    v_mfma_f32_16x16x32_bf16 v[148:151], v[36:39], a[172:175], v[148:151]
    v_mfma_f32_16x16x32_bf16 v[164:167], v[36:39], a[176:179], v[164:167]
    s_waitcnt vmcnt(13)
    v_mfma_f32_16x16x32_bf16 v[104:107], v[40:43], a[160:163], v[104:107]
    v_mfma_f32_16x16x32_bf16 v[120:123], v[40:43], a[164:167], v[120:123]
    buffer_load_dwordx4 v[88:91], v14, s[32:35], s46 offen offset:2048 sc1
    v_mfma_f32_16x16x32_bf16 v[136:139], v[40:43], a[168:171], v[136:139]
    v_mfma_f32_16x16x32_bf16 v[152:155], v[40:43], a[172:175], v[152:155]
    v_mfma_f32_16x16x32_bf16 v[168:171], v[40:43], a[176:179], v[168:171]
    s_waitcnt vmcnt(12)
    v_mfma_f32_16x16x32_bf16 v[108:111], v[44:47], a[160:163], v[108:111]
    v_mfma_f32_16x16x32_bf16 v[124:127], v[44:47], a[164:167], v[124:127]
    buffer_load_dwordx4 v[92:95], v14, s[32:35], s46 offen offset:3072 sc1
    v_mfma_f32_16x16x32_bf16 v[140:143], v[44:47], a[168:171], v[140:143]
    v_mfma_f32_16x16x32_bf16 v[156:159], v[44:47], a[172:175], v[156:159]
    v_mfma_f32_16x16x32_bf16 v[172:175], v[44:47], a[176:179], v[172:175]
    s_waitcnt vmcnt(12)
    v_mfma_f32_16x16x32_bf16 v[96:99], v[48:51], a[180:183], v[96:99]
    v_mfma_f32_16x16x32_bf16 v[112:115], v[48:51], a[184:187], v[112:115]
    v_mfma_f32_16x16x32_bf16 v[128:131], v[48:51], a[188:191], v[128:131]
    v_mfma_f32_16x16x32_bf16 v[144:147], v[48:51], a[192:195], v[144:147]
    v_mfma_f32_16x16x32_bf16 v[160:163], v[48:51], a[196:199], v[160:163]
    s_waitcnt vmcnt(11)
    v_mfma_f32_16x16x32_bf16 v[100:103], v[52:55], a[180:183], v[100:103]
    v_mfma_f32_16x16x32_bf16 v[116:119], v[52:55], a[184:187], v[116:119]
    v_mfma_f32_16x16x32_bf16 v[132:135], v[52:55], a[188:191], v[132:135]
    v_mfma_f32_16x16x32_bf16 v[148:151], v[52:55], a[192:195], v[148:151]
    v_mfma_f32_16x16x32_bf16 v[164:167], v[52:55], a[196:199], v[164:167]
    s_waitcnt vmcnt(10)
    v_mfma_f32_16x16x32_bf16 v[104:107], v[56:59], a[180:183], v[104:107]
    v_mfma_f32_16x16x32_bf16 v[120:123], v[56:59], a[184:187], v[120:123]
    v_mfma_f32_16x16x32_bf16 v[136:139], v[56:59], a[188:191], v[136:139]
    s_waitcnt vmcnt(5)
    v_cmp_ne_u32 vcc, 1, v13
    s_mov_b32 s55, 0
    s_cbranch_vccz L_ok_16
L_sp_17:
    buffer_load_dword v13, off, s[20:23], s83 sc1
    s_add_u32 s55, s55, 1
    s_cmp_gt_u32 s55, 200000
    s_cbranch_scc1 L_ok_16
    s_waitcnt vmcnt(0)
    v_cmp_ne_u32 vcc, 1, v13
    s_nop 0
    s_cbranch_vccnz L_sp_17
L_ok_16:
    buffer_load_dwordx4 v[176:179], v14, s[20:23], s48 offen sc1
    buffer_load_dwordx4 v[180:183], v14, s[20:23], s48 offen offset:1024 sc1
    buffer_load_dwordx2 v[184:185], v9, s[20:23], s48 offen offset:2048 sc1
    v_mfma_f32_16x16x32_bf16 v[152:155], v[56:59], a[192:195], v[152:155]
    v_mfma_f32_16x16x32_bf16 v[168:171], v[56:59], a[196:199], v[168:171]
    v_mfma_f32_16x16x32_bf16 v[108:111], v[60:63], a[180:183], v[108:111]
    v_mfma_f32_16x16x32_bf16 v[124:127], v[60:63], a[184:187], v[124:127]
    v_mfma_f32_16x16x32_bf16 v[140:143], v[60:63], a[188:191], v[140:143]
    v_mfma_f32_16x16x32_bf16 v[156:159], v[60:63], a[192:195], v[156:159]
    v_mfma_f32_16x16x32_bf16 v[172:175], v[60:63], a[196:199], v[172:175]
    v_mfma_f32_16x16x32_bf16 v[96:99], v[64:67], a[200:203], v[96:99]
    v_mfma_f32_16x16x32_bf16 v[100:103], v[68:71], a[200:203], v[100:103]
    v_mfma_f32_16x16x32_bf16 v[104:107], v[72:75], a[200:203], v[104:107]
    s_waitcnt vmcnt(7)
    v_mfma_f32_16x16x32_bf16 v[108:111], v[76:79], a[200:203], v[108:111]
    s_waitcnt vmcnt(6)
    v_mfma_f32_16x16x32_bf16 v[96:99], v[80:83], a[220:223], v[96:99]
    s_waitcnt vmcnt(5)
    v_mfma_f32_16x16x32_bf16 v[100:103], v[84:87], a[220:223], v[100:103]
    s_waitcnt vmcnt(4)
    v_mfma_f32_16x16x32_bf16 v[104:107], v[88:91], a[220:223], v[104:107]
    s_waitcnt vmcnt(3)
    v_mfma_f32_16x16x32_bf16 v[108:111], v[92:95], a[220:223], v[108:111]
    v_mfma_f32_16x16x32_bf16 v[112:115], v[64:67], a[204:207], v[112:115]
    v_mfma_f32_16x16x32_bf16 v[116:119], v[68:71], a[204:207], v[116:119]
    v_mfma_f32_16x16x32_bf16 v[120:123], v[72:75], a[204:207], v[120:123]
    v_mfma_f32_16x16x32_bf16 v[124:127], v[76:79], a[204:207], v[124:127]
    v_mfma_f32_16x16x32_bf16 v[112:115], v[80:83], a[224:227], v[112:115]
    ds_write_addtid_b32 v96 offset:0
    ds_write_addtid_b32 v97 offset:256
    v_mfma_f32_16x16x32_bf16 v[116:119], v[84:87], a[224:227], v[116:119]
    ds_write_addtid_b32 v98 offset:512
    ds_write_addtid_b32 v99 offset:768
    v_mfma_f32_16x16x32_bf16 v[120:123], v[88:91], a[224:227], v[120:123]
    ds_write_addtid_b32 v100 offset:5120
    ds_write_addtid_b32 v101 offset:5376
    v_mfma_f32_16x16x32_bf16 v[124:127], v[92:95], a[224:227], v[124:127]
    ds_write_addtid_b32 v102 offset:5632
    ds_write_addtid_b32 v103 offset:5888
    v_mfma_f32_16x16x32_bf16 v[128:131], v[64:67], a[208:211], v[128:131]
    ds_write_addtid_b32 v104 offset:10240
    ds_write_addtid_b32 v105 offset:10496
    v_mfma_f32_16x16x32_bf16 v[132:135], v[68:71], a[208:211], v[132:135]
    ds_write_addtid_b32 v106 offset:10752
    ds_write_addtid_b32 v107 offset:11008
    v_mfma_f32_16x16x32_bf16 v[136:139], v[72:75], a[208:211], v[136:139]
    ds_write_addtid_b32 v108 offset:15360
    ds_write_addtid_b32 v109 offset:15616
    v_mfma_f32_16x16x32_bf16 v[140:143], v[76:79], a[208:211], v[140:143]
    ds_write_addtid_b32 v110 offset:15872
    ds_write_addtid_b32 v111 offset:16128
    v_mfma_f32_16x16x32_bf16 v[128:131], v[80:83], a[228:231], v[128:131]
    ds_write_addtid_b32 v112 offset:1024
    ds_write_addtid_b32 v113 offset:1280
    v_mfma_f32_16x16x32_bf16 v[132:135], v[84:87], a[228:231], v[132:135]
    ds_write_addtid_b32 v114 offset:1536
    ds_write_addtid_b32 v115 offset:1792
    v_mfma_f32_16x16x32_bf16 v[136:139], v[88:91], a[228:231], v[136:139]
    ds_write_addtid_b32 v116 offset:6144
    ds_write_addtid_b32 v117 offset:6400
    v_mfma_f32_16x16x32_bf16 v[140:143], v[92:95], a[228:231], v[140:143]
    ds_write_addtid_b32 v118 offset:6656
    ds_write_addtid_b32 v119 offset:6912
    v_mfma_f32_16x16x32_bf16 v[144:147], v[64:67], a[212:215], v[144:147]
    ds_write_addtid_b32 v120 offset:11264
    ds_write_addtid_b32 v121 offset:11520
    v_mfma_f32_16x16x32_bf16 v[148:151], v[68:71], a[212:215], v[148:151]
    ds_write_addtid_b32 v122 offset:11776
    ds_write_addtid_b32 v123 offset:12032
    v_mfma_f32_16x16x32_bf16 v[152:155], v[72:75], a[212:215], v[152:155]
    ds_write_addtid_b32 v124 offset:16384
    ds_write_addtid_b32 v125 offset:16640
    v_mfma_f32_16x16x32_bf16 v[156:159], v[76:79], a[212:215], v[156:159]
    ds_write_addtid_b32 v126 offset:16896
    ds_write_addtid_b32 v127 offset:17152
    v_mfma_f32_16x16x32_bf16 v[144:147], v[80:83], a[232:235], v[144:147]
    ds_write_addtid_b32 v128 offset:2048
    ds_write_addtid_b32 v129 offset:2304
    v_mfma_f32_16x16x32_bf16 v[148:151], v[84:87], a[232:235], v[148:151]
    ds_write_addtid_b32 v130 offset:2560
    ds_write_addtid_b32 v131 offset:2816
    v_mfma_f32_16x16x32_bf16 v[152:155], v[88:91], a[232:235], v[152:155]
    s_waitcnt lgkmcnt(4)
    s_barrier
    v_mfma_f32_16x16x32_bf16 v[156:159], v[92:95], a[232:235], v[156:159]
    ds_read_b128 v[192:195], v11 offset:0
    ds_write_addtid_b32 v132 offset:7168
    v_mfma_f32_16x16x32_bf16 v[160:163], v[64:67], a[216:219], v[160:163]
    ds_read_b128 v[196:199], v11 offset:20480
    ds_write_addtid_b32 v133 offset:7424
    v_mfma_f32_16x16x32_bf16 v[164:167], v[68:71], a[216:219], v[164:167]
    ds_read_b128 v[200:203], v12 offset:0
    ds_write_addtid_b32 v134 offset:7680
    v_mfma_f32_16x16x32_bf16 v[168:171], v[72:75], a[216:219], v[168:171]
    ds_read_b128 v[204:207], v12 offset:20480
    ds_write_addtid_b32 v135 offset:7936
    v_mfma_f32_16x16x32_bf16 v[172:175], v[76:79], a[216:219], v[172:175]
    ds_read_b128 v[240:243], v11 offset:1024
    ds_write_addtid_b32 v136 offset:12288
    v_mfma_f32_16x16x32_bf16 v[160:163], v[80:83], a[236:239], v[160:163]
    ds_read_b128 v[244:247], v11 offset:21504
    ds_write_addtid_b32 v137 offset:12544
    v_mfma_f32_16x16x32_bf16 v[164:167], v[84:87], a[236:239], v[164:167]
    ds_read_b128 v[248:251], v12 offset:1024
    ds_write_addtid_b32 v138 offset:12800
    v_mfma_f32_16x16x32_bf16 v[168:171], v[88:91], a[236:239], v[168:171]
    ds_read_b128 v[252:255], v12 offset:21504
    ds_write_addtid_b32 v139 offset:13056
    v_mfma_f32_16x16x32_bf16 v[172:175], v[92:95], a[236:239], v[172:175]
    ds_write_addtid_b32 v140 offset:17408
    ds_write_addtid_b32 v141 offset:17664
    s_waitcnt vmcnt(0)
    v_lshlrev_b32 v186, 16, v176
    v_and_b32 v187, s59, v176
    v_pk_add_f32 v[16:17], v[16:17], v[186:187]
    v_lshlrev_b32 v186, 16, v177
    v_and_b32 v187, s59, v177
    v_pk_add_f32 v[18:19], v[18:19], v[186:187]
    s_waitcnt lgkmcnt(11)
    v_pk_add_f32 v[192:193], v[192:193], v[196:197]
    v_pk_add_f32 v[200:201], v[200:201], v[204:205]
    v_pk_add_f32 v[194:195], v[194:195], v[198:199]
    v_pk_add_f32 v[202:203], v[202:203], v[206:207]
    v_pk_add_f32 v[16:17], v[16:17], v[192:193]
    v_pk_add_f32 v[18:19], v[18:19], v[194:195]
    v_pk_add_f32 v[16:17], v[16:17], v[200:201]
    v_pk_add_f32 v[18:19], v[18:19], v[202:203]
    buffer_store_dwordx4 v[16:19], v8, s[24:27], 0 offen offset:0 sc1
    ds_write_addtid_b32 v142 offset:17920
    ds_write_addtid_b32 v143 offset:18176
    ds_write_addtid_b32 v144 offset:3072
    ds_write_addtid_b32 v145 offset:3328
    ds_write_addtid_b32 v146 offset:3584
    ds_write_addtid_b32 v147 offset:3840
    ds_write_addtid_b32 v148 offset:8192
    ds_write_addtid_b32 v149 offset:8448
    ds_write_addtid_b32 v150 offset:8704
    ds_write_addtid_b32 v151 offset:8960
    ds_write_addtid_b32 v152 offset:13312
    ds_write_addtid_b32 v153 offset:13568
    ds_write_addtid_b32 v154 offset:13824
    ds_write_addtid_b32 v155 offset:14080
    ds_write_addtid_b32 v156 offset:18432
    ds_write_addtid_b32 v157 offset:18688
    ds_write_addtid_b32 v158 offset:18944
    ds_write_addtid_b32 v159 offset:19200
    ds_write_addtid_b32 v160 offset:4096
    ds_write_addtid_b32 v161 offset:4352
    ds_write_addtid_b32 v162 offset:4608
    ds_write_addtid_b32 v163 offset:4864
    ds_write_addtid_b32 v164 offset:9216
    ds_write_addtid_b32 v165 offset:9472
    ds_write_addtid_b32 v166 offset:9728
    ds_write_addtid_b32 v167 offset:9984
    ds_write_addtid_b32 v168 offset:14336
    ds_write_addtid_b32 v169 offset:14592
    ds_write_addtid_b32 v170 offset:14848
    ds_write_addtid_b32 v171 offset:15104
    ds_write_addtid_b32 v172 offset:19456
    ds_write_addtid_b32 v173 offset:19712
    ds_write_addtid_b32 v174 offset:19968
    ds_write_addtid_b32 v175 offset:20224
    v_lshlrev_b32 v186, 16, v178
    v_and_b32 v187, s59, v178
    v_pk_add_f32 v[20:21], v[20:21], v[186:187]
    v_lshlrev_b32 v186, 16, v179
    v_and_b32 v187, s59, v179
    v_pk_add_f32 v[22:23], v[22:23], v[186:187]
    s_waitcnt lgkmcnt(14)
    v_pk_add_f32 v[240:241], v[240:241], v[244:245]
    v_pk_add_f32 v[248:249], v[248:249], v[252:253]
L_st_7:
    s_cbranch_execz L_tr_x
L_st_p7:
    s_cbranch_execz L_st_8
    v_pk_add_f32 v[242:243], v[242:243], v[246:247]
    v_pk_add_f32 v[250:251], v[250:251], v[254:255]
    v_pk_add_f32 v[20:21], v[20:21], v[240:241]
    v_pk_add_f32 v[22:23], v[22:23], v[242:243]
    v_pk_add_f32 v[20:21], v[20:21], v[248:249]
    v_pk_add_f32 v[22:23], v[22:23], v[250:251]
    buffer_store_dwordx4 v[20:23], v8, s[24:27], 0 offen offset:64 sc1
    s_waitcnt lgkmcnt(0)
    s_barrier
    ds_read_b128 v[32:35], v11 offset:2048
    ds_read_b128 v[36:39], v11 offset:22528
    ds_read_b128 v[40:43], v12 offset:2048
    ds_read_b128 v[44:47], v12 offset:22528
    ds_read_b128 v[48:51], v11 offset:3072
    ds_read_b128 v[52:55], v11 offset:23552
    ds_read_b128 v[56:59], v12 offset:3072
    ds_read_b128 v[60:63], v12 offset:23552
    ds_read_b128 v[64:67], v11 offset:4096
    ds_read_b128 v[68:71], v11 offset:24576
    ds_read_b128 v[72:75], v12 offset:4096
    ds_read_b128 v[76:79], v12 offset:24576
    v_lshlrev_b32 v186, 16, v180
    v_and_b32 v187, s59, v180
    v_pk_add_f32 v[24:25], v[24:25], v[186:187]
    v_lshlrev_b32 v186, 16, v181
    v_and_b32 v187, s59, v181
    v_pk_add_f32 v[26:27], v[26:27], v[186:187]
    s_waitcnt lgkmcnt(8)
    v_pk_add_f32 v[32:33], v[32:33], v[36:37]
    v_pk_add_f32 v[40:41], v[40:41], v[44:45]
    v_pk_add_f32 v[34:35], v[34:35], v[38:39]
    v_pk_add_f32 v[42:43], v[42:43], v[46:47]
    v_pk_add_f32 v[24:25], v[24:25], v[32:33]
    v_pk_add_f32 v[26:27], v[26:27], v[34:35]
    v_pk_add_f32 v[24:25], v[24:25], v[40:41]
    v_pk_add_f32 v[26:27], v[26:27], v[42:43]
    buffer_store_dwordx4 v[24:27], v8, s[24:27], 0 offen offset:128 sc1
    v_lshlrev_b32 v186, 16, v182
    v_and_b32 v187, s59, v182
    v_pk_add_f32 v[28:29], v[28:29], v[186:187]
    v_lshlrev_b32 v186, 16, v183
    v_and_b32 v187, s59, v183
    v_pk_add_f32 v[30:31], v[30:31], v[186:187]
    s_waitcnt lgkmcnt(4)
    v_pk_add_f32 v[48:49], v[48:49], v[52:53]
    v_pk_add_f32 v[56:57], v[56:57], v[60:61]
    v_pk_add_f32 v[50:51], v[50:51], v[54:55]
    v_pk_add_f32 v[58:59], v[58:59], v[62:63]
    v_pk_add_f32 v[28:29], v[28:29], v[48:49]
    v_pk_add_f32 v[30:31], v[30:31], v[50:51]
    v_pk_add_f32 v[28:29], v[28:29], v[56:57]
    v_pk_add_f32 v[30:31], v[30:31], v[58:59]
    buffer_store_dwordx4 v[28:31], v8, s[24:27], 0 offen offset:192 sc1
    v_lshlrev_b32 v186, 16, v184
    v_and_b32 v187, s59, v184
    v_pk_add_f32 v[4:5], v[4:5], v[186:187]
    v_lshlrev_b32 v186, 16, v185
    v_and_b32 v187, s59, v185
    v_pk_add_f32 v[6:7], v[6:7], v[186:187]
    s_waitcnt lgkmcnt(0)
    v_pk_add_f32 v[64:65], v[64:65], v[68:69]
    v_pk_add_f32 v[72:73], v[72:73], v[76:77]
    v_pk_add_f32 v[66:67], v[66:67], v[70:71]
    v_pk_add_f32 v[74:75], v[74:75], v[78:79]
    v_pk_add_f32 v[4:5], v[4:5], v[64:65]
    v_pk_add_f32 v[6:7], v[6:7], v[66:67]
    v_pk_add_f32 v[4:5], v[4:5], v[72:73]
    v_pk_add_f32 v[6:7], v[6:7], v[74:75]
    buffer_store_dwordx4 v[4:7], v8, s[24:27], 0 offen offset:256 sc1
    s_endpgm
L_fs_11:
    s_mov_b32 s57, 0x7fa5a5a5
    s_mov_b64 s[58:59], 0
    v_cmp_eq_u32 vcc, s57, v144
    s_or_b64 s[58:59], s[58:59], vcc
    v_cmp_eq_u32 vcc, s57, v145
    s_or_b64 s[58:59], s[58:59], vcc
    v_cmp_eq_u32 vcc, s57, v146
    s_or_b64 s[58:59], s[58:59], vcc
    v_cmp_eq_u32 vcc, s57, v147
    s_or_b64 s[58:59], s[58:59], vcc
    v_cmp_eq_u32 vcc, s57, v160
    s_or_b64 s[58:59], s[58:59], vcc
    v_cmp_eq_u32 vcc, s57, v161
    s_or_b64 s[58:59], s[58:59], vcc
    v_cmp_eq_u32 vcc, s57, v162
    s_or_b64 s[58:59], s[58:59], vcc
    v_cmp_eq_u32 vcc, s57, v163
    s_or_b64 s[58:59], s[58:59], vcc
    v_cmp_eq_u32 vcc, s57, v148
    s_or_b64 s[58:59], s[58:59], vcc
    v_cmp_eq_u32 vcc, s57, v149
    s_or_b64 s[58:59], s[58:59], vcc
    v_cmp_eq_u32 vcc, s57, v150
    s_or_b64 s[58:59], s[58:59], vcc
    v_cmp_eq_u32 vcc, s57, v151
    s_or_b64 s[58:59], s[58:59], vcc
    v_cmp_eq_u32 vcc, s57, v164
    s_or_b64 s[58:59], s[58:59], vcc
    v_cmp_eq_u32 vcc, s57, v165
    s_or_b64 s[58:59], s[58:59], vcc
    v_cmp_eq_u32 vcc, s57, v166
    s_or_b64 s[58:59], s[58:59], vcc
    v_cmp_eq_u32 vcc, s57, v167
    s_or_b64 s[58:59], s[58:59], vcc
    s_cbranch_scc0 L_fok_10
    s_add_u32 s55, s55, 1
    s_cmp_gt_u32 s55, 200000
    s_cbranch_scc1 L_fok_10
    s_sleep 2
    buffer_load_dwordx2 v[144:145], v91, s[24:27], 0 offen offset:896 sc1
    buffer_load_dwordx2 v[146:147], v91, s[24:27], 0 offen offset:768 sc1
    buffer_load_dwordx2 v[160:161], v91, s[24:27], 0 offen offset:640 sc1
    buffer_load_dwordx2 v[162:163], v91, s[24:27], 0 offen offset:512 sc1
    buffer_load_dwordx2 v[148:149], v91, s[24:27], 0 offen offset:384 sc1
    buffer_load_dwordx2 v[150:151], v91, s[24:27], 0 offen offset:256 sc1
    buffer_load_dwordx2 v[164:165], v91, s[24:27], 0 offen offset:128 sc1
    buffer_load_dwordx2 v[166:167], v91, s[24:27], 0 offen offset:0 sc1
    s_waitcnt vmcnt(0)
    s_branch L_fh_9
L_end:
    s_endpgm
L_y:
    s_mul_i32 s56, s41, 5
    s_add_u32 s56, s56, s42
    s_sub_u32 s18, s56, 27
    s_and_b32 s57, s40, 1
    s_lshl1_add_u32 s16, s18, s57
    s_mul_i32 s56, s16, 10240
    s_cmp_lt_u32 s40, 2
    s_cselect_b32 s12, s70, s72
    s_cselect_b32 s13, s71, s73
    s_cselect_b32 s17, 0, 0x1000
    s_add_u32 s12, s12, s56
    s_addc_u32 s13, s13, 0
    s_mov_b32 s14, 10240
    s_mov_b32 s15, 0x20000
    s_mov_b32 s20, s94
    s_mov_b32 s21, s95
    s_mov_b32 s22, 268435456
    s_mov_b32 s23, 0x20000
    s_lshl2_add_u32 s56, s18, s40
    v_mov_b32 v40, 0x7fa5a5a5
    v_mov_b32 v41, 0x7fa5a5a5
    v_mov_b32 v42, 0x7fa5a5a5
    v_mov_b32 v43, 0x7fa5a5a5
    s_lshl_b32 s57, s56, 10
    s_add_u32 s58, s57, 65536
    buffer_store_dwordx4 v[40:43], v14, s[20:23], s58 offen sc1
    v_mov_b32 v44, 0
    v_mov_b32 v45, 0
    v_mov_b32 v46, 0
    v_mov_b32 v47, 0
    s_add_u32 s58, s57, 393216
    s_add_u32 s59, s57, 4294852608
    s_cmp_lt_u32 s56, 128
    s_cselect_b32 s58, s58, s59
    s_cmp_lt_u32 s56, 144
    s_cselect_b32 s58, s58, 1073741824
    buffer_store_dwordx4 v[44:47], v14, s[20:23], s58 offen sc1
    s_cmp_lt_u32 s56, 128
    s_cselect_b32 s57, s57, 1073741824
    s_add_u32 s58, s57, 524288
    s_add_u32 s59, s57, 262144
    buffer_store_dwordx4 v[44:47], v14, s[20:23], s58 offen sc1
    buffer_store_dwordx4 v[44:47], v14, s[20:23], s59 offen sc1
    s_mov_b32 s30, 1280
    s_mov_b32 s31, 0x20000
    s_mov_b32 s28, s66
    s_mov_b32 s29, s67
    buffer_load_ushort v28, v23, s[28:31], 0 offen offset:0
    buffer_load_ushort v31, v23, s[28:31], 0 offen offset:32
    buffer_load_ushort v34, v23, s[28:31], 0 offen offset:64
    s_mov_b32 s28, s68
    s_mov_b32 s29, s69
    buffer_load_ushort v29, v23, s[28:31], 0 offen offset:0
    buffer_load_ushort v32, v23, s[28:31], 0 offen offset:32
    buffer_load_ushort v35, v23, s[28:31], 0 offen offset:64
    s_mov_b32 s28, s78
    s_mov_b32 s29, s79
    buffer_load_ushort v30, v23, s[28:31], 0 offen offset:0
    buffer_load_ushort v33, v23, s[28:31], 0 offen offset:32
    buffer_load_ushort v36, v23, s[28:31], 0 offen offset:64
    v_lshrrev_b32 v88, 5, v0
    v_mul_u32_u24 v88, 1280, v88
    v_and_b32 v89, 31, v0
    v_cmp_gt_u32 vcc, 16, v89
    v_lshl_add_u32 v88, v89, 4, v88
    v_mov_b32 v89, 0x7fff0000
    v_cndmask_b32 v89, v89, v88, vcc
    s_mul_i32 s56, s51, 2560
    s_add_u32 s32, s64, s56
    s_addc_u32 s33, s65, 0
    s_mov_b32 s34, 2560
    s_mov_b32 s35, 0x20000
    buffer_load_dwordx4 v[76:79], v88, s[32:35], 0 offen
    buffer_load_dwordx4 v[80:83], v88, s[32:35], 0 offen offset:512
    buffer_load_dwordx4 v[84:87], v89, s[32:35], 0 offen offset:1024
    s_mul_i32 s56, s40, 40
    s_add_u32 s56, s56, s18
    s_add_u32 s72, s56, 864
    s_cmp_lt_u32 s72, 540
    s_cselect_b32 s56, 0, 540
    s_cselect_b32 s24, s88, s74
    s_cselect_b32 s25, s89, s75
    s_cselect_b32 s28, s88, s76
    s_cselect_b32 s29, s89, s77
    s_cselect_b32 s55, 20480, 0
    s_add_u32 s47, s55, 20480
    s_sub_u32 s56, s72, s56
    s_mul_i32 s58, s56, 6554
    s_lshr_b32 s58, s58, 16
    s_mul_i32 s57, s58, 10
    s_sub_u32 s59, s56, s57
    s_mul_i32 s56, s58, s47
    s_lshl_b32 s57, s59, 7
    s_add_u32 s56, s56, s57
    s_cmp_lt_u32 s72, 940
    s_cselect_b32 s56, s56, 0
    s_cselect_b32 s26, 19328, 0
    s_cselect_b32 s30, 19328, 0
    s_add_u32 s24, s24, s56
    s_addc_u32 s25, s25, 0
    s_add_u32 s56, s56, s55
    s_add_u32 s28, s28, s56
    s_addc_u32 s29, s29, 0
    s_mov_b32 s27, 0x20000
    s_add_u32 m0, s48, 0
    s_mov_b32 s47, 0
    buffer_load_dwordx4 v90, s[24:27], s47 offen lds
    s_add_u32 m0, s48, 1024
    s_mov_b32 s47, 10240
    buffer_load_dwordx4 v90, s[24:27], s47 offen lds
    s_add_u32 m0, s48, 2048
    s_mov_b32 s47, 0
    buffer_load_dwordx4 v90, s[28:31], s47 offen lds
    s_add_u32 m0, s48, 3072
    s_mov_b32 s47, 10240
    buffer_load_dwordx4 v90, s[28:31], s47 offen lds
    buffer_load_dwordx4 v[216:219], v90, s[12:15], 0 offen offset:0
    buffer_load_dwordx4 v[220:223], v90, s[12:15], 0 offen offset:128
    buffer_load_dwordx4 v[224:227], v90, s[12:15], 0 offen offset:256
    buffer_load_dwordx4 v[228:231], v90, s[12:15], 0 offen offset:384
    s_cmp_ge_u32 s72, 540
    s_cbranch_scc1 L_jS_18
    v_lshrrev_b32 v24, 2, v0
    v_and_b32 v25, 3, v0
    s_lshr_b32 s56, s58, 1
    s_and_b32 s57, s58, 1
    s_mul_i32 s57, s57, 12
    s_lshr_b32 s58, s56, 2
    s_add_u32 s57, s57, s58
    s_and_b32 s56, s56, 3
    s_mul_i32 s56, s56, 24
    s_add_u32 s56, s56, s57
    s_mul_i32 s56, s56, 5120
    s_lshl_b32 s57, s59, 12
    s_add_u32 s56, s56, s57
    s_mul_i32 s59, s59, 208
    s_add_u32 s57, s59, 0
    s_lshr_b32 s57, s57, 8
    s_mul_i32 s57, s57, 486400
    s_add_u32 s57, s57, s56
    s_add_u32 s82, s57, 1048576
    s_add_u32 s57, s59, 52
    s_lshr_b32 s57, s57, 8
    s_mul_i32 s57, s57, 486400
    s_add_u32 s57, s57, s56
    s_add_u32 s83, s57, 1049600
    s_add_u32 s57, s59, 104
    s_lshr_b32 s57, s57, 8
    s_mul_i32 s57, s57, 486400
    s_add_u32 s57, s57, s56
    s_add_u32 s100, s57, 1050624
    s_add_u32 s57, s59, 156
    s_lshr_b32 s57, s57, 8
    s_mul_i32 s57, s57, 486400
    s_add_u32 s57, s57, s56
    s_add_u32 s101, s57, 1051648
    s_branch L_jn_19
L_jS_18:
    v_and_b32 v24, 15, v0
    v_lshrrev_b32 v25, 4, v0
    s_mul_i32 s57, s58, 52
    s_lshr_b32 s57, s57, 8
    s_mul_i32 s56, s57, 486400
    s_lshl_b32 s57, s58, 10
    s_add_u32 s56, s56, s57
    s_and_b32 s57, s59, 1
    s_mul_i32 s57, s57, 12
    s_lshr_b32 s59, s59, 1
    s_add_u32 s59, s59, s57
    s_mul_i32 s59, s59, 5120
    s_add_u32 s56, s56, s59
    s_cmp_lt_u32 s72, 940
    s_cselect_b32 s56, s56, 1073741824
    s_add_u32 s82, s56, 1084416
    s_add_u32 s83, s56, 1207296
    s_add_u32 s100, s56, 1330176
    s_add_u32 s101, s56, 1453056
L_jn_19:
    v_lshlrev_b32 v25, 3, v25
    v_lshl_add_u32 v24, v24, 7, v25
    v_add_u32 v91, s48, v24
    s_cmp_eq_u32 s40, 3
    s_cselect_b32 s54, 1073741824, 0
    s_mov_b32 s60, 0xffff0000
    s_mov_b32 s61, 0
    s_mov_b32 s62, 0
    s_mov_b32 s63, 0xffff
    s_mov_b32 s96, 0
    s_mov_b32 s97, 0xffff0000
    s_lshl_b32 s56, s49, 5
    s_add_u32 s56, s56, s42
    s_lshl_b32 s56, s56, 7
    s_add_u32 s3, s56, 262144
    s_bfe_u32 s56, s2, 0x20001
    s_bfe_u32 s57, s2, 0x20003
    s_lshl2_add_u32 s56, s56, s57
    s_lshr_b32 s53, s2, 5
    s_and_b32 s57, s2, 1
    s_lshl1_add_u32 s52, s56, s57
    buffer_load_dwordx4 v[232:235], v90, s[12:15], 0 offen offset:512
    v_and_b32 v22, 15, v0
    v_lshrrev_b32 v23, 1, v22
    v_xor_b32 v23, v23, v18
    v_lshlrev_b32 v23, 4, v23
    v_lshl_add_u32 v24, v22, 7, v23
    v_add_u32 v6, s43, v24
    v_xor_b32 v7, 64, v6
    v_lshrrev_b32 v25, 3, v22
    v_mul_u32_u24 v25, 4096, v25
    v_add_u32 v24, v24, v25
    v_add_u32 v8, 65536, v24
    v_xor_b32 v9, 64, v8
    v_lshrrev_b32 v23, 2, v22
    v_and_b32 v24, 3, v0
    v_lshlrev_b32 v24, 3, v24
    v_lshl_add_u32 v24, v23, 7, v24
    v_lshrrev_b32 v25, 1, v18
    v_mul_u32_u24 v25, 5120, v25
    v_and_b32 v26, 1, v18
    v_lshl_add_u32 v25, v26, 10, v25
    v_add_u32 v25, v24, v25
    v_lshrrev_b32 v23, 1, v23
    v_lshl_or_b32 v23, v26, 1, v23
    v_lshl_add_u32 v25, v23, 5, v25
    v_add_u32 v10, 65536, v25
    s_andn2_b32 s56, 1, s40
    s_lshl_b32 s56, s56, 6
    v_xor_b32 v10, s56, v10
    v_xor_b32 v11, 32, v10
    v_xor_b32 v12, 64, v10
    v_xor_b32 v13, 0x60, v10
    buffer_load_dwordx4 v[236:239], v90, s[12:15], 0 offen offset:640
    s_mov_b32 s68, s92
    s_mov_b32 s69, s93
    s_mov_b32 s70, 256
    s_mov_b32 s71, 0x20000
    s_lshl_b32 s56, s40, 11
    s_add_u32 s66, s56, 16384
    s_and_b32 s56, s2, 7
    s_lshl_b32 s56, s56, 5
    s_lshr_b32 s57, s2, 3
    s_add_u32 s56, s56, s57
    s_lshl_b32 s56, s56, 5
    s_add_u32 s56, s56, 16384
    s_cmp_eq_u32 s40, 0
    s_cselect_b32 s67, s56, 1073741824
    v_accvgpr_write_b32 a255, 1
    v_lshlrev_b32 v92, 5, v0
    s_mov_b64 exec, 0
    s_cmp_eq_u32 s40, 0
    s_cbranch_scc1 L_st_q
    s_cmp_eq_u32 s40, 1
    s_cbranch_scc1 L_st_p7
    s_cmp_eq_u32 s40, 2
    s_cbranch_scc1 L_st_10
    s_branch L_tr_y
L_tr_y:
    s_mov_b64 exec, -1
    s_nop 0
    s_nop 0
    s_waitcnt vmcnt(22)
    s_barrier
    s_cmp_eq_u32 s40, 0
    s_cselect_b32 s56, 0, 1073741824
    s_mov_b64 exec, 1
    buffer_atomic_add a255, off, s[68:71], s56
    s_mov_b64 exec, -1
    s_waitcnt vmcnt(16)
    v_lshlrev_b32 v18, 16, v30
    v_mul_f32 v18, 0x3fb8aa3b, v18
    v_exp_f32 v18, v18
    v_lshlrev_b32 v16, 16, v28
    v_lshlrev_b32 v17, 16, v29
    v_cvt_pk_bf16_f32 v18, v18, v18
    v_lshlrev_b32 v18, 16, v18
    v_mul_f32 v19, v18, v16
    v_mul_f32 v20, v18, v17
    v_mul_f32 v19, 0x3fb8aa3b, v19
    v_mul_f32 v20, 0.15915494, v20
    v_exp_f32 v19, v19
    v_rndne_f32 v21, v20
    v_sub_f32 v20, v20, v21
    v_cos_f32 v21, v20
    v_sin_f32 v22, v20
    v_mul_f32 v23, v16, v16
    v_fmac_f32 v23, v17, v17
    v_mul_f32 v64, v19, v21
    v_mul_f32 v65, v19, v22
    v_rcp_f32 v23, v23
    v_add_f32 v24, -1.0, v64
    v_mov_b32 v25, v65
    v_add_f32 v23, v23, v23
    v_mul_f32 v26, v16, v23
    v_mul_f32 v27, -v17, v23
    v_pk_mul_f32 v[66:67], v[26:27], v[24:25] op_sel_hi:[1,0]
    v_pk_fma_f32 v[66:67], v[26:27], v[24:25], v[66:67] op_sel:[1,1,0] op_sel_hi:[0,1,1] neg_lo:[1,0,0]
    buffer_load_dwordx4 v[240:243], v90, s[12:15], 0 offen offset:768
    v_pk_mul_f32 v[16:17], v[64:65], v[64:65] op_sel_hi:[1,0]
    v_pk_fma_f32 v[16:17], v[64:65], v[64:65], v[16:17] op_sel:[1,1,0] op_sel_hi:[0,1,1] neg_lo:[1,0,0]
    v_pk_mul_f32 v[18:19], v[16:17], v[16:17] op_sel_hi:[1,0]
    v_pk_fma_f32 v[18:19], v[16:17], v[16:17], v[18:19] op_sel:[1,1,0] op_sel_hi:[0,1,1] neg_lo:[1,0,0]
    v_pk_mul_f32 v[16:17], v[18:19], v[18:19] op_sel_hi:[1,0]
    v_pk_fma_f32 v[16:17], v[18:19], v[18:19], v[16:17] op_sel:[1,1,0] op_sel_hi:[0,1,1] neg_lo:[1,0,0]
    v_pk_mul_f32 v[68:69], v[16:17], v[16:17] op_sel_hi:[1,0]
    v_pk_fma_f32 v[68:69], v[16:17], v[16:17], v[68:69] op_sel:[1,1,0] op_sel_hi:[0,1,1] neg_lo:[1,0,0]
    v_pk_mul_f32 v[18:19], v[68:69], v[68:69] op_sel_hi:[1,0]
    v_pk_fma_f32 v[18:19], v[68:69], v[68:69], v[18:19] op_sel:[1,1,0] op_sel_hi:[0,1,1] neg_lo:[1,0,0]
    v_pk_mul_f32 v[20:21], v[18:19], v[68:69] op_sel_hi:[1,0]
    v_pk_fma_f32 v[20:21], v[18:19], v[68:69], v[20:21] op_sel:[1,1,0] op_sel_hi:[0,1,1] neg_lo:[1,0,0]
    v_pk_mul_f32 v[70:71], v[18:19], v[18:19] op_sel_hi:[1,0]
    v_pk_fma_f32 v[70:71], v[18:19], v[18:19], v[70:71] op_sel:[1,1,0] op_sel_hi:[0,1,1] neg_lo:[1,0,0]
    v_pk_mul_f32 v[16:17], v[70:71], v[70:71] op_sel_hi:[1,0]
    v_pk_fma_f32 v[16:17], v[70:71], v[70:71], v[16:17] op_sel:[1,1,0] op_sel_hi:[0,1,1] neg_lo:[1,0,0]
    buffer_load_dwordx4 v[244:247], v90, s[12:15], 0 offen offset:896
    v_pk_mul_f32 v[22:23], v[16:17], v[16:17] op_sel_hi:[1,0]
    v_pk_fma_f32 v[22:23], v[16:17], v[16:17], v[22:23] op_sel:[1,1,0] op_sel_hi:[0,1,1] neg_lo:[1,0,0]
    v_pk_mul_f32 v[16:17], v[22:23], v[22:23] op_sel_hi:[1,0]
    v_pk_fma_f32 v[16:17], v[22:23], v[22:23], v[16:17] op_sel:[1,1,0] op_sel_hi:[0,1,1] neg_lo:[1,0,0]
    v_pk_mul_f32 v[22:23], v[16:17], v[16:17] op_sel_hi:[1,0]
    v_pk_fma_f32 v[22:23], v[16:17], v[16:17], v[22:23] op_sel:[1,1,0] op_sel_hi:[0,1,1] neg_lo:[1,0,0]
    v_pk_mul_f32 v[24:25], v[22:23], v[16:17] op_sel_hi:[1,0]
    v_pk_fma_f32 v[24:25], v[22:23], v[16:17], v[24:25] op_sel:[1,1,0] op_sel_hi:[0,1,1] neg_lo:[1,0,0]
    v_cndmask_b32 v72, 1.0, v68, s[60:61]
    v_cndmask_b32 v72, v72, v18, s[62:63]
    v_cndmask_b32 v72, v72, v20, s[96:97]
    v_cndmask_b32 v74, v24, v22, s[60:61]
    v_cndmask_b32 v74, v74, v16, s[62:63]
    v_cndmask_b32 v74, v74, 1.0, s[96:97]
    v_cndmask_b32 v73, 0, v69, s[60:61]
    v_cndmask_b32 v73, v73, v19, s[62:63]
    v_cndmask_b32 v73, v73, v21, s[96:97]
    v_cndmask_b32 v75, v25, v23, s[60:61]
    v_cndmask_b32 v75, v75, v17, s[62:63]
    v_cndmask_b32 v75, v75, 0, s[96:97]
    buffer_load_dwordx4 v[248:251], v90, s[12:15], 0 offen offset:1024
    s_waitcnt vmcnt(18)
    v_lshlrev_b32 v18, 16, v33
    v_mul_f32 v18, 0x3fb8aa3b, v18
    v_exp_f32 v18, v18
    v_lshlrev_b32 v16, 16, v31
    v_lshlrev_b32 v17, 16, v32
    v_cvt_pk_bf16_f32 v18, v18, v18
    v_lshlrev_b32 v18, 16, v18
    v_mul_f32 v19, v18, v16
    v_mul_f32 v20, v18, v17
    v_mul_f32 v19, 0x3fb8aa3b, v19
    v_mul_f32 v20, 0.15915494, v20
    v_exp_f32 v19, v19
    v_rndne_f32 v21, v20
    v_sub_f32 v20, v20, v21
    v_cos_f32 v21, v20
    v_sin_f32 v22, v20
    v_mul_f32 v23, v16, v16
    v_fmac_f32 v23, v17, v17
    v_mul_f32 v192, v19, v21
    v_mul_f32 v193, v19, v22
    v_rcp_f32 v23, v23
    v_add_f32 v24, -1.0, v192
    v_mov_b32 v25, v193
    v_add_f32 v23, v23, v23
    v_mul_f32 v26, v16, v23
    v_mul_f32 v27, -v17, v23
    v_pk_mul_f32 v[194:195], v[26:27], v[24:25] op_sel_hi:[1,0]
    v_pk_fma_f32 v[194:195], v[26:27], v[24:25], v[194:195] op_sel:[1,1,0] op_sel_hi:[0,1,1] neg_lo:[1,0,0]
    buffer_load_dwordx4 v[252:255], v90, s[12:15], 0 offen offset:1152
    v_pk_mul_f32 v[16:17], v[192:193], v[192:193] op_sel_hi:[1,0]
    v_pk_fma_f32 v[16:17], v[192:193], v[192:193], v[16:17] op_sel:[1,1,0] op_sel_hi:[0,1,1] neg_lo:[1,0,0]
    v_pk_mul_f32 v[18:19], v[16:17], v[16:17] op_sel_hi:[1,0]
    v_pk_fma_f32 v[18:19], v[16:17], v[16:17], v[18:19] op_sel:[1,1,0] op_sel_hi:[0,1,1] neg_lo:[1,0,0]
    v_pk_mul_f32 v[16:17], v[18:19], v[18:19] op_sel_hi:[1,0]
    v_pk_fma_f32 v[16:17], v[18:19], v[18:19], v[16:17] op_sel:[1,1,0] op_sel_hi:[0,1,1] neg_lo:[1,0,0]
    v_pk_mul_f32 v[196:197], v[16:17], v[16:17] op_sel_hi:[1,0]
    v_pk_fma_f32 v[196:197], v[16:17], v[16:17], v[196:197] op_sel:[1,1,0] op_sel_hi:[0,1,1] neg_lo:[1,0,0]
    v_pk_mul_f32 v[18:19], v[196:197], v[196:197] op_sel_hi:[1,0]
    v_pk_fma_f32 v[18:19], v[196:197], v[196:197], v[18:19] op_sel:[1,1,0] op_sel_hi:[0,1,1] neg_lo:[1,0,0]
    v_pk_mul_f32 v[20:21], v[18:19], v[196:197] op_sel_hi:[1,0]
    v_pk_fma_f32 v[20:21], v[18:19], v[196:197], v[20:21] op_sel:[1,1,0] op_sel_hi:[0,1,1] neg_lo:[1,0,0]
    v_pk_mul_f32 v[198:199], v[18:19], v[18:19] op_sel_hi:[1,0]
    v_pk_fma_f32 v[198:199], v[18:19], v[18:19], v[198:199] op_sel:[1,1,0] op_sel_hi:[0,1,1] neg_lo:[1,0,0]
    v_pk_mul_f32 v[16:17], v[198:199], v[198:199] op_sel_hi:[1,0]
    v_pk_fma_f32 v[16:17], v[198:199], v[198:199], v[16:17] op_sel:[1,1,0] op_sel_hi:[0,1,1] neg_lo:[1,0,0]
    s_add_u32 m0, s44, 0
    s_mov_b32 s46, 0
    buffer_load_dwordx4 v3, s[8:11], s46 offen lds
    v_pk_mul_f32 v[22:23], v[16:17], v[16:17] op_sel_hi:[1,0]
    v_pk_fma_f32 v[22:23], v[16:17], v[16:17], v[22:23] op_sel:[1,1,0] op_sel_hi:[0,1,1] neg_lo:[1,0,0]
    v_pk_mul_f32 v[16:17], v[22:23], v[22:23] op_sel_hi:[1,0]
    v_pk_fma_f32 v[16:17], v[22:23], v[22:23], v[16:17] op_sel:[1,1,0] op_sel_hi:[0,1,1] neg_lo:[1,0,0]
    v_pk_mul_f32 v[22:23], v[16:17], v[16:17] op_sel_hi:[1,0]
    v_pk_fma_f32 v[22:23], v[16:17], v[16:17], v[22:23] op_sel:[1,1,0] op_sel_hi:[0,1,1] neg_lo:[1,0,0]
    v_pk_mul_f32 v[24:25], v[22:23], v[16:17] op_sel_hi:[1,0]
    v_pk_fma_f32 v[24:25], v[22:23], v[16:17], v[24:25] op_sel:[1,1,0] op_sel_hi:[0,1,1] neg_lo:[1,0,0]
    v_cndmask_b32 v200, 1.0, v196, s[60:61]
    v_cndmask_b32 v200, v200, v18, s[62:63]
    v_cndmask_b32 v200, v200, v20, s[96:97]
    v_cndmask_b32 v202, v24, v22, s[60:61]
    v_cndmask_b32 v202, v202, v16, s[62:63]
    v_cndmask_b32 v202, v202, 1.0, s[96:97]
    v_cndmask_b32 v201, 0, v197, s[60:61]
    v_cndmask_b32 v201, v201, v19, s[62:63]
    v_cndmask_b32 v201, v201, v21, s[96:97]
    v_cndmask_b32 v203, v25, v23, s[60:61]
    v_cndmask_b32 v203, v203, v17, s[62:63]
    v_cndmask_b32 v203, v203, 0, s[96:97]
    s_add_u32 m0, s44, 1024
    s_mov_b32 s45, 20480
    buffer_load_dwordx4 v3, s[8:11], s45 offen lds
    s_waitcnt vmcnt(20)
    v_lshlrev_b32 v18, 16, v36
    v_mul_f32 v18, 0x3fb8aa3b, v18
    v_exp_f32 v18, v18
    v_lshlrev_b32 v16, 16, v34
    v_lshlrev_b32 v17, 16, v35
    v_cvt_pk_bf16_f32 v18, v18, v18
    v_lshlrev_b32 v18, 16, v18
    v_mul_f32 v19, v18, v16
    v_mul_f32 v20, v18, v17
    v_mul_f32 v19, 0x3fb8aa3b, v19
    v_mul_f32 v20, 0.15915494, v20
    v_exp_f32 v19, v19
    v_rndne_f32 v21, v20
    v_sub_f32 v20, v20, v21
    v_cos_f32 v21, v20
    v_sin_f32 v22, v20
    v_mul_f32 v23, v16, v16
    v_fmac_f32 v23, v17, v17
    v_mul_f32 v204, v19, v21
    v_mul_f32 v205, v19, v22
    v_rcp_f32 v23, v23
    v_add_f32 v24, -1.0, v204
    v_mov_b32 v25, v205
    v_add_f32 v23, v23, v23
    v_mul_f32 v26, v16, v23
    v_mul_f32 v27, -v17, v23
    v_pk_mul_f32 v[206:207], v[26:27], v[24:25] op_sel_hi:[1,0]
    v_pk_fma_f32 v[206:207], v[26:27], v[24:25], v[206:207] op_sel:[1,1,0] op_sel_hi:[0,1,1] neg_lo:[1,0,0]
    s_add_u32 m0, s44, 2048
    s_mov_b32 s46, 40960
    buffer_load_dwordx4 v3, s[8:11], s46 offen lds
    v_pk_mul_f32 v[16:17], v[204:205], v[204:205] op_sel_hi:[1,0]
    v_pk_fma_f32 v[16:17], v[204:205], v[204:205], v[16:17] op_sel:[1,1,0] op_sel_hi:[0,1,1] neg_lo:[1,0,0]
    v_pk_mul_f32 v[18:19], v[16:17], v[16:17] op_sel_hi:[1,0]
    v_pk_fma_f32 v[18:19], v[16:17], v[16:17], v[18:19] op_sel:[1,1,0] op_sel_hi:[0,1,1] neg_lo:[1,0,0]
    v_pk_mul_f32 v[16:17], v[18:19], v[18:19] op_sel_hi:[1,0]
    v_pk_fma_f32 v[16:17], v[18:19], v[18:19], v[16:17] op_sel:[1,1,0] op_sel_hi:[0,1,1] neg_lo:[1,0,0]
    v_pk_mul_f32 v[208:209], v[16:17], v[16:17] op_sel_hi:[1,0]
    v_pk_fma_f32 v[208:209], v[16:17], v[16:17], v[208:209] op_sel:[1,1,0] op_sel_hi:[0,1,1] neg_lo:[1,0,0]
    v_pk_mul_f32 v[18:19], v[208:209], v[208:209] op_sel_hi:[1,0]
    v_pk_fma_f32 v[18:19], v[208:209], v[208:209], v[18:19] op_sel:[1,1,0] op_sel_hi:[0,1,1] neg_lo:[1,0,0]
    v_pk_mul_f32 v[20:21], v[18:19], v[208:209] op_sel_hi:[1,0]
    v_pk_fma_f32 v[20:21], v[18:19], v[208:209], v[20:21] op_sel:[1,1,0] op_sel_hi:[0,1,1] neg_lo:[1,0,0]
    v_pk_mul_f32 v[210:211], v[18:19], v[18:19] op_sel_hi:[1,0]
    v_pk_fma_f32 v[210:211], v[18:19], v[18:19], v[210:211] op_sel:[1,1,0] op_sel_hi:[0,1,1] neg_lo:[1,0,0]
    v_pk_mul_f32 v[16:17], v[210:211], v[210:211] op_sel_hi:[1,0]
    v_pk_fma_f32 v[16:17], v[210:211], v[210:211], v[16:17] op_sel:[1,1,0] op_sel_hi:[0,1,1] neg_lo:[1,0,0]
    s_add_u32 m0, s43, 0
    s_mov_b32 s45, 0
    buffer_load_dwordx4 v1, s[4:7], s45 offen lds
    v_pk_mul_f32 v[22:23], v[16:17], v[16:17] op_sel_hi:[1,0]
    v_pk_fma_f32 v[22:23], v[16:17], v[16:17], v[22:23] op_sel:[1,1,0] op_sel_hi:[0,1,1] neg_lo:[1,0,0]
    v_pk_mul_f32 v[16:17], v[22:23], v[22:23] op_sel_hi:[1,0]
    v_pk_fma_f32 v[16:17], v[22:23], v[22:23], v[16:17] op_sel:[1,1,0] op_sel_hi:[0,1,1] neg_lo:[1,0,0]
    v_pk_mul_f32 v[22:23], v[16:17], v[16:17] op_sel_hi:[1,0]
    v_pk_fma_f32 v[22:23], v[16:17], v[16:17], v[22:23] op_sel:[1,1,0] op_sel_hi:[0,1,1] neg_lo:[1,0,0]
    v_pk_mul_f32 v[24:25], v[22:23], v[16:17] op_sel_hi:[1,0]
    v_pk_fma_f32 v[24:25], v[22:23], v[16:17], v[24:25] op_sel:[1,1,0] op_sel_hi:[0,1,1] neg_lo:[1,0,0]
    v_cndmask_b32 v212, 1.0, v208, s[60:61]
    v_cndmask_b32 v212, v212, v18, s[62:63]
    v_cndmask_b32 v212, v212, v20, s[96:97]
    v_cndmask_b32 v214, v24, v22, s[60:61]
    v_cndmask_b32 v214, v214, v16, s[62:63]
    v_cndmask_b32 v214, v214, 1.0, s[96:97]
    v_cndmask_b32 v213, 0, v209, s[60:61]
    v_cndmask_b32 v213, v213, v19, s[62:63]
    v_cndmask_b32 v213, v213, v21, s[96:97]
    v_cndmask_b32 v215, v25, v23, s[60:61]
    v_cndmask_b32 v215, v215, v17, s[62:63]
    v_cndmask_b32 v215, v215, 0, s[96:97]
    buffer_load_dwordx4 v2, s[4:7], s45 offen offset:1024 lds
    s_waitcnt vmcnt(20)
    s_mov_b32 s58, 0x3f803f80
    s_mov_b32 s59, 0xffff0000
    v_mov_b32 v38, 0
    v_dot2_f32_bf16 v38, v76, s58, v38
    v_dot2_f32_bf16 v38, v77, s58, v38
    v_dot2_f32_bf16 v38, v78, s58, v38
    v_dot2_f32_bf16 v38, v79, s58, v38
    v_dot2_f32_bf16 v38, v80, s58, v38
    v_dot2_f32_bf16 v38, v81, s58, v38
    v_dot2_f32_bf16 v38, v82, s58, v38
    v_dot2_f32_bf16 v38, v83, s58, v38
    v_dot2_f32_bf16 v38, v84, s58, v38
    v_dot2_f32_bf16 v38, v85, s58, v38
    v_dot2_f32_bf16 v38, v86, s58, v38
    v_dot2_f32_bf16 v38, v87, s58, v38
    s_add_u32 m0, s43, 2048
    s_mov_b32 s46, 5120
    buffer_load_dwordx4 v1, s[4:7], s46 offen lds
    s_nop 2
    v_add_f32_dpp v38, v38, v38 quad_perm:[1,0,3,2] row_mask:0xf bank_mask:0xf
    s_nop 1
    v_add_f32_dpp v38, v38, v38 quad_perm:[2,3,0,1] row_mask:0xf bank_mask:0xf
    s_nop 1
    v_add_f32_dpp v38, v38, v38 row_half_mirror row_mask:0xf bank_mask:0xf
    s_nop 1
    v_add_f32_dpp v38, v38, v38 row_mirror row_mask:0xf bank_mask:0xf
    s_nop 1
    v_mov_b32 v39, v38
    s_nop 1
    v_permlane16_swap_b32 v38, v39
    s_nop 0
    v_add_f32 v38, v38, v39
    v_mul_f32 v38, -0.0015625, v38
    v_mov_b32 v40, 0
    v_mov_b32 v41, 0
    v_mov_b32 v42, 0
    v_mov_b32 v43, 0
    v_lshlrev_b32 v44, 16, v76
    v_and_b32 v45, s59, v76
    v_pk_add_f32 v[44:45], v[44:45], v[38:39] op_sel_hi:[1,0]
    v_pk_fma_f32 v[40:41], v[44:45], v[44:45], v[40:41]
    buffer_load_dwordx4 v2, s[4:7], s46 offen offset:1024 lds
    v_lshlrev_b32 v46, 16, v77
    v_and_b32 v47, s59, v77
    v_pk_add_f32 v[46:47], v[46:47], v[38:39] op_sel_hi:[1,0]
    v_pk_fma_f32 v[40:41], v[46:47], v[46:47], v[40:41]
    v_lshlrev_b32 v44, 16, v78
    v_and_b32 v45, s59, v78
    v_pk_add_f32 v[44:45], v[44:45], v[38:39] op_sel_hi:[1,0]
    v_pk_fma_f32 v[40:41], v[44:45], v[44:45], v[40:41]
    v_lshlrev_b32 v46, 16, v79
    v_and_b32 v47, s59, v79
    v_pk_add_f32 v[46:47], v[46:47], v[38:39] op_sel_hi:[1,0]
    v_pk_fma_f32 v[40:41], v[46:47], v[46:47], v[40:41]
    v_lshlrev_b32 v44, 16, v80
    v_and_b32 v45, s59, v80
    v_pk_add_f32 v[44:45], v[44:45], v[38:39] op_sel_hi:[1,0]
    v_pk_fma_f32 v[40:41], v[44:45], v[44:45], v[40:41]
    s_add_u32 m0, s43, 4096
    s_mov_b32 s45, 10240
    buffer_load_dwordx4 v1, s[4:7], s45 offen lds
    v_lshlrev_b32 v46, 16, v81
    v_and_b32 v47, s59, v81
    v_pk_add_f32 v[46:47], v[46:47], v[38:39] op_sel_hi:[1,0]
    v_pk_fma_f32 v[40:41], v[46:47], v[46:47], v[40:41]
    v_lshlrev_b32 v44, 16, v82
    v_and_b32 v45, s59, v82
    v_pk_add_f32 v[44:45], v[44:45], v[38:39] op_sel_hi:[1,0]
    v_pk_fma_f32 v[40:41], v[44:45], v[44:45], v[40:41]
    v_lshlrev_b32 v46, 16, v83
    v_and_b32 v47, s59, v83
    v_pk_add_f32 v[46:47], v[46:47], v[38:39] op_sel_hi:[1,0]
L_st_8:
    s_cbranch_execz L_st_9
    v_pk_fma_f32 v[40:41], v[46:47], v[46:47], v[40:41]
    v_lshlrev_b32 v44, 16, v84
    v_and_b32 v45, s59, v84
    v_pk_add_f32 v[44:45], v[44:45], v[38:39] op_sel_hi:[1,0]
    v_pk_fma_f32 v[42:43], v[44:45], v[44:45], v[42:43]
    buffer_load_dwordx4 v2, s[4:7], s45 offen offset:1024 lds
    v_lshlrev_b32 v46, 16, v85
    v_and_b32 v47, s59, v85
    v_pk_add_f32 v[46:47], v[46:47], v[38:39] op_sel_hi:[1,0]
    v_pk_fma_f32 v[42:43], v[46:47], v[46:47], v[42:43]
    v_lshlrev_b32 v44, 16, v86
    v_and_b32 v45, s59, v86
    v_pk_add_f32 v[44:45], v[44:45], v[38:39] op_sel_hi:[1,0]
    v_pk_fma_f32 v[42:43], v[44:45], v[44:45], v[42:43]
    v_lshlrev_b32 v46, 16, v87
    v_and_b32 v47, s59, v87
    v_pk_add_f32 v[46:47], v[46:47], v[38:39] op_sel_hi:[1,0]
    v_pk_fma_f32 v[42:43], v[46:47], v[46:47], v[42:43]
    v_and_b32 v44, 31, v0
    v_cmp_gt_u32 vcc, 16, v44
    v_add_f32 v42, v42, v43
    v_add_f32 v40, v40, v41
    v_cndmask_b32 v42, 0, v42, vcc
    v_add_f32 v40, v40, v42
    s_nop 2
    v_add_f32_dpp v40, v40, v40 quad_perm:[1,0,3,2] row_mask:0xf bank_mask:0xf
    s_nop 1
    v_add_f32_dpp v40, v40, v40 quad_perm:[2,3,0,1] row_mask:0xf bank_mask:0xf
    s_nop 1
    v_add_f32_dpp v40, v40, v40 row_half_mirror row_mask:0xf bank_mask:0xf
    s_nop 1
    v_add_f32_dpp v40, v40, v40 row_mirror row_mask:0xf bank_mask:0xf
    s_nop 1
    v_mov_b32 v41, v40
    s_nop 1
    v_permlane16_swap_b32 v40, v41
    s_nop 0
    v_add_f32 v40, v40, v41
    s_add_u32 m0, s43, 6144
    s_mov_b32 s46, 15360
    buffer_load_dwordx4 v1, s[4:7], s46 offen lds
    v_mul_f32 v40, 0.0015625, v40
    v_cvt_pk_bf16_f32 v40, v40, v38
    v_and_b32 v38, s59, v40
    v_lshlrev_b32 v40, 16, v40
    v_add_f32 v40, 0x3727c5ac, v40
    v_cvt_pk_bf16_f32 v40, v40, v40
    v_lshlrev_b32 v40, 16, v40
    v_sqrt_f32 v40, v40
    v_lshrrev_b32 v41, 5, v0
    v_cvt_pk_bf16_f32 v40, v40, v40
    v_lshlrev_b32 v40, 16, v40
    v_rcp_f32 v39, v40
    v_lshlrev_b32 v41, 3, v41
    s_lshl_b32 s56, s51, 4
    s_mov_b32 exec_lo, 1
    s_mov_b32 exec_hi, 1
    buffer_store_dwordx2 v[38:39], v41, s[20:23], s56 offen sc1
    s_mov_b64 exec, -1
    s_waitcnt vmcnt(22)
    s_cmp_ge_u32 s72, 540
    s_cbranch_scc1 L_rS_20
    ds_read_b64_tr_b16 a[184:185], v91 offset:0
    ds_read_b64_tr_b16 a[186:187], v91 offset:2048
    ds_read_b64_tr_b16 a[188:189], v91 offset:32
    ds_read_b64_tr_b16 a[190:191], v91 offset:2080
    ds_read_b64_tr_b16 a[192:193], v91 offset:64
    ds_read_b64_tr_b16 a[194:195], v91 offset:2112
    ds_read_b64_tr_b16 a[196:197], v91 offset:96
    ds_read_b64_tr_b16 a[198:199], v91 offset:2144
    s_branch L_rn_21
L_rS_20:
    ds_read_b64 a[184:185], v91 offset:0
    ds_read_b64 a[186:187], v91 offset:2048
    ds_read_b64 a[188:189], v91 offset:32
    ds_read_b64 a[190:191], v91 offset:2080
    ds_read_b64 a[192:193], v91 offset:64
    ds_read_b64 a[194:195], v91 offset:2112
    ds_read_b64 a[196:197], v91 offset:96
    ds_read_b64 a[198:199], v91 offset:2144
L_rn_21:
    s_mov_b32 s58, 0x3f803f80
    s_waitcnt vmcnt(21)
    v_dot2_f32_bf16 v24, v216, s58, 0
    v_dot2_f32_bf16 v24, v217, s58, v24
    v_dot2_f32_bf16 v24, v218, s58, v24
    v_dot2_f32_bf16 v24, v219, s58, v24
    buffer_load_dwordx4 v2, s[4:7], s46 offen offset:1024 lds
    s_waitcnt vmcnt(21)
    v_dot2_f32_bf16 v24, v220, s58, v24
    v_dot2_f32_bf16 v24, v221, s58, v24
    v_dot2_f32_bf16 v24, v222, s58, v24
    v_dot2_f32_bf16 v24, v223, s58, v24
    s_waitcnt vmcnt(20)
    v_dot2_f32_bf16 v24, v224, s58, v24
    v_dot2_f32_bf16 v24, v225, s58, v24
    v_dot2_f32_bf16 v24, v226, s58, v24
    v_dot2_f32_bf16 v24, v227, s58, v24
    s_waitcnt vmcnt(19)
    v_dot2_f32_bf16 v24, v228, s58, v24
    v_dot2_f32_bf16 v24, v229, s58, v24
    v_dot2_f32_bf16 v24, v230, s58, v24
    v_dot2_f32_bf16 v24, v231, s58, v24
    s_waitcnt vmcnt(18)
    v_dot2_f32_bf16 v24, v232, s58, v24
    v_dot2_f32_bf16 v24, v233, s58, v24
    v_dot2_f32_bf16 v24, v234, s58, v24
    v_dot2_f32_bf16 v24, v235, s58, v24
    s_add_u32 m0, s44, 20480
    s_mov_b32 s46, 128
    buffer_load_dwordx4 v3, s[8:11], s46 offen lds
    s_waitcnt vmcnt(18)
    v_dot2_f32_bf16 v24, v236, s58, v24
    v_dot2_f32_bf16 v24, v237, s58, v24
    v_dot2_f32_bf16 v24, v238, s58, v24
    v_dot2_f32_bf16 v24, v239, s58, v24
    s_waitcnt vmcnt(16)
    v_dot2_f32_bf16 v24, v240, s58, v24
    v_dot2_f32_bf16 v24, v241, s58, v24
    v_dot2_f32_bf16 v24, v242, s58, v24
    v_dot2_f32_bf16 v24, v243, s58, v24
    s_waitcnt vmcnt(15)
    v_dot2_f32_bf16 v24, v244, s58, v24
    v_dot2_f32_bf16 v24, v245, s58, v24
    v_dot2_f32_bf16 v24, v246, s58, v24
    v_dot2_f32_bf16 v24, v247, s58, v24
    s_waitcnt vmcnt(14)
    v_dot2_f32_bf16 v24, v248, s58, v24
    v_dot2_f32_bf16 v24, v249, s58, v24
    v_dot2_f32_bf16 v24, v250, s58, v24
    v_dot2_f32_bf16 v24, v251, s58, v24
    s_add_u32 m0, s44, 21504
    s_mov_b32 s45, 20608
    buffer_load_dwordx4 v3, s[8:11], s45 offen lds
    s_waitcnt vmcnt(14)
    v_dot2_f32_bf16 v24, v252, s58, v24
    v_dot2_f32_bf16 v24, v253, s58, v24
    v_dot2_f32_bf16 v24, v254, s58, v24
    v_dot2_f32_bf16 v24, v255, s58, v24
    v_lshlrev_b32 v25, 28, v0
    v_and_b32 v25, 0x70000000, v25
    v_lshrrev_b32 v26, 1, v0
    v_or_b32 v25, v25, v26
    v_add_f32_dpp v24, v24, v24 quad_perm:[1,0,3,2] row_mask:0xf bank_mask:0xf
    s_nop 1
    v_add_f32_dpp v24, v24, v24 quad_perm:[2,3,0,1] row_mask:0xf bank_mask:0xf
    s_nop 1
    v_add_f32_dpp v24, v24, v24 row_half_mirror row_mask:0xf bank_mask:0xf
    s_nop 1
    s_lshl_b32 s56, s16, 5
    s_add_u32 s56, s56, s17
    s_add_u32 s56, s56, 32768
    buffer_store_dword v24, v25, s[20:23], s56 offen sc1
    s_waitcnt lgkmcnt(6)
    buffer_store_dwordx4 a[184:187], v14, s[20:23], s82 offen sc1
    s_waitcnt lgkmcnt(4)
    buffer_store_dwordx4 a[188:191], v14, s[20:23], s83 offen sc1
    s_waitcnt lgkmcnt(2)
    buffer_store_dwordx4 a[192:195], v14, s[20:23], s100 offen sc1
    s_waitcnt lgkmcnt(0)
    buffer_store_dwordx4 a[196:199], v14, s[20:23], s101 offen sc1
    s_lshl2_add_u32 s56, s53, s40
    s_and_b32 s57, s52, 1
    s_lshl1_add_u32 s56, s56, s57
    s_mul_i32 s56, s56, 61440
    s_add_u32 s56, s56, 1048576
    s_add_u32 s36, s94, s56
    s_addc_u32 s37, s95, 0
    s_mov_b32 s38, 61440
    s_mov_b32 s39, 0x20000
    s_andn2_b32 s56, s52, 1
    s_lshl2_add_u32 s56, s56, s40
    s_and_b32 s57, s52, 1
    s_lshl1_add_u32 s56, s56, s57
    s_mul_i32 s56, s56, 49152
    s_add_u32 s56, s56, 5242880
    s_add_u32 s32, s94, s56
    s_addc_u32 s33, s95, 0
    s_mov_b32 s34, 442368
    s_mov_b32 s35, 0x20000
    s_add_u32 m0, s44, 22528
    s_mov_b32 s46, 41088
    buffer_load_dwordx4 v3, s[8:11], s46 offen lds
    s_add_u32 m0, s43, 8192
    s_mov_b32 s45, 128
    buffer_load_dwordx4 v1, s[4:7], s45 offen lds
    buffer_load_dwordx4 v2, s[4:7], s45 offen offset:1024 lds
    s_add_u32 m0, s43, 10240
    s_mov_b32 s46, 5248
    buffer_load_dwordx4 v1, s[4:7], s46 offen lds
    buffer_load_dwordx4 v2, s[4:7], s46 offen offset:1024 lds
    s_add_u32 m0, s43, 12288
    s_mov_b32 s45, 10368
    buffer_load_dwordx4 v1, s[4:7], s45 offen lds
    buffer_load_dwordx4 v2, s[4:7], s45 offen offset:1024 lds
    s_add_u32 m0, s43, 14336
    s_mov_b32 s46, 15488
    buffer_load_dwordx4 v1, s[4:7], s46 offen lds
    buffer_load_dwordx4 v2, s[4:7], s46 offen offset:1024 lds
    s_waitcnt vmcnt(16)
    s_barrier
    ds_read_b128 v[16:19], v6 offset:0
    ds_read_b128 v[20:23], v6 offset:2048
    ds_read_b128 v[24:27], v6 offset:4096
    ds_read_b128 v[28:31], v6 offset:6144
    ds_read_b128 v[48:51], v8 offset:0
    ds_read_b128 v[52:55], v8 offset:10240
    ds_read_b128 v[56:59], v8 offset:1024
    s_waitcnt lgkmcnt(2)
    v_mfma_f32_16x16x32_bf16 v[96:99], v[16:19], v[48:51], 0
    s_mov_b32 s46, 256
    ds_read_b128 v[60:63], v8 offset:11264
    v_mfma_f32_16x16x32_bf16 v[100:103], v[20:23], v[48:51], 0
    s_add_u32 m0, s44, 40960
    v_mfma_f32_16x16x32_bf16 v[104:107], v[24:27], v[48:51], 0
    buffer_load_dwordx4 v3, s[8:11], s46 offen lds
    v_mfma_f32_16x16x32_bf16 v[108:111], v[28:31], v[48:51], 0
    s_waitcnt lgkmcnt(2)
    v_mfma_f32_16x16x32_bf16 v[112:115], v[16:19], v[52:55], 0
    s_mov_b32 s45, 20736
    ds_read_b128 v[48:51], v8 offset:2048
    v_mfma_f32_16x16x32_bf16 v[116:119], v[20:23], v[52:55], 0
    s_add_u32 m0, s44, 41984
    v_mfma_f32_16x16x32_bf16 v[120:123], v[24:27], v[52:55], 0
    buffer_load_dwordx4 v3, s[8:11], s45 offen lds
    v_mfma_f32_16x16x32_bf16 v[124:127], v[28:31], v[52:55], 0
    s_waitcnt lgkmcnt(2)
    v_mfma_f32_16x16x32_bf16 v[128:131], v[16:19], v[56:59], 0
    s_mov_b32 s46, 41216
    ds_read_b128 v[52:55], v8 offset:12288
    v_mfma_f32_16x16x32_bf16 v[132:135], v[20:23], v[56:59], 0
    s_add_u32 m0, s44, 43008
    v_mfma_f32_16x16x32_bf16 v[136:139], v[24:27], v[56:59], 0
    buffer_load_dwordx4 v3, s[8:11], s46 offen lds
    v_mfma_f32_16x16x32_bf16 v[140:143], v[28:31], v[56:59], 0
    s_waitcnt lgkmcnt(2)
    v_mfma_f32_16x16x32_bf16 v[144:147], v[16:19], v[60:63], 0
    ds_read_b128 v[56:59], v9 offset:0
    v_mfma_f32_16x16x32_bf16 v[148:151], v[20:23], v[60:63], 0
    v_mfma_f32_16x16x32_bf16 v[152:155], v[24:27], v[60:63], 0
    ds_read_b128 v[32:35], v7 offset:0
    v_mfma_f32_16x16x32_bf16 v[156:159], v[28:31], v[60:63], 0
    s_waitcnt lgkmcnt(3)
    ds_read_b128 v[36:39], v7 offset:2048
    v_mfma_f32_16x16x32_bf16 v[160:163], v[16:19], v[48:51], 0
    ds_read_b128 v[60:63], v9 offset:10240
    v_mfma_f32_16x16x32_bf16 v[164:167], v[20:23], v[48:51], 0
    v_mfma_f32_16x16x32_bf16 v[168:171], v[24:27], v[48:51], 0
    ds_read_b128 v[40:43], v7 offset:4096
    v_mfma_f32_16x16x32_bf16 v[172:175], v[28:31], v[48:51], 0
    s_waitcnt lgkmcnt(5)
    ds_read_b128 v[44:47], v7 offset:6144
    v_mfma_f32_16x16x32_bf16 v[176:179], v[16:19], v[52:55], 0
    s_mov_b32 s45, 256
    ds_read_b128 v[48:51], v9 offset:1024
    v_mfma_f32_16x16x32_bf16 v[180:183], v[20:23], v[52:55], 0
    s_add_u32 m0, s43, 0
    v_mfma_f32_16x16x32_bf16 v[184:187], v[24:27], v[52:55], 0
    buffer_load_dwordx4 v1, s[4:7], s45 offen lds
    v_mfma_f32_16x16x32_bf16 v[188:191], v[28:31], v[52:55], 0
    s_waitcnt lgkmcnt(5)
    buffer_load_dwordx4 v2, s[4:7], s45 offen offset:1024 lds
    v_mfma_f32_16x16x32_bf16 v[96:99], v[32:35], v[56:59], v[96:99]
    s_waitcnt lgkmcnt(4)
    s_mov_b32 s46, 5376
    ds_read_b128 v[52:55], v9 offset:11264
    v_mfma_f32_16x16x32_bf16 v[100:103], v[36:39], v[56:59], v[100:103]
    s_waitcnt lgkmcnt(3)
    s_add_u32 m0, s43, 2048
    v_mfma_f32_16x16x32_bf16 v[104:107], v[40:43], v[56:59], v[104:107]
    s_waitcnt lgkmcnt(2)
    buffer_load_dwordx4 v1, s[4:7], s46 offen lds
    v_mfma_f32_16x16x32_bf16 v[108:111], v[44:47], v[56:59], v[108:111]
    buffer_load_dwordx4 v2, s[4:7], s46 offen offset:1024 lds
    v_mfma_f32_16x16x32_bf16 v[112:115], v[32:35], v[60:63], v[112:115]
    s_mov_b32 s45, 10496
    ds_read_b128 v[56:59], v9 offset:2048
    v_mfma_f32_16x16x32_bf16 v[116:119], v[36:39], v[60:63], v[116:119]
    s_add_u32 m0, s43, 4096
    v_mfma_f32_16x16x32_bf16 v[120:123], v[40:43], v[60:63], v[120:123]
    buffer_load_dwordx4 v1, s[4:7], s45 offen lds
    v_mfma_f32_16x16x32_bf16 v[124:127], v[44:47], v[60:63], v[124:127]
    s_waitcnt lgkmcnt(2)
    s_mov_b32 s46, 15616
    buffer_load_dwordx4 v2, s[4:7], s45 offen offset:1024 lds
    v_mfma_f32_16x16x32_bf16 v[128:131], v[32:35], v[48:51], v[128:131]
    s_add_u32 m0, s43, 6144
    ds_read_b128 v[60:63], v9 offset:12288
    v_mfma_f32_16x16x32_bf16 v[132:135], v[36:39], v[48:51], v[132:135]
    buffer_load_dwordx4 v1, s[4:7], s46 offen lds
    v_mfma_f32_16x16x32_bf16 v[136:139], v[40:43], v[48:51], v[136:139]
    buffer_load_dwordx4 v2, s[4:7], s46 offen offset:1024 lds
    v_mfma_f32_16x16x32_bf16 v[140:143], v[44:47], v[48:51], v[140:143]
    s_waitcnt lgkmcnt(2)
    s_waitcnt vmcnt(11)
    s_barrier
    v_mfma_f32_16x16x32_bf16 v[144:147], v[32:35], v[52:55], v[144:147]
    ds_read_b128 v[48:51], v8 offset:20480
    v_mfma_f32_16x16x32_bf16 v[148:151], v[36:39], v[52:55], v[148:151]
    v_mfma_f32_16x16x32_bf16 v[152:155], v[40:43], v[52:55], v[152:155]
    ds_read_b128 v[16:19], v6 offset:8192
    v_mfma_f32_16x16x32_bf16 v[156:159], v[44:47], v[52:55], v[156:159]
    s_waitcnt lgkmcnt(3)
    ds_read_b128 v[20:23], v6 offset:10240
    v_mfma_f32_16x16x32_bf16 v[160:163], v[32:35], v[56:59], v[160:163]
    ds_read_b128 v[52:55], v8 offset:30720
    v_mfma_f32_16x16x32_bf16 v[164:167], v[36:39], v[56:59], v[164:167]
    v_mfma_f32_16x16x32_bf16 v[168:171], v[40:43], v[56:59], v[168:171]
    ds_read_b128 v[24:27], v6 offset:12288
    v_mfma_f32_16x16x32_bf16 v[172:175], v[44:47], v[56:59], v[172:175]
    s_waitcnt lgkmcnt(5)
    ds_read_b128 v[28:31], v6 offset:14336
    v_mfma_f32_16x16x32_bf16 v[176:179], v[32:35], v[60:63], v[176:179]
    ds_read_b128 v[56:59], v8 offset:21504
    v_mfma_f32_16x16x32_bf16 v[180:183], v[36:39], v[60:63], v[180:183]
    v_mfma_f32_16x16x32_bf16 v[184:187], v[40:43], v[60:63], v[184:187]
    buffer_load_dword v93, off, s[68:71], 0 sc1
    v_mfma_f32_16x16x32_bf16 v[188:191], v[44:47], v[60:63], v[188:191]
    s_waitcnt lgkmcnt(5)
    v_mfma_f32_16x16x32_bf16 v[96:99], v[16:19], v[48:51], v[96:99]
    s_waitcnt lgkmcnt(4)
    s_mov_b32 s46, 384
    ds_read_b128 v[60:63], v8 offset:31744
    v_mfma_f32_16x16x32_bf16 v[100:103], v[20:23], v[48:51], v[100:103]
    s_waitcnt lgkmcnt(3)
    s_add_u32 m0, s44, 0
    v_mfma_f32_16x16x32_bf16 v[104:107], v[24:27], v[48:51], v[104:107]
    s_waitcnt lgkmcnt(2)
    buffer_load_dwordx4 v3, s[8:11], s46 offen lds
    v_mfma_f32_16x16x32_bf16 v[108:111], v[28:31], v[48:51], v[108:111]
    v_mfma_f32_16x16x32_bf16 v[112:115], v[16:19], v[52:55], v[112:115]
    s_mov_b32 s45, 20864
    ds_read_b128 v[48:51], v8 offset:22528
    v_mfma_f32_16x16x32_bf16 v[116:119], v[20:23], v[52:55], v[116:119]
    s_add_u32 m0, s44, 1024
    v_mfma_f32_16x16x32_bf16 v[120:123], v[24:27], v[52:55], v[120:123]
    buffer_load_dwordx4 v3, s[8:11], s45 offen lds
    v_mfma_f32_16x16x32_bf16 v[124:127], v[28:31], v[52:55], v[124:127]
    s_waitcnt lgkmcnt(2)
    v_mfma_f32_16x16x32_bf16 v[128:131], v[16:19], v[56:59], v[128:131]
    s_mov_b32 s46, 41344
    ds_read_b128 v[52:55], v8 offset:32768
    v_mfma_f32_16x16x32_bf16 v[132:135], v[20:23], v[56:59], v[132:135]
    s_add_u32 m0, s44, 2048
    v_mfma_f32_16x16x32_bf16 v[136:139], v[24:27], v[56:59], v[136:139]
    buffer_load_dwordx4 v3, s[8:11], s46 offen lds
    v_mfma_f32_16x16x32_bf16 v[140:143], v[28:31], v[56:59], v[140:143]
    s_waitcnt lgkmcnt(2)
    v_mfma_f32_16x16x32_bf16 v[144:147], v[16:19], v[60:63], v[144:147]
    ds_read_b128 v[56:59], v9 offset:20480
    v_mfma_f32_16x16x32_bf16 v[148:151], v[20:23], v[60:63], v[148:151]
    v_mfma_f32_16x16x32_bf16 v[152:155], v[24:27], v[60:63], v[152:155]
    ds_read_b128 v[32:35], v7 offset:8192
    v_mfma_f32_16x16x32_bf16 v[156:159], v[28:31], v[60:63], v[156:159]
    s_waitcnt lgkmcnt(3)
    ds_read_b128 v[36:39], v7 offset:10240
    v_mfma_f32_16x16x32_bf16 v[160:163], v[16:19], v[48:51], v[160:163]
    ds_read_b128 v[60:63], v9 offset:30720
    v_mfma_f32_16x16x32_bf16 v[164:167], v[20:23], v[48:51], v[164:167]
    v_mfma_f32_16x16x32_bf16 v[168:171], v[24:27], v[48:51], v[168:171]
    ds_read_b128 v[40:43], v7 offset:12288
    v_mfma_f32_16x16x32_bf16 v[172:175], v[28:31], v[48:51], v[172:175]
    s_waitcnt lgkmcnt(5)
    ds_read_b128 v[44:47], v7 offset:14336
    v_mfma_f32_16x16x32_bf16 v[176:179], v[16:19], v[52:55], v[176:179]
    s_mov_b32 s45, 384
    ds_read_b128 v[48:51], v9 offset:21504
    v_mfma_f32_16x16x32_bf16 v[180:183], v[20:23], v[52:55], v[180:183]
    s_add_u32 m0, s43, 8192
    v_mfma_f32_16x16x32_bf16 v[184:187], v[24:27], v[52:55], v[184:187]
    buffer_load_dwordx4 v1, s[4:7], s45 offen lds
    v_mfma_f32_16x16x32_bf16 v[188:191], v[28:31], v[52:55], v[188:191]
    s_waitcnt lgkmcnt(5)
    buffer_load_dwordx4 v2, s[4:7], s45 offen offset:1024 lds
    v_mfma_f32_16x16x32_bf16 v[96:99], v[32:35], v[56:59], v[96:99]
    s_waitcnt lgkmcnt(4)
    s_mov_b32 s46, 5504
    ds_read_b128 v[52:55], v9 offset:31744
    v_mfma_f32_16x16x32_bf16 v[100:103], v[36:39], v[56:59], v[100:103]
    s_waitcnt lgkmcnt(3)
    s_add_u32 m0, s43, 10240
    v_mfma_f32_16x16x32_bf16 v[104:107], v[40:43], v[56:59], v[104:107]
    s_waitcnt lgkmcnt(2)
    buffer_load_dwordx4 v1, s[4:7], s46 offen lds
    v_mfma_f32_16x16x32_bf16 v[108:111], v[44:47], v[56:59], v[108:111]
    buffer_load_dwordx4 v2, s[4:7], s46 offen offset:1024 lds
    v_mfma_f32_16x16x32_bf16 v[112:115], v[32:35], v[60:63], v[112:115]
    s_mov_b32 s45, 10624
    ds_read_b128 v[56:59], v9 offset:22528
    v_mfma_f32_16x16x32_bf16 v[116:119], v[36:39], v[60:63], v[116:119]
    s_add_u32 m0, s43, 12288
    v_mfma_f32_16x16x32_bf16 v[120:123], v[40:43], v[60:63], v[120:123]
    buffer_load_dwordx4 v1, s[4:7], s45 offen lds
    v_mfma_f32_16x16x32_bf16 v[124:127], v[44:47], v[60:63], v[124:127]
    s_waitcnt lgkmcnt(2)
    s_mov_b32 s46, 15744
    buffer_load_dwordx4 v2, s[4:7], s45 offen offset:1024 lds
    v_mfma_f32_16x16x32_bf16 v[128:131], v[32:35], v[48:51], v[128:131]
    s_add_u32 m0, s43, 14336
    ds_read_b128 v[60:63], v9 offset:32768
    v_mfma_f32_16x16x32_bf16 v[132:135], v[36:39], v[48:51], v[132:135]
    buffer_load_dwordx4 v1, s[4:7], s46 offen lds
    v_mfma_f32_16x16x32_bf16 v[136:139], v[40:43], v[48:51], v[136:139]
    buffer_load_dwordx4 v2, s[4:7], s46 offen offset:1024 lds
    v_mfma_f32_16x16x32_bf16 v[140:143], v[44:47], v[48:51], v[140:143]
    s_waitcnt lgkmcnt(2)
    s_waitcnt vmcnt(12)
    s_waitcnt vmcnt(11)
    v_cmp_gt_u32 vcc, 40, v93
    s_mov_b32 s55, 0
    s_cbranch_vccz L_ok_22
L_sp_23:
    s_sleep 16
    buffer_load_dword v93, off, s[68:71], 0 sc1
    s_add_u32 s55, s55, 1
    s_cmp_gt_u32 s55, 200000
    s_cbranch_scc1 L_ok_22
    s_waitcnt vmcnt(0)
    v_cmp_gt_u32 vcc, 40, v93
    s_nop 0
    s_cbranch_vccnz L_sp_23
L_ok_22:
    s_barrier
    v_mfma_f32_16x16x32_bf16 v[144:147], v[32:35], v[52:55], v[144:147]
    ds_read_b128 v[48:51], v8 offset:40960
    v_mfma_f32_16x16x32_bf16 v[148:151], v[36:39], v[52:55], v[148:151]
    s_mov_b64 exec, 1
    buffer_store_dword a255, off, s[20:23], s67 sc1
    s_mov_b64 exec, -1
    v_mfma_f32_16x16x32_bf16 v[152:155], v[40:43], v[52:55], v[152:155]
    ds_read_b128 v[16:19], v6 offset:0
    v_mfma_f32_16x16x32_bf16 v[156:159], v[44:47], v[52:55], v[156:159]
    s_waitcnt lgkmcnt(3)
    ds_read_b128 v[20:23], v6 offset:2048
    v_mfma_f32_16x16x32_bf16 v[160:163], v[32:35], v[56:59], v[160:163]
    ds_read_b128 v[52:55], v8 offset:51200
    v_mfma_f32_16x16x32_bf16 v[164:167], v[36:39], v[56:59], v[164:167]
    v_mfma_f32_16x16x32_bf16 v[168:171], v[40:43], v[56:59], v[168:171]
    ds_read_b128 v[24:27], v6 offset:4096
    v_mfma_f32_16x16x32_bf16 v[172:175], v[44:47], v[56:59], v[172:175]
    s_waitcnt lgkmcnt(5)
    ds_read_b128 v[28:31], v6 offset:6144
    v_mfma_f32_16x16x32_bf16 v[176:179], v[32:35], v[60:63], v[176:179]
    ds_read_b128 v[56:59], v8 offset:41984
    v_mfma_f32_16x16x32_bf16 v[180:183], v[36:39], v[60:63], v[180:183]
    v_mfma_f32_16x16x32_bf16 v[184:187], v[40:43], v[60:63], v[184:187]
    v_mfma_f32_16x16x32_bf16 v[188:191], v[44:47], v[60:63], v[188:191]
    s_waitcnt lgkmcnt(5)
    v_mfma_f32_16x16x32_bf16 v[96:99], v[16:19], v[48:51], v[96:99]
    s_waitcnt lgkmcnt(4)
    s_mov_b32 s46, 512
    ds_read_b128 v[60:63], v8 offset:52224
    v_mfma_f32_16x16x32_bf16 v[100:103], v[20:23], v[48:51], v[100:103]
    s_waitcnt lgkmcnt(3)
    s_add_u32 m0, s44, 20480
    v_mfma_f32_16x16x32_bf16 v[104:107], v[24:27], v[48:51], v[104:107]
    s_waitcnt lgkmcnt(2)
    s_mul_i32 s56, s53, 160
    buffer_load_dwordx4 v3, s[8:11], s46 offen lds
    v_mfma_f32_16x16x32_bf16 v[108:111], v[28:31], v[48:51], v[108:111]
    v_mfma_f32_16x16x32_bf16 v[112:115], v[16:19], v[52:55], v[112:115]
    s_mov_b32 s45, 20992
    ds_read_b128 v[48:51], v8 offset:43008
    v_mfma_f32_16x16x32_bf16 v[116:119], v[20:23], v[52:55], v[116:119]
    s_add_u32 m0, s44, 21504
    v_mfma_f32_16x16x32_bf16 v[120:123], v[24:27], v[52:55], v[120:123]
    s_add_u32 s28, s80, s56
    s_addc_u32 s29, s81, 0
    buffer_load_dwordx4 v3, s[8:11], s45 offen lds
    v_mfma_f32_16x16x32_bf16 v[124:127], v[28:31], v[52:55], v[124:127]
    s_waitcnt lgkmcnt(2)
    v_mfma_f32_16x16x32_bf16 v[128:131], v[16:19], v[56:59], v[128:131]
    s_mov_b32 s46, 41472
    ds_read_b128 v[52:55], v8 offset:53248
    v_mfma_f32_16x16x32_bf16 v[132:135], v[20:23], v[56:59], v[132:135]
    s_add_u32 m0, s44, 22528
    v_mfma_f32_16x16x32_bf16 v[136:139], v[24:27], v[56:59], v[136:139]
    s_mov_b32 s30, 160
    buffer_load_dwordx4 v3, s[8:11], s46 offen lds
    v_mfma_f32_16x16x32_bf16 v[140:143], v[28:31], v[56:59], v[140:143]
    s_waitcnt lgkmcnt(2)
    v_mfma_f32_16x16x32_bf16 v[144:147], v[16:19], v[60:63], v[144:147]
    s_lshl_b32 s57, s52, 4
    ds_read_b128 v[56:59], v9 offset:40960
    v_mfma_f32_16x16x32_bf16 v[148:151], v[20:23], v[60:63], v[148:151]
    s_add_u32 s57, s57, s40
    v_mfma_f32_16x16x32_bf16 v[152:155], v[24:27], v[60:63], v[152:155]
    s_mul_i32 s57, s57, 5120
    ds_read_b128 v[32:35], v7 offset:0
    v_mfma_f32_16x16x32_bf16 v[156:159], v[28:31], v[60:63], v[156:159]
    s_waitcnt lgkmcnt(3)
    ds_read_b128 v[36:39], v7 offset:2048
    v_mfma_f32_16x16x32_bf16 v[160:163], v[16:19], v[48:51], v[160:163]
    s_add_u32 s56, s56, s57
    ds_read_b128 v[60:63], v9 offset:51200
    v_mfma_f32_16x16x32_bf16 v[164:167], v[20:23], v[48:51], v[164:167]
    s_add_u32 s24, s64, s56
    s_addc_u32 s25, s65, 0
    v_mfma_f32_16x16x32_bf16 v[168:171], v[24:27], v[48:51], v[168:171]
    s_mov_b32 s26, 65440
    ds_read_b128 v[40:43], v7 offset:4096
    v_mfma_f32_16x16x32_bf16 v[172:175], v[28:31], v[48:51], v[172:175]
    s_waitcnt lgkmcnt(5)
    ds_read_b128 v[44:47], v7 offset:6144
    v_add_u32 v94, 0, v0
    v_mfma_f32_16x16x32_bf16 v[176:179], v[16:19], v[52:55], v[176:179]
    s_mov_b32 s45, 512
    ds_read_b128 v[48:51], v9 offset:41984
    v_mul_u32_u24 v95, 6554, v94
    v_mfma_f32_16x16x32_bf16 v[180:183], v[20:23], v[52:55], v[180:183]
    s_add_u32 m0, s43, 0
    v_lshrrev_b32 v95, 16, v95
    v_mfma_f32_16x16x32_bf16 v[184:187], v[24:27], v[52:55], v[184:187]
    buffer_load_dwordx4 v1, s[4:7], s45 offen lds
    v_mfma_f32_16x16x32_bf16 v[188:191], v[28:31], v[52:55], v[188:191]
    s_waitcnt lgkmcnt(5)
    buffer_load_dwordx4 v2, s[4:7], s45 offen offset:1024 lds
    v_mfma_f32_16x16x32_bf16 v[96:99], v[32:35], v[56:59], v[96:99]
    s_waitcnt lgkmcnt(4)
    s_mov_b32 s46, 5632
    ds_read_b128 v[52:55], v9 offset:52224
    v_mul_u32_u24 v88, 10, v95
    v_mfma_f32_16x16x32_bf16 v[100:103], v[36:39], v[56:59], v[100:103]
    s_waitcnt lgkmcnt(3)
    s_add_u32 m0, s43, 2048
    v_sub_u32 v94, v94, v88
    v_mfma_f32_16x16x32_bf16 v[104:107], v[40:43], v[56:59], v[104:107]
    s_waitcnt lgkmcnt(2)
    buffer_load_dwordx4 v1, s[4:7], s46 offen lds
    v_mfma_f32_16x16x32_bf16 v[108:111], v[44:47], v[56:59], v[108:111]
    buffer_load_dwordx4 v2, s[4:7], s46 offen offset:1024 lds
    v_mfma_f32_16x16x32_bf16 v[112:115], v[32:35], v[60:63], v[112:115]
    s_mov_b32 s45, 10752
    ds_read_b128 v[56:59], v9 offset:43008
    v_lshrrev_b32 v88, 2, v95
    v_mfma_f32_16x16x32_bf16 v[116:119], v[36:39], v[60:63], v[116:119]
    s_add_u32 m0, s43, 4096
    v_mul_u32_u24 v88, 12, v88
    v_mfma_f32_16x16x32_bf16 v[120:123], v[40:43], v[60:63], v[120:123]
    buffer_load_dwordx4 v1, s[4:7], s45 offen lds
    v_mfma_f32_16x16x32_bf16 v[124:127], v[44:47], v[60:63], v[124:127]
    s_waitcnt lgkmcnt(2)
    s_mov_b32 s46, 15872
    buffer_load_dwordx4 v2, s[4:7], s45 offen offset:1024 lds
    v_mfma_f32_16x16x32_bf16 v[128:131], v[32:35], v[48:51], v[128:131]
    s_add_u32 m0, s43, 6144
    ds_read_b128 v[60:63], v9 offset:53248
    v_add_u32 v95, v95, v88
    v_mfma_f32_16x16x32_bf16 v[132:135], v[36:39], v[48:51], v[132:135]
    buffer_load_dwordx4 v1, s[4:7], s46 offen lds
    v_mfma_f32_16x16x32_bf16 v[136:139], v[40:43], v[48:51], v[136:139]
    buffer_load_dwordx4 v2, s[4:7], s46 offen offset:1024 lds
    v_mfma_f32_16x16x32_bf16 v[140:143], v[44:47], v[48:51], v[140:143]
    s_waitcnt lgkmcnt(2)
    s_waitcnt vmcnt(12)
    s_barrier
    v_mfma_f32_16x16x32_bf16 v[144:147], v[32:35], v[52:55], v[144:147]
    ds_read_b128 v[48:51], v8 offset:0
    v_mul_u32_u24 v95, 1280, v95
    v_mfma_f32_16x16x32_bf16 v[148:151], v[36:39], v[52:55], v[148:151]
    v_lshl_add_u32 v94, v94, 4, v95
    v_mfma_f32_16x16x32_bf16 v[152:155], v[40:43], v[52:55], v[152:155]
    ds_read_b128 v[16:19], v6 offset:8192
    v_mfma_f32_16x16x32_bf16 v[156:159], v[44:47], v[52:55], v[156:159]
    s_waitcnt lgkmcnt(3)
    ds_read_b128 v[20:23], v6 offset:10240
    v_mfma_f32_16x16x32_bf16 v[160:163], v[32:35], v[56:59], v[160:163]
    s_add_u32 m0, s48, 0
    ds_read_b128 v[52:55], v8 offset:10240
    v_mfma_f32_16x16x32_bf16 v[164:167], v[36:39], v[56:59], v[164:167]
    buffer_load_dwordx4 v94, s[24:27], 0 offen lds
    v_mfma_f32_16x16x32_bf16 v[168:171], v[40:43], v[56:59], v[168:171]
    ds_read_b128 v[24:27], v6 offset:12288
    v_add_u32 v94, 64, v0
    v_mfma_f32_16x16x32_bf16 v[172:175], v[44:47], v[56:59], v[172:175]
    s_waitcnt lgkmcnt(5)
    ds_read_b128 v[28:31], v6 offset:14336
    v_mul_u32_u24 v95, 6554, v94
    v_mfma_f32_16x16x32_bf16 v[176:179], v[32:35], v[60:63], v[176:179]
    ds_read_b128 v[56:59], v8 offset:1024
    v_lshrrev_b32 v95, 16, v95
    v_mfma_f32_16x16x32_bf16 v[180:183], v[36:39], v[60:63], v[180:183]
    v_mul_u32_u24 v88, 10, v95
    v_mfma_f32_16x16x32_bf16 v[184:187], v[40:43], v[60:63], v[184:187]
    v_sub_u32 v94, v94, v88
    v_mfma_f32_16x16x32_bf16 v[188:191], v[44:47], v[60:63], v[188:191]
    s_waitcnt lgkmcnt(5)
    v_lshrrev_b32 v88, 2, v95
    v_mfma_f32_16x16x32_bf16 v[96:99], v[16:19], v[48:51], v[96:99]
    s_waitcnt lgkmcnt(4)
    s_mov_b32 s46, 640
    ds_read_b128 v[60:63], v8 offset:11264
    v_mul_u32_u24 v88, 12, v88
    v_mfma_f32_16x16x32_bf16 v[100:103], v[20:23], v[48:51], v[100:103]
    s_waitcnt lgkmcnt(3)
    s_add_u32 m0, s44, 40960
    v_add_u32 v95, v95, v88
    v_mfma_f32_16x16x32_bf16 v[104:107], v[24:27], v[48:51], v[104:107]
    s_waitcnt lgkmcnt(2)
    buffer_load_dwordx4 v3, s[8:11], s46 offen lds
L_st_9:
    s_cbranch_execz L_tr_y
    v_mfma_f32_16x16x32_bf16 v[108:111], v[28:31], v[48:51], v[108:111]
    v_mul_u32_u24 v95, 1280, v95
    v_mfma_f32_16x16x32_bf16 v[112:115], v[16:19], v[52:55], v[112:115]
    s_mov_b32 s45, 21120
    ds_read_b128 v[48:51], v8 offset:2048
    v_lshl_add_u32 v94, v94, 4, v95
    v_mfma_f32_16x16x32_bf16 v[116:119], v[20:23], v[52:55], v[116:119]
    s_add_u32 m0, s44, 41984
    v_mfma_f32_16x16x32_bf16 v[120:123], v[24:27], v[52:55], v[120:123]
    buffer_load_dwordx4 v3, s[8:11], s45 offen lds
    v_mfma_f32_16x16x32_bf16 v[124:127], v[28:31], v[52:55], v[124:127]
    s_waitcnt lgkmcnt(2)
    v_mfma_f32_16x16x32_bf16 v[128:131], v[16:19], v[56:59], v[128:131]
    s_mov_b32 s46, 41600
    ds_read_b128 v[52:55], v8 offset:12288
    v_mfma_f32_16x16x32_bf16 v[132:135], v[20:23], v[56:59], v[132:135]
    s_add_u32 m0, s44, 43008
    v_mfma_f32_16x16x32_bf16 v[136:139], v[24:27], v[56:59], v[136:139]
    buffer_load_dwordx4 v3, s[8:11], s46 offen lds
    v_mfma_f32_16x16x32_bf16 v[140:143], v[28:31], v[56:59], v[140:143]
    s_waitcnt lgkmcnt(2)
    v_mfma_f32_16x16x32_bf16 v[144:147], v[16:19], v[60:63], v[144:147]
    ds_read_b128 v[56:59], v9 offset:0
    v_mfma_f32_16x16x32_bf16 v[148:151], v[20:23], v[60:63], v[148:151]
    v_mfma_f32_16x16x32_bf16 v[152:155], v[24:27], v[60:63], v[152:155]
    ds_read_b128 v[32:35], v7 offset:8192
    v_mfma_f32_16x16x32_bf16 v[156:159], v[28:31], v[60:63], v[156:159]
    s_waitcnt lgkmcnt(3)
    ds_read_b128 v[36:39], v7 offset:10240
    v_mfma_f32_16x16x32_bf16 v[160:163], v[16:19], v[48:51], v[160:163]
    s_add_u32 m0, s48, 1024
    ds_read_b128 v[60:63], v9 offset:10240
    v_mfma_f32_16x16x32_bf16 v[164:167], v[20:23], v[48:51], v[164:167]
    buffer_load_dwordx4 v94, s[24:27], 0 offen lds
    v_mfma_f32_16x16x32_bf16 v[168:171], v[24:27], v[48:51], v[168:171]
    ds_read_b128 v[40:43], v7 offset:12288
    v_add_u32 v94, 128, v0
    v_mfma_f32_16x16x32_bf16 v[172:175], v[28:31], v[48:51], v[172:175]
    s_waitcnt lgkmcnt(5)
    ds_read_b128 v[44:47], v7 offset:14336
    v_mul_u32_u24 v95, 6554, v94
    v_mfma_f32_16x16x32_bf16 v[176:179], v[16:19], v[52:55], v[176:179]
    s_mov_b32 s45, 640
    ds_read_b128 v[48:51], v9 offset:1024
    v_lshrrev_b32 v95, 16, v95
    v_mfma_f32_16x16x32_bf16 v[180:183], v[20:23], v[52:55], v[180:183]
    s_add_u32 m0, s43, 8192
    v_mul_u32_u24 v88, 10, v95
    v_mfma_f32_16x16x32_bf16 v[184:187], v[24:27], v[52:55], v[184:187]
    buffer_load_dwordx4 v1, s[4:7], s45 offen lds
    v_mfma_f32_16x16x32_bf16 v[188:191], v[28:31], v[52:55], v[188:191]
    s_waitcnt lgkmcnt(5)
    buffer_load_dwordx4 v2, s[4:7], s45 offen offset:1024 lds
    v_mfma_f32_16x16x32_bf16 v[96:99], v[32:35], v[56:59], v[96:99]
    s_waitcnt lgkmcnt(4)
    s_mov_b32 s46, 5760
    ds_read_b128 v[52:55], v9 offset:11264
    v_sub_u32 v94, v94, v88
    v_mfma_f32_16x16x32_bf16 v[100:103], v[36:39], v[56:59], v[100:103]
    s_waitcnt lgkmcnt(3)
    s_add_u32 m0, s43, 10240
    v_lshrrev_b32 v88, 2, v95
    v_mfma_f32_16x16x32_bf16 v[104:107], v[40:43], v[56:59], v[104:107]
    s_waitcnt lgkmcnt(2)
    buffer_load_dwordx4 v1, s[4:7], s46 offen lds
    v_mfma_f32_16x16x32_bf16 v[108:111], v[44:47], v[56:59], v[108:111]
    buffer_load_dwordx4 v2, s[4:7], s46 offen offset:1024 lds
    v_mfma_f32_16x16x32_bf16 v[112:115], v[32:35], v[60:63], v[112:115]
    s_mov_b32 s45, 10880
    ds_read_b128 v[56:59], v9 offset:2048
    v_mul_u32_u24 v88, 12, v88
    v_mfma_f32_16x16x32_bf16 v[116:119], v[36:39], v[60:63], v[116:119]
    s_add_u32 m0, s43, 12288
    v_add_u32 v95, v95, v88
    v_mfma_f32_16x16x32_bf16 v[120:123], v[40:43], v[60:63], v[120:123]
    buffer_load_dwordx4 v1, s[4:7], s45 offen lds
    v_mfma_f32_16x16x32_bf16 v[124:127], v[44:47], v[60:63], v[124:127]
    s_waitcnt lgkmcnt(2)
    s_mov_b32 s46, 16000
    buffer_load_dwordx4 v2, s[4:7], s45 offen offset:1024 lds
    v_mfma_f32_16x16x32_bf16 v[128:131], v[32:35], v[48:51], v[128:131]
    s_add_u32 m0, s43, 14336
    ds_read_b128 v[60:63], v9 offset:12288
    v_mul_u32_u24 v95, 1280, v95
    v_mfma_f32_16x16x32_bf16 v[132:135], v[36:39], v[48:51], v[132:135]
    buffer_load_dwordx4 v1, s[4:7], s46 offen lds
    v_mfma_f32_16x16x32_bf16 v[136:139], v[40:43], v[48:51], v[136:139]
    buffer_load_dwordx4 v2, s[4:7], s46 offen offset:1024 lds
    v_mfma_f32_16x16x32_bf16 v[140:143], v[44:47], v[48:51], v[140:143]
    s_waitcnt lgkmcnt(2)
    s_waitcnt vmcnt(13)
    s_barrier
    v_mfma_f32_16x16x32_bf16 v[144:147], v[32:35], v[52:55], v[144:147]
    ds_read_b128 v[48:51], v8 offset:20480
    v_lshl_add_u32 v94, v94, 4, v95
    v_mfma_f32_16x16x32_bf16 v[148:151], v[36:39], v[52:55], v[148:151]
    v_mfma_f32_16x16x32_bf16 v[152:155], v[40:43], v[52:55], v[152:155]
    ds_read_b128 v[16:19], v6 offset:0
    v_mfma_f32_16x16x32_bf16 v[156:159], v[44:47], v[52:55], v[156:159]
    s_waitcnt lgkmcnt(3)
    ds_read_b128 v[20:23], v6 offset:2048
    v_mfma_f32_16x16x32_bf16 v[160:163], v[32:35], v[56:59], v[160:163]
    s_add_u32 m0, s48, 2048
    ds_read_b128 v[52:55], v8 offset:30720
    v_mfma_f32_16x16x32_bf16 v[164:167], v[36:39], v[56:59], v[164:167]
    buffer_load_dwordx4 v94, s[24:27], 0 offen lds
    v_mfma_f32_16x16x32_bf16 v[168:171], v[40:43], v[56:59], v[168:171]
    ds_read_b128 v[24:27], v6 offset:4096
    v_mfma_f32_16x16x32_bf16 v[172:175], v[44:47], v[56:59], v[172:175]
    s_waitcnt lgkmcnt(5)
    ds_read_b128 v[28:31], v6 offset:6144
    v_mfma_f32_16x16x32_bf16 v[176:179], v[32:35], v[60:63], v[176:179]
    ds_read_b128 v[56:59], v8 offset:21504
    v_mfma_f32_16x16x32_bf16 v[180:183], v[36:39], v[60:63], v[180:183]
    v_mfma_f32_16x16x32_bf16 v[184:187], v[40:43], v[60:63], v[184:187]
    v_mfma_f32_16x16x32_bf16 v[188:191], v[44:47], v[60:63], v[188:191]
    s_waitcnt lgkmcnt(5)
    v_mfma_f32_16x16x32_bf16 v[96:99], v[16:19], v[48:51], v[96:99]
    s_waitcnt lgkmcnt(4)
    s_mov_b32 s46, 768
    ds_read_b128 v[60:63], v8 offset:31744
    v_mfma_f32_16x16x32_bf16 v[100:103], v[20:23], v[48:51], v[100:103]
    s_waitcnt lgkmcnt(3)
    s_add_u32 m0, s44, 0
    v_mfma_f32_16x16x32_bf16 v[104:107], v[24:27], v[48:51], v[104:107]
    s_waitcnt lgkmcnt(2)
    buffer_load_dwordx4 v3, s[8:11], s46 offen lds
    v_mfma_f32_16x16x32_bf16 v[108:111], v[28:31], v[48:51], v[108:111]
    v_mfma_f32_16x16x32_bf16 v[112:115], v[16:19], v[52:55], v[112:115]
    s_mov_b32 s45, 21248
    ds_read_b128 v[48:51], v8 offset:22528
    v_mfma_f32_16x16x32_bf16 v[116:119], v[20:23], v[52:55], v[116:119]
    s_add_u32 m0, s44, 1024
    v_mfma_f32_16x16x32_bf16 v[120:123], v[24:27], v[52:55], v[120:123]
    buffer_load_dwordx4 v3, s[8:11], s45 offen lds
    v_mfma_f32_16x16x32_bf16 v[124:127], v[28:31], v[52:55], v[124:127]
    s_waitcnt lgkmcnt(2)
    v_mfma_f32_16x16x32_bf16 v[128:131], v[16:19], v[56:59], v[128:131]
    s_mov_b32 s46, 41728
    ds_read_b128 v[52:55], v8 offset:32768
    v_mfma_f32_16x16x32_bf16 v[132:135], v[20:23], v[56:59], v[132:135]
    s_add_u32 m0, s44, 2048
    v_mfma_f32_16x16x32_bf16 v[136:139], v[24:27], v[56:59], v[136:139]
    buffer_load_dwordx4 v3, s[8:11], s46 offen lds
    v_mfma_f32_16x16x32_bf16 v[140:143], v[28:31], v[56:59], v[140:143]
    s_waitcnt lgkmcnt(2)
    v_mfma_f32_16x16x32_bf16 v[144:147], v[16:19], v[60:63], v[144:147]
    ds_read_b128 v[56:59], v9 offset:20480
    v_mfma_f32_16x16x32_bf16 v[148:151], v[20:23], v[60:63], v[148:151]
    v_mfma_f32_16x16x32_bf16 v[152:155], v[24:27], v[60:63], v[152:155]
    ds_read_b128 v[32:35], v7 offset:0
    v_mfma_f32_16x16x32_bf16 v[156:159], v[28:31], v[60:63], v[156:159]
    s_waitcnt lgkmcnt(3)
    ds_read_b128 v[36:39], v7 offset:2048
    v_mfma_f32_16x16x32_bf16 v[160:163], v[16:19], v[48:51], v[160:163]
    s_add_u32 m0, s48, 3072
    ds_read_b128 v[60:63], v9 offset:30720
    v_mfma_f32_16x16x32_bf16 v[164:167], v[20:23], v[48:51], v[164:167]
    s_mov_b64 exec, 0xffff
    buffer_load_dwordx4 v14, s[28:31], 0 offen lds
    s_mov_b64 exec, -1
    v_mfma_f32_16x16x32_bf16 v[168:171], v[24:27], v[48:51], v[168:171]
    ds_read_b128 v[40:43], v7 offset:4096
    v_mfma_f32_16x16x32_bf16 v[172:175], v[28:31], v[48:51], v[172:175]
    s_waitcnt lgkmcnt(5)
    ds_read_b128 v[44:47], v7 offset:6144
    v_mfma_f32_16x16x32_bf16 v[176:179], v[16:19], v[52:55], v[176:179]
    s_mov_b32 s45, 768
    ds_read_b128 v[48:51], v9 offset:21504
    v_mfma_f32_16x16x32_bf16 v[180:183], v[20:23], v[52:55], v[180:183]
    s_add_u32 m0, s43, 0
    v_mfma_f32_16x16x32_bf16 v[184:187], v[24:27], v[52:55], v[184:187]
    buffer_load_dwordx4 v1, s[4:7], s45 offen lds
    v_mfma_f32_16x16x32_bf16 v[188:191], v[28:31], v[52:55], v[188:191]
    s_waitcnt lgkmcnt(5)
    buffer_load_dwordx4 v2, s[4:7], s45 offen offset:1024 lds
    v_mfma_f32_16x16x32_bf16 v[96:99], v[32:35], v[56:59], v[96:99]
    s_waitcnt lgkmcnt(4)
    s_mov_b32 s46, 5888
    ds_read_b128 v[52:55], v9 offset:31744
    v_mfma_f32_16x16x32_bf16 v[100:103], v[36:39], v[56:59], v[100:103]
    s_waitcnt lgkmcnt(3)
    s_add_u32 m0, s43, 2048
    v_mfma_f32_16x16x32_bf16 v[104:107], v[40:43], v[56:59], v[104:107]
    s_waitcnt lgkmcnt(2)
    buffer_load_dwordx4 v1, s[4:7], s46 offen lds
    v_mfma_f32_16x16x32_bf16 v[108:111], v[44:47], v[56:59], v[108:111]
    buffer_load_dwordx4 v2, s[4:7], s46 offen offset:1024 lds
    v_mfma_f32_16x16x32_bf16 v[112:115], v[32:35], v[60:63], v[112:115]
    s_mov_b32 s45, 11008
    ds_read_b128 v[56:59], v9 offset:22528
    v_mfma_f32_16x16x32_bf16 v[116:119], v[36:39], v[60:63], v[116:119]
    s_add_u32 m0, s43, 4096
    v_mfma_f32_16x16x32_bf16 v[120:123], v[40:43], v[60:63], v[120:123]
    buffer_load_dwordx4 v1, s[4:7], s45 offen lds
    v_mfma_f32_16x16x32_bf16 v[124:127], v[44:47], v[60:63], v[124:127]
    s_waitcnt lgkmcnt(2)
    s_mov_b32 s46, 16128
    buffer_load_dwordx4 v2, s[4:7], s45 offen offset:1024 lds
    v_mfma_f32_16x16x32_bf16 v[128:131], v[32:35], v[48:51], v[128:131]
    s_add_u32 m0, s43, 6144
    ds_read_b128 v[60:63], v9 offset:32768
    v_mfma_f32_16x16x32_bf16 v[132:135], v[36:39], v[48:51], v[132:135]
    buffer_load_dwordx4 v1, s[4:7], s46 offen lds
    v_mfma_f32_16x16x32_bf16 v[136:139], v[40:43], v[48:51], v[136:139]
    buffer_load_dwordx4 v2, s[4:7], s46 offen offset:1024 lds
    v_mfma_f32_16x16x32_bf16 v[140:143], v[44:47], v[48:51], v[140:143]
    s_waitcnt lgkmcnt(2)
    s_waitcnt vmcnt(13)
    s_barrier
    v_mfma_f32_16x16x32_bf16 v[144:147], v[32:35], v[52:55], v[144:147]
    ds_read_b128 v[48:51], v8 offset:40960
    v_mfma_f32_16x16x32_bf16 v[148:151], v[36:39], v[52:55], v[148:151]
    v_mfma_f32_16x16x32_bf16 v[152:155], v[40:43], v[52:55], v[152:155]
    ds_read_b128 v[16:19], v6 offset:8192
    v_mfma_f32_16x16x32_bf16 v[156:159], v[44:47], v[52:55], v[156:159]
    s_waitcnt lgkmcnt(3)
    ds_read_b128 v[20:23], v6 offset:10240
    v_mfma_f32_16x16x32_bf16 v[160:163], v[32:35], v[56:59], v[160:163]
    ds_read_b128 v[52:55], v8 offset:51200
    v_mfma_f32_16x16x32_bf16 v[164:167], v[36:39], v[56:59], v[164:167]
    v_mfma_f32_16x16x32_bf16 v[168:171], v[40:43], v[56:59], v[168:171]
    ds_read_b128 v[24:27], v6 offset:12288
    v_mfma_f32_16x16x32_bf16 v[172:175], v[44:47], v[56:59], v[172:175]
    s_waitcnt lgkmcnt(5)
    ds_read_b128 v[28:31], v6 offset:14336
    v_mfma_f32_16x16x32_bf16 v[176:179], v[32:35], v[60:63], v[176:179]
    ds_read_b128 v[56:59], v8 offset:41984
    v_mfma_f32_16x16x32_bf16 v[180:183], v[36:39], v[60:63], v[180:183]
    v_mfma_f32_16x16x32_bf16 v[184:187], v[40:43], v[60:63], v[184:187]
    v_mfma_f32_16x16x32_bf16 v[188:191], v[44:47], v[60:63], v[188:191]
    s_waitcnt lgkmcnt(5)
    v_mfma_f32_16x16x32_bf16 v[96:99], v[16:19], v[48:51], v[96:99]
    s_waitcnt lgkmcnt(4)
    s_mov_b32 s46, 896
    ds_read_b128 v[60:63], v8 offset:52224
    v_mfma_f32_16x16x32_bf16 v[100:103], v[20:23], v[48:51], v[100:103]
    s_waitcnt lgkmcnt(3)
    s_add_u32 m0, s44, 20480
    v_mfma_f32_16x16x32_bf16 v[104:107], v[24:27], v[48:51], v[104:107]
    s_waitcnt lgkmcnt(2)
    buffer_load_dwordx4 v3, s[8:11], s46 offen lds
    v_mfma_f32_16x16x32_bf16 v[108:111], v[28:31], v[48:51], v[108:111]
    v_mfma_f32_16x16x32_bf16 v[112:115], v[16:19], v[52:55], v[112:115]
    s_mov_b32 s45, 21376
    ds_read_b128 v[48:51], v8 offset:43008
    v_mfma_f32_16x16x32_bf16 v[116:119], v[20:23], v[52:55], v[116:119]
    s_add_u32 m0, s44, 21504
    v_mfma_f32_16x16x32_bf16 v[120:123], v[24:27], v[52:55], v[120:123]
    buffer_load_dwordx4 v3, s[8:11], s45 offen lds
    v_mfma_f32_16x16x32_bf16 v[124:127], v[28:31], v[52:55], v[124:127]
    s_waitcnt lgkmcnt(2)
    v_mfma_f32_16x16x32_bf16 v[128:131], v[16:19], v[56:59], v[128:131]
    s_mov_b32 s46, 41856
    ds_read_b128 v[52:55], v8 offset:53248
    v_mfma_f32_16x16x32_bf16 v[132:135], v[20:23], v[56:59], v[132:135]
    s_add_u32 m0, s44, 22528
    v_mfma_f32_16x16x32_bf16 v[136:139], v[24:27], v[56:59], v[136:139]
    buffer_load_dwordx4 v3, s[8:11], s46 offen lds
    v_mfma_f32_16x16x32_bf16 v[140:143], v[28:31], v[56:59], v[140:143]
    s_waitcnt lgkmcnt(2)
    v_mfma_f32_16x16x32_bf16 v[144:147], v[16:19], v[60:63], v[144:147]
    ds_read_b128 v[56:59], v9 offset:40960
    v_mfma_f32_16x16x32_bf16 v[148:151], v[20:23], v[60:63], v[148:151]
    v_mfma_f32_16x16x32_bf16 v[152:155], v[24:27], v[60:63], v[152:155]
    ds_read_b128 v[32:35], v7 offset:8192
    v_mfma_f32_16x16x32_bf16 v[156:159], v[28:31], v[60:63], v[156:159]
    s_waitcnt lgkmcnt(3)
    ds_read_b128 v[36:39], v7 offset:10240
    v_mfma_f32_16x16x32_bf16 v[160:163], v[16:19], v[48:51], v[160:163]
    ds_read_b128 v[60:63], v9 offset:51200
    v_mfma_f32_16x16x32_bf16 v[164:167], v[20:23], v[48:51], v[164:167]
    v_mfma_f32_16x16x32_bf16 v[168:171], v[24:27], v[48:51], v[168:171]
    ds_read_b128 v[40:43], v7 offset:12288
    v_mfma_f32_16x16x32_bf16 v[172:175], v[28:31], v[48:51], v[172:175]
    s_waitcnt lgkmcnt(5)
    ds_read_b128 v[44:47], v7 offset:14336
    v_mfma_f32_16x16x32_bf16 v[176:179], v[16:19], v[52:55], v[176:179]
    s_mov_b32 s45, 896
    ds_read_b128 v[48:51], v9 offset:41984
    v_mfma_f32_16x16x32_bf16 v[180:183], v[20:23], v[52:55], v[180:183]
    s_add_u32 m0, s43, 8192
    v_mfma_f32_16x16x32_bf16 v[184:187], v[24:27], v[52:55], v[184:187]
    buffer_load_dwordx4 v1, s[4:7], s45 offen lds
    v_mfma_f32_16x16x32_bf16 v[188:191], v[28:31], v[52:55], v[188:191]
    s_waitcnt lgkmcnt(5)
    buffer_load_dwordx4 v2, s[4:7], s45 offen offset:1024 lds
    v_mfma_f32_16x16x32_bf16 v[96:99], v[32:35], v[56:59], v[96:99]
    s_waitcnt lgkmcnt(4)
    s_mov_b32 s46, 6016
    ds_read_b128 v[52:55], v9 offset:52224
    v_mfma_f32_16x16x32_bf16 v[100:103], v[36:39], v[56:59], v[100:103]
    s_waitcnt lgkmcnt(3)
    s_add_u32 m0, s43, 10240
    v_mfma_f32_16x16x32_bf16 v[104:107], v[40:43], v[56:59], v[104:107]
    s_waitcnt lgkmcnt(2)
    buffer_load_dwordx4 v1, s[4:7], s46 offen lds
    v_mfma_f32_16x16x32_bf16 v[108:111], v[44:47], v[56:59], v[108:111]
    buffer_load_dwordx4 v2, s[4:7], s46 offen offset:1024 lds
    v_mfma_f32_16x16x32_bf16 v[112:115], v[32:35], v[60:63], v[112:115]
    s_mov_b32 s45, 11136
    ds_read_b128 v[56:59], v9 offset:43008
    v_mfma_f32_16x16x32_bf16 v[116:119], v[36:39], v[60:63], v[116:119]
    s_add_u32 m0, s43, 12288
    v_mfma_f32_16x16x32_bf16 v[120:123], v[40:43], v[60:63], v[120:123]
    buffer_load_dwordx4 v1, s[4:7], s45 offen lds
    v_mfma_f32_16x16x32_bf16 v[124:127], v[44:47], v[60:63], v[124:127]
    s_waitcnt lgkmcnt(2)
    s_mov_b32 s46, 16256
    buffer_load_dwordx4 v2, s[4:7], s45 offen offset:1024 lds
    v_mfma_f32_16x16x32_bf16 v[128:131], v[32:35], v[48:51], v[128:131]
    s_add_u32 m0, s43, 14336
    ds_read_b128 v[60:63], v9 offset:53248
    v_mfma_f32_16x16x32_bf16 v[132:135], v[36:39], v[48:51], v[132:135]
    buffer_load_dwordx4 v1, s[4:7], s46 offen lds
    v_mfma_f32_16x16x32_bf16 v[136:139], v[40:43], v[48:51], v[136:139]
    buffer_load_dwordx4 v2, s[4:7], s46 offen offset:1024 lds
    v_mfma_f32_16x16x32_bf16 v[140:143], v[44:47], v[48:51], v[140:143]
    s_waitcnt lgkmcnt(2)
    s_waitcnt vmcnt(11)
    s_barrier
    v_mfma_f32_16x16x32_bf16 v[144:147], v[32:35], v[52:55], v[144:147]
    ds_read_b128 v[48:51], v8 offset:0
    v_mfma_f32_16x16x32_bf16 v[148:151], v[36:39], v[52:55], v[148:151]
    v_mfma_f32_16x16x32_bf16 v[152:155], v[40:43], v[52:55], v[152:155]
    ds_read_b128 v[16:19], v6 offset:0
    v_mfma_f32_16x16x32_bf16 v[156:159], v[44:47], v[52:55], v[156:159]
    s_waitcnt lgkmcnt(3)
    ds_read_b128 v[20:23], v6 offset:2048
    v_mfma_f32_16x16x32_bf16 v[160:163], v[32:35], v[56:59], v[160:163]
    ds_read_b128 v[52:55], v8 offset:10240
    v_mfma_f32_16x16x32_bf16 v[164:167], v[36:39], v[56:59], v[164:167]
    v_mfma_f32_16x16x32_bf16 v[168:171], v[40:43], v[56:59], v[168:171]
    ds_read_b128 v[24:27], v6 offset:4096
    v_mfma_f32_16x16x32_bf16 v[172:175], v[44:47], v[56:59], v[172:175]
    s_waitcnt lgkmcnt(5)
    ds_read_b128 v[28:31], v6 offset:6144
    v_mfma_f32_16x16x32_bf16 v[176:179], v[32:35], v[60:63], v[176:179]
    ds_read_b128 v[56:59], v8 offset:1024
    v_mfma_f32_16x16x32_bf16 v[180:183], v[36:39], v[60:63], v[180:183]
    v_mfma_f32_16x16x32_bf16 v[184:187], v[40:43], v[60:63], v[184:187]
    v_mfma_f32_16x16x32_bf16 v[188:191], v[44:47], v[60:63], v[188:191]
    s_waitcnt lgkmcnt(5)
    v_mfma_f32_16x16x32_bf16 v[96:99], v[16:19], v[48:51], v[96:99]
    s_waitcnt lgkmcnt(4)
    s_mov_b32 s46, 1024
    ds_read_b128 v[60:63], v8 offset:11264
    v_bfe_u32 v85, v0, 3, 2
    v_mfma_f32_16x16x32_bf16 v[100:103], v[20:23], v[48:51], v[100:103]
    s_waitcnt lgkmcnt(3)
    s_add_u32 m0, s44, 40960
    v_bfe_u32 v83, v0, 2, 1
    v_mfma_f32_16x16x32_bf16 v[104:107], v[24:27], v[48:51], v[104:107]
    s_waitcnt lgkmcnt(2)
    buffer_load_dwordx4 v3, s[8:11], s46 offen lds
    v_mfma_f32_16x16x32_bf16 v[108:111], v[28:31], v[48:51], v[108:111]
    v_lshlrev_b32 v85, 6, v85
    v_mfma_f32_16x16x32_bf16 v[112:115], v[16:19], v[52:55], v[112:115]
    s_mov_b32 s45, 21504
    ds_read_b128 v[48:51], v8 offset:2048
    v_lshl_add_u32 v85, v83, 12, v85
    v_mfma_f32_16x16x32_bf16 v[116:119], v[20:23], v[52:55], v[116:119]
    s_add_u32 m0, s44, 41984
    v_and_b32 v83, 3, v0
    v_mfma_f32_16x16x32_bf16 v[120:123], v[24:27], v[52:55], v[120:123]
    s_lshl_b32 s56, s50, 6
    buffer_load_dwordx4 v3, s[8:11], s45 offen lds
    v_mfma_f32_16x16x32_bf16 v[124:127], v[28:31], v[52:55], v[124:127]
    s_waitcnt lgkmcnt(2)
    v_lshl_add_u32 v85, v83, 4, v85
    v_mfma_f32_16x16x32_bf16 v[128:131], v[16:19], v[56:59], v[128:131]
    s_mov_b32 s46, 41984
    ds_read_b128 v[52:55], v8 offset:12288
    v_mfma_f32_16x16x32_bf16 v[132:135], v[20:23], v[56:59], v[132:135]
    s_add_u32 m0, s44, 43008
    v_mfma_f32_16x16x32_bf16 v[136:139], v[24:27], v[56:59], v[136:139]
    s_add_u32 s56, s56, 32768
    buffer_load_dwordx4 v3, s[8:11], s46 offen lds
    v_mfma_f32_16x16x32_bf16 v[140:143], v[28:31], v[56:59], v[140:143]
    s_waitcnt lgkmcnt(2)
    v_mfma_f32_16x16x32_bf16 v[144:147], v[16:19], v[60:63], v[144:147]
    s_lshl_b32 s57, s49, 9
    ds_read_b128 v[56:59], v9 offset:0
    v_mfma_f32_16x16x32_bf16 v[148:151], v[20:23], v[60:63], v[148:151]
    v_add_u32 v85, s56, v85
    v_mfma_f32_16x16x32_bf16 v[152:155], v[24:27], v[60:63], v[152:155]
    ds_read_b128 v[32:35], v7 offset:0
    v_add_u32 v84, s57, v14
    v_mfma_f32_16x16x32_bf16 v[156:159], v[28:31], v[60:63], v[156:159]
    s_waitcnt lgkmcnt(3)
    ds_read_b128 v[36:39], v7 offset:2048
    v_cndmask_b32 v84, v84, v85, s[62:63]
    v_mfma_f32_16x16x32_bf16 v[160:163], v[16:19], v[48:51], v[160:163]
    ds_read_b128 v[60:63], v9 offset:10240
    v_cndmask_b32 v84, v84, v85, s[96:97]
    v_mfma_f32_16x16x32_bf16 v[164:167], v[20:23], v[48:51], v[164:167]
    v_bfe_u32 v85, v0, 1, 2
    v_mfma_f32_16x16x32_bf16 v[168:171], v[24:27], v[48:51], v[168:171]
    ds_read_b128 v[40:43], v7 offset:4096
    v_and_b32 v83, 1, v0
    v_mfma_f32_16x16x32_bf16 v[172:175], v[28:31], v[48:51], v[172:175]
    s_waitcnt lgkmcnt(5)
    ds_read_b128 v[44:47], v7 offset:6144
    v_lshlrev_b32 v85, 7, v85
    v_mfma_f32_16x16x32_bf16 v[176:179], v[16:19], v[52:55], v[176:179]
    s_mov_b32 s45, 1024
    ds_read_b128 v[48:51], v9 offset:1024
    v_mfma_f32_16x16x32_bf16 v[180:183], v[20:23], v[52:55], v[180:183]
    s_add_u32 m0, s43, 0
    v_mfma_f32_16x16x32_bf16 v[184:187], v[24:27], v[52:55], v[184:187]
    s_lshl_b32 s56, s52, 4
    buffer_load_dwordx4 v1, s[4:7], s45 offen lds
    v_mfma_f32_16x16x32_bf16 v[188:191], v[28:31], v[52:55], v[188:191]
    s_waitcnt lgkmcnt(5)
    buffer_load_dwordx4 v2, s[4:7], s45 offen offset:1024 lds
    v_mfma_f32_16x16x32_bf16 v[96:99], v[32:35], v[56:59], v[96:99]
    s_waitcnt lgkmcnt(4)
    s_mov_b32 s46, 6144
    ds_read_b128 v[52:55], v9 offset:11264
    v_lshl_add_u32 v85, v83, 4, v85
    v_mfma_f32_16x16x32_bf16 v[100:103], v[36:39], v[56:59], v[100:103]
    s_waitcnt lgkmcnt(3)
    s_add_u32 m0, s43, 2048
    v_mfma_f32_16x16x32_bf16 v[104:107], v[40:43], v[56:59], v[104:107]
    s_waitcnt lgkmcnt(2)
    s_add_u32 s56, s56, s40
    buffer_load_dwordx4 v1, s[4:7], s46 offen lds
    v_mfma_f32_16x16x32_bf16 v[108:111], v[44:47], v[56:59], v[108:111]
    buffer_load_dwordx4 v2, s[4:7], s46 offen offset:1024 lds
    v_mfma_f32_16x16x32_bf16 v[112:115], v[32:35], v[60:63], v[112:115]
    s_mov_b32 s45, 11264
    ds_read_b128 v[56:59], v9 offset:2048
    v_cmp_lt_u32 vcc, 55, v0
    v_mfma_f32_16x16x32_bf16 v[116:119], v[36:39], v[60:63], v[116:119]
    s_add_u32 m0, s43, 4096
    v_mfma_f32_16x16x32_bf16 v[120:123], v[40:43], v[60:63], v[120:123]
    s_lshl_b32 s56, s56, 5
    buffer_load_dwordx4 v1, s[4:7], s45 offen lds
    v_mfma_f32_16x16x32_bf16 v[124:127], v[44:47], v[60:63], v[124:127]
    s_waitcnt lgkmcnt(2)
    s_mov_b32 s46, 16384
    buffer_load_dwordx4 v2, s[4:7], s45 offen offset:1024 lds
    v_mfma_f32_16x16x32_bf16 v[128:131], v[32:35], v[48:51], v[128:131]
    s_add_u32 m0, s43, 6144
    ds_read_b128 v[60:63], v9 offset:12288
    v_add_u32 v85, s56, v85
    v_mfma_f32_16x16x32_bf16 v[132:135], v[36:39], v[48:51], v[132:135]
    buffer_load_dwordx4 v1, s[4:7], s46 offen lds
    v_mfma_f32_16x16x32_bf16 v[136:139], v[40:43], v[48:51], v[136:139]
    buffer_load_dwordx4 v2, s[4:7], s46 offen offset:1024 lds
    v_mfma_f32_16x16x32_bf16 v[140:143], v[44:47], v[48:51], v[140:143]
    s_waitcnt lgkmcnt(2)
    s_waitcnt vmcnt(11)
    s_barrier
    v_mfma_f32_16x16x32_bf16 v[144:147], v[32:35], v[52:55], v[144:147]
    ds_read_b128 v[48:51], v8 offset:20480
    v_cndmask_b32 v84, v84, v85, vcc
    v_mfma_f32_16x16x32_bf16 v[148:151], v[36:39], v[52:55], v[148:151]
    v_mfma_f32_16x16x32_bf16 v[152:155], v[40:43], v[52:55], v[152:155]
    ds_read_b128 v[16:19], v6 offset:8192
    v_mfma_f32_16x16x32_bf16 v[156:159], v[44:47], v[52:55], v[156:159]
    s_waitcnt lgkmcnt(3)
    ds_read_b128 v[20:23], v6 offset:10240
    v_mfma_f32_16x16x32_bf16 v[160:163], v[32:35], v[56:59], v[160:163]
    ds_read_b128 v[52:55], v8 offset:30720
    v_mfma_f32_16x16x32_bf16 v[164:167], v[36:39], v[56:59], v[164:167]
    v_mfma_f32_16x16x32_bf16 v[168:171], v[40:43], v[56:59], v[168:171]
    ds_read_b128 v[24:27], v6 offset:12288
    v_mfma_f32_16x16x32_bf16 v[172:175], v[44:47], v[56:59], v[172:175]
    s_waitcnt lgkmcnt(5)
    ds_read_b128 v[28:31], v6 offset:14336
    v_mfma_f32_16x16x32_bf16 v[176:179], v[32:35], v[60:63], v[176:179]
    ds_read_b128 v[56:59], v8 offset:21504
    v_mfma_f32_16x16x32_bf16 v[180:183], v[36:39], v[60:63], v[180:183]
    v_mfma_f32_16x16x32_bf16 v[184:187], v[40:43], v[60:63], v[184:187]
    buffer_load_dword v93, v92, s[20:23], s66 offen sc1
    v_mfma_f32_16x16x32_bf16 v[188:191], v[44:47], v[60:63], v[188:191]
    s_waitcnt lgkmcnt(5)
    v_mfma_f32_16x16x32_bf16 v[96:99], v[16:19], v[48:51], v[96:99]
    s_waitcnt lgkmcnt(4)
    s_mov_b32 s46, 1152
    ds_read_b128 v[60:63], v8 offset:31744
    v_mfma_f32_16x16x32_bf16 v[100:103], v[20:23], v[48:51], v[100:103]
    s_waitcnt lgkmcnt(3)
    s_add_u32 m0, s44, 0
    v_mfma_f32_16x16x32_bf16 v[104:107], v[24:27], v[48:51], v[104:107]
    s_waitcnt lgkmcnt(2)
    buffer_load_dwordx4 v3, s[8:11], s46 offen lds
    v_mfma_f32_16x16x32_bf16 v[108:111], v[28:31], v[48:51], v[108:111]
    v_mfma_f32_16x16x32_bf16 v[112:115], v[16:19], v[52:55], v[112:115]
    s_mov_b32 s45, 21632
    ds_read_b128 v[48:51], v8 offset:22528
    v_mfma_f32_16x16x32_bf16 v[116:119], v[20:23], v[52:55], v[116:119]
    s_add_u32 m0, s44, 1024
    v_mfma_f32_16x16x32_bf16 v[120:123], v[24:27], v[52:55], v[120:123]
    buffer_load_dwordx4 v3, s[8:11], s45 offen lds
    v_mfma_f32_16x16x32_bf16 v[124:127], v[28:31], v[52:55], v[124:127]
    s_waitcnt lgkmcnt(2)
    v_mfma_f32_16x16x32_bf16 v[128:131], v[16:19], v[56:59], v[128:131]
    s_mov_b32 s46, 42112
    ds_read_b128 v[52:55], v8 offset:32768
    v_mfma_f32_16x16x32_bf16 v[132:135], v[20:23], v[56:59], v[132:135]
    s_add_u32 m0, s44, 2048
    v_mfma_f32_16x16x32_bf16 v[136:139], v[24:27], v[56:59], v[136:139]
    buffer_load_dwordx4 v3, s[8:11], s46 offen lds
    v_mfma_f32_16x16x32_bf16 v[140:143], v[28:31], v[56:59], v[140:143]
    s_waitcnt lgkmcnt(2)
    v_mfma_f32_16x16x32_bf16 v[144:147], v[16:19], v[60:63], v[144:147]
    ds_read_b128 v[56:59], v9 offset:20480
    v_mfma_f32_16x16x32_bf16 v[148:151], v[20:23], v[60:63], v[148:151]
    v_mfma_f32_16x16x32_bf16 v[152:155], v[24:27], v[60:63], v[152:155]
    ds_read_b128 v[32:35], v7 offset:8192
    v_mfma_f32_16x16x32_bf16 v[156:159], v[28:31], v[60:63], v[156:159]
    s_waitcnt lgkmcnt(3)
    ds_read_b128 v[36:39], v7 offset:10240
    v_mfma_f32_16x16x32_bf16 v[160:163], v[16:19], v[48:51], v[160:163]
    ds_read_b128 v[60:63], v9 offset:30720
    v_mfma_f32_16x16x32_bf16 v[164:167], v[20:23], v[48:51], v[164:167]
    v_mfma_f32_16x16x32_bf16 v[168:171], v[24:27], v[48:51], v[168:171]
    ds_read_b128 v[40:43], v7 offset:12288
    v_mfma_f32_16x16x32_bf16 v[172:175], v[28:31], v[48:51], v[172:175]
    s_waitcnt lgkmcnt(5)
    ds_read_b128 v[44:47], v7 offset:14336
    v_mfma_f32_16x16x32_bf16 v[176:179], v[16:19], v[52:55], v[176:179]
    s_mov_b32 s45, 1152
    ds_read_b128 v[48:51], v9 offset:21504
    v_mfma_f32_16x16x32_bf16 v[180:183], v[20:23], v[52:55], v[180:183]
    s_add_u32 m0, s43, 8192
    v_mfma_f32_16x16x32_bf16 v[184:187], v[24:27], v[52:55], v[184:187]
    buffer_load_dwordx4 v1, s[4:7], s45 offen lds
    v_mfma_f32_16x16x32_bf16 v[188:191], v[28:31], v[52:55], v[188:191]
    s_waitcnt lgkmcnt(5)
    buffer_load_dwordx4 v2, s[4:7], s45 offen offset:1024 lds
    v_mfma_f32_16x16x32_bf16 v[96:99], v[32:35], v[56:59], v[96:99]
    s_waitcnt lgkmcnt(4)
    s_mov_b32 s46, 6272
    ds_read_b128 v[52:55], v9 offset:31744
    v_mfma_f32_16x16x32_bf16 v[100:103], v[36:39], v[56:59], v[100:103]
    s_waitcnt lgkmcnt(3)
    s_add_u32 m0, s43, 10240
    v_mfma_f32_16x16x32_bf16 v[104:107], v[40:43], v[56:59], v[104:107]
    s_waitcnt lgkmcnt(2)
    buffer_load_dwordx4 v1, s[4:7], s46 offen lds
    v_mfma_f32_16x16x32_bf16 v[108:111], v[44:47], v[56:59], v[108:111]
    buffer_load_dwordx4 v2, s[4:7], s46 offen offset:1024 lds
    v_mfma_f32_16x16x32_bf16 v[112:115], v[32:35], v[60:63], v[112:115]
    s_mov_b32 s45, 11392
    ds_read_b128 v[56:59], v9 offset:22528
    v_mfma_f32_16x16x32_bf16 v[116:119], v[36:39], v[60:63], v[116:119]
    s_add_u32 m0, s43, 12288
    v_mfma_f32_16x16x32_bf16 v[120:123], v[40:43], v[60:63], v[120:123]
    buffer_load_dwordx4 v1, s[4:7], s45 offen lds
    v_mfma_f32_16x16x32_bf16 v[124:127], v[44:47], v[60:63], v[124:127]
    s_waitcnt lgkmcnt(2)
    s_mov_b32 s46, 16512
    buffer_load_dwordx4 v2, s[4:7], s45 offen offset:1024 lds
    v_mfma_f32_16x16x32_bf16 v[128:131], v[32:35], v[48:51], v[128:131]
    s_add_u32 m0, s43, 14336
    ds_read_b128 v[60:63], v9 offset:32768
    v_mfma_f32_16x16x32_bf16 v[132:135], v[36:39], v[48:51], v[132:135]
    buffer_load_dwordx4 v1, s[4:7], s46 offen lds
    v_mfma_f32_16x16x32_bf16 v[136:139], v[40:43], v[48:51], v[136:139]
    buffer_load_dwordx4 v2, s[4:7], s46 offen offset:1024 lds
    v_mfma_f32_16x16x32_bf16 v[140:143], v[44:47], v[48:51], v[140:143]
L_st_10:
    s_cbranch_execz L_st_11
    s_waitcnt lgkmcnt(2)
    s_waitcnt vmcnt(12)
    s_waitcnt vmcnt(11)
    v_cmp_ne_u32 vcc, 1, v93
    s_mov_b32 s55, 0
    s_cbranch_vccz L_ok_24
L_sp_25:
    s_sleep 16
    buffer_load_dword v93, v92, s[20:23], s66 offen sc1
    s_add_u32 s55, s55, 1
    s_cmp_gt_u32 s55, 200000
    s_cbranch_scc1 L_ok_24
    s_waitcnt vmcnt(0)
    v_cmp_ne_u32 vcc, 1, v93
    s_nop 0
    s_cbranch_vccnz L_sp_25
L_ok_24:
    s_barrier
    v_mfma_f32_16x16x32_bf16 v[144:147], v[32:35], v[52:55], v[144:147]
    s_add_u32 m0, s48, 4096
    ds_read_b128 v[48:51], v8 offset:40960
    v_mfma_f32_16x16x32_bf16 v[148:151], v[36:39], v[52:55], v[148:151]
    buffer_load_dwordx4 v84, s[20:23], 0 offen sc1 lds
    v_mfma_f32_16x16x32_bf16 v[152:155], v[40:43], v[52:55], v[152:155]
    ds_read_b128 v[16:19], v6 offset:0
    v_mfma_f32_16x16x32_bf16 v[156:159], v[44:47], v[52:55], v[156:159]
    s_waitcnt lgkmcnt(3)
    ds_read_b128 v[20:23], v6 offset:2048
    v_mfma_f32_16x16x32_bf16 v[160:163], v[32:35], v[56:59], v[160:163]
    s_mov_b32 s47, 0
    ds_read_b128 v[52:55], v8 offset:51200
    v_mfma_f32_16x16x32_bf16 v[164:167], v[36:39], v[56:59], v[164:167]
    buffer_load_dwordx4 a[0:3], v14, s[36:39], s47 offen offset:0 sc1
    v_mfma_f32_16x16x32_bf16 v[168:171], v[40:43], v[56:59], v[168:171]
    ds_read_b128 v[24:27], v6 offset:4096
    v_mfma_f32_16x16x32_bf16 v[172:175], v[44:47], v[56:59], v[172:175]
    s_waitcnt lgkmcnt(5)
    ds_read_b128 v[28:31], v6 offset:6144
    v_mfma_f32_16x16x32_bf16 v[176:179], v[32:35], v[60:63], v[176:179]
    ds_read_b128 v[56:59], v8 offset:41984
    v_mfma_f32_16x16x32_bf16 v[180:183], v[36:39], v[60:63], v[180:183]
    v_mfma_f32_16x16x32_bf16 v[184:187], v[40:43], v[60:63], v[184:187]
    buffer_load_dwordx4 a[4:7], v14, s[36:39], s47 offen offset:1024 sc1
    v_mfma_f32_16x16x32_bf16 v[188:191], v[44:47], v[60:63], v[188:191]
    s_waitcnt lgkmcnt(5)
    v_mfma_f32_16x16x32_bf16 v[96:99], v[16:19], v[48:51], v[96:99]
    s_waitcnt lgkmcnt(4)
    s_mul_i32 s43, s40, 20480
    ds_read_b128 v[60:63], v8 offset:52224
    v_mfma_f32_16x16x32_bf16 v[100:103], v[20:23], v[48:51], v[100:103]
    s_waitcnt lgkmcnt(3)
    v_lshrrev_b32 v3, 4, v0
    v_mfma_f32_16x16x32_bf16 v[104:107], v[24:27], v[48:51], v[104:107]
    s_waitcnt lgkmcnt(2)
    buffer_load_dwordx4 a[8:11], v14, s[36:39], s47 offen offset:2048 sc1
    v_mfma_f32_16x16x32_bf16 v[108:111], v[28:31], v[48:51], v[108:111]
    v_and_b32 v5, 15, v0
    v_mfma_f32_16x16x32_bf16 v[112:115], v[16:19], v[52:55], v[112:115]
    ds_read_b128 v[48:51], v8 offset:43008
    v_lshlrev_b32 v88, 7, v3
    v_mfma_f32_16x16x32_bf16 v[116:119], v[20:23], v[52:55], v[116:119]
    v_add_u32 v88, s48, v88
    v_mfma_f32_16x16x32_bf16 v[120:123], v[24:27], v[52:55], v[120:123]
    buffer_load_dwordx4 a[12:15], v14, s[36:39], s47 offen offset:3072 sc1
    v_mfma_f32_16x16x32_bf16 v[124:127], v[28:31], v[52:55], v[124:127]
    s_waitcnt lgkmcnt(2)
    v_lshl_add_u32 v89, v5, 2, s48
    v_mfma_f32_16x16x32_bf16 v[128:131], v[16:19], v[56:59], v[128:131]
    s_sub_u32 s56, 56, s49
    ds_read_b128 v[52:55], v8 offset:53248
    v_mfma_f32_16x16x32_bf16 v[132:135], v[20:23], v[56:59], v[132:135]
    s_add_u32 s47, s47, 1024
    v_mfma_f32_16x16x32_bf16 v[136:139], v[24:27], v[56:59], v[136:139]
    s_lshl_b32 s56, s56, 7
    buffer_load_dwordx4 a[16:19], v14, s[36:39], s47 offen offset:3072 sc1
    v_mfma_f32_16x16x32_bf16 v[140:143], v[28:31], v[56:59], v[140:143]
    s_waitcnt lgkmcnt(2)
    v_lshl_add_u32 v91, v5, 3, s56
    v_mfma_f32_16x16x32_bf16 v[144:147], v[16:19], v[60:63], v[144:147]
    s_mov_b32 s47, 5120
    ds_read_b128 v[56:59], v9 offset:40960
    v_lshlrev_b32 v4, 10, v3
    v_mfma_f32_16x16x32_bf16 v[148:151], v[20:23], v[60:63], v[148:151]
    buffer_load_dwordx4 a[20:23], v14, s[36:39], s47 offen offset:0 sc1
    v_mfma_f32_16x16x32_bf16 v[152:155], v[24:27], v[60:63], v[152:155]
    ds_read_b128 v[32:35], v7 offset:0
    v_sub_u32 v91, v91, v4
    v_mfma_f32_16x16x32_bf16 v[156:159], v[28:31], v[60:63], v[156:159]
    s_waitcnt lgkmcnt(3)
    ds_read_b128 v[36:39], v7 offset:2048
    v_mfma_f32_16x16x32_bf16 v[160:163], v[16:19], v[48:51], v[160:163]
    s_sub_u32 s83, s56, 3200
    ds_read_b128 v[60:63], v9 offset:51200
    v_mfma_f32_16x16x32_bf16 v[164:167], v[20:23], v[48:51], v[164:167]
    buffer_load_dwordx4 a[24:27], v14, s[36:39], s47 offen offset:1024 sc1
    v_mfma_f32_16x16x32_bf16 v[168:171], v[24:27], v[48:51], v[168:171]
    ds_read_b128 v[40:43], v7 offset:4096
    v_bfe_u32 v4, v0, 2, 2
    v_mfma_f32_16x16x32_bf16 v[172:175], v[28:31], v[48:51], v[172:175]
    s_waitcnt lgkmcnt(5)
    ds_read_b128 v[44:47], v7 offset:6144
    v_xor_b32 v4, v4, v3
    v_mfma_f32_16x16x32_bf16 v[176:179], v[16:19], v[52:55], v[176:179]
    ds_read_b128 v[48:51], v9 offset:41984
    v_lshlrev_b32 v92, 5, v5
    v_mfma_f32_16x16x32_bf16 v[180:183], v[20:23], v[52:55], v[180:183]
    v_lshl_add_u32 v92, v4, 3, v92
    v_mfma_f32_16x16x32_bf16 v[184:187], v[24:27], v[52:55], v[184:187]
    buffer_load_dwordx4 a[28:31], v14, s[36:39], s47 offen offset:2048 sc1
    v_mfma_f32_16x16x32_bf16 v[188:191], v[28:31], v[52:55], v[188:191]
    s_waitcnt lgkmcnt(5)
    v_add_u32 v92, s43, v92
    v_mfma_f32_16x16x32_bf16 v[96:99], v[32:35], v[56:59], v[96:99]
    s_waitcnt lgkmcnt(4)
    ds_read_b128 v[52:55], v9 offset:52224
    v_xor_b32 v93, v0, v3
    v_mfma_f32_16x16x32_bf16 v[100:103], v[36:39], v[56:59], v[100:103]
    s_waitcnt lgkmcnt(3)
    v_lshl_add_u32 v93, v93, 3, s43
    v_mfma_f32_16x16x32_bf16 v[104:107], v[40:43], v[56:59], v[104:107]
    s_waitcnt lgkmcnt(2)
    buffer_load_dwordx4 a[32:35], v14, s[36:39], s47 offen offset:3072 sc1
    v_mfma_f32_16x16x32_bf16 v[108:111], v[44:47], v[56:59], v[108:111]
    v_and_b32 v2, 7, v0
    v_mfma_f32_16x16x32_bf16 v[112:115], v[32:35], v[60:63], v[112:115]
    ds_read_b128 v[56:59], v9 offset:43008
    v_lshl_add_u32 v2, v2, 2, s40
    v_mfma_f32_16x16x32_bf16 v[116:119], v[36:39], v[60:63], v[116:119]
    s_add_u32 s47, s47, 1024
    v_cmp_gt_u32 vcc, 27, v2
    v_mfma_f32_16x16x32_bf16 v[120:123], v[40:43], v[60:63], v[120:123]
    buffer_load_dwordx4 a[36:39], v14, s[36:39], s47 offen offset:3072 sc1
    v_mfma_f32_16x16x32_bf16 v[124:127], v[44:47], v[60:63], v[124:127]
    s_waitcnt lgkmcnt(2)
    v_mov_b32 v1, s40
    v_mfma_f32_16x16x32_bf16 v[128:131], v[32:35], v[48:51], v[128:131]
    ds_read_b128 v[60:63], v9 offset:53248
    v_and_b32 v4, 31, v0
    v_mfma_f32_16x16x32_bf16 v[132:135], v[36:39], v[48:51], v[132:135]
    s_mov_b32 s47, 10240
    v_cndmask_b32 v1, v1, v2, vcc
    v_mfma_f32_16x16x32_bf16 v[136:139], v[40:43], v[48:51], v[136:139]
    buffer_load_dwordx4 a[40:43], v14, s[36:39], s47 offen offset:0 sc1
    v_mfma_f32_16x16x32_bf16 v[140:143], v[44:47], v[48:51], v[140:143]
    s_waitcnt lgkmcnt(2)
    s_waitcnt vmcnt(12)
    s_barrier
    v_mfma_f32_16x16x32_bf16 v[144:147], v[32:35], v[52:55], v[144:147]
    ds_read_b128 v[48:51], v8 offset:0
    v_cmp_gt_u32 vcc, 8, v4
    v_mfma_f32_16x16x32_bf16 v[148:151], v[36:39], v[52:55], v[148:151]
    buffer_load_dwordx4 a[44:47], v14, s[36:39], s47 offen offset:1024 sc1
    v_mfma_f32_16x16x32_bf16 v[152:155], v[40:43], v[52:55], v[152:155]
    ds_read_b128 v[16:19], v6 offset:8192
    v_min_u32 v4, 12, v4
    v_mfma_f32_16x16x32_bf16 v[156:159], v[44:47], v[52:55], v[156:159]
    s_waitcnt lgkmcnt(3)
    ds_read_b128 v[20:23], v6 offset:10240
    v_add_u32 v4, 19, v4
    v_mfma_f32_16x16x32_bf16 v[160:163], v[32:35], v[56:59], v[160:163]
    ds_read_b128 v[52:55], v8 offset:10240
    v_cndmask_b32 v2, v4, v2, vcc
    v_mfma_f32_16x16x32_bf16 v[164:167], v[36:39], v[56:59], v[164:167]
    buffer_load_dwordx4 a[48:51], v14, s[36:39], s47 offen offset:2048 sc1
    v_mfma_f32_16x16x32_bf16 v[168:171], v[40:43], v[56:59], v[168:171]
    ds_read_b128 v[24:27], v6 offset:12288
    v_and_or_b32 v2, v0, 32, v2
    v_mfma_f32_16x16x32_bf16 v[172:175], v[44:47], v[56:59], v[172:175]
    s_waitcnt lgkmcnt(5)
    ds_read_b128 v[28:31], v6 offset:14336
    v_lshlrev_b32 v2, 7, v2
    v_mfma_f32_16x16x32_bf16 v[176:179], v[32:35], v[60:63], v[176:179]
    ds_read_b128 v[56:59], v8 offset:1024
    v_lshlrev_b32 v1, 7, v1
    v_mfma_f32_16x16x32_bf16 v[180:183], v[36:39], v[60:63], v[180:183]
    s_andn2_b32 s58, s52, 1
    v_mfma_f32_16x16x32_bf16 v[184:187], v[40:43], v[60:63], v[184:187]
    s_lshl_b32 s58, s58, 12
    buffer_load_dwordx4 a[52:55], v14, s[36:39], s47 offen offset:3072 sc1
    v_mfma_f32_16x16x32_bf16 v[188:191], v[44:47], v[60:63], v[188:191]
    s_waitcnt lgkmcnt(5)
    v_mfma_f32_16x16x32_bf16 v[96:99], v[16:19], v[48:51], v[96:99]
    s_waitcnt lgkmcnt(4)
    s_add_u32 s44, s58, 393216
    ds_read_b128 v[60:63], v8 offset:11264
    v_mfma_f32_16x16x32_bf16 v[100:103], v[20:23], v[48:51], v[100:103]
    s_waitcnt lgkmcnt(3)
    s_add_u32 s47, s47, 1024
    v_mfma_f32_16x16x32_bf16 v[104:107], v[24:27], v[48:51], v[104:107]
    s_waitcnt lgkmcnt(2)
    s_xor_b32 s58, s52, 1
    buffer_load_dwordx4 a[56:59], v14, s[36:39], s47 offen offset:3072 sc1
    v_mfma_f32_16x16x32_bf16 v[108:111], v[28:31], v[48:51], v[108:111]
    v_mfma_f32_16x16x32_bf16 v[112:115], v[16:19], v[52:55], v[112:115]
    s_lshl_b32 s58, s58, 12
    ds_read_b128 v[48:51], v8 offset:2048
    v_mfma_f32_16x16x32_bf16 v[116:119], v[20:23], v[52:55], v[116:119]
    s_mov_b32 s47, 15360
    v_mfma_f32_16x16x32_bf16 v[120:123], v[24:27], v[52:55], v[120:123]
    s_add_u32 s100, s58, 262144
    buffer_load_dwordx4 a[60:63], v14, s[36:39], s47 offen offset:0 sc1
    v_mfma_f32_16x16x32_bf16 v[124:127], v[28:31], v[52:55], v[124:127]
    s_waitcnt lgkmcnt(2)
    v_mfma_f32_16x16x32_bf16 v[128:131], v[16:19], v[56:59], v[128:131]
    ds_read_b128 v[52:55], v8 offset:12288
    v_mfma_f32_16x16x32_bf16 v[132:135], v[20:23], v[56:59], v[132:135]
    v_mfma_f32_16x16x32_bf16 v[136:139], v[24:27], v[56:59], v[136:139]
    buffer_load_dwordx4 a[64:67], v14, s[36:39], s47 offen offset:1024 sc1
    v_mfma_f32_16x16x32_bf16 v[140:143], v[28:31], v[56:59], v[140:143]
    s_waitcnt lgkmcnt(2)
    v_mfma_f32_16x16x32_bf16 v[144:147], v[16:19], v[60:63], v[144:147]
    ds_read_b128 v[56:59], v9 offset:0
    v_mfma_f32_16x16x32_bf16 v[148:151], v[20:23], v[60:63], v[148:151]
    buffer_load_dwordx4 a[68:71], v14, s[36:39], s47 offen offset:2048 sc1
    v_mfma_f32_16x16x32_bf16 v[152:155], v[24:27], v[60:63], v[152:155]
    ds_read_b128 v[32:35], v7 offset:8192
    v_mfma_f32_16x16x32_bf16 v[156:159], v[28:31], v[60:63], v[156:159]
    s_waitcnt lgkmcnt(3)
    ds_read_b128 v[36:39], v7 offset:10240
    v_mfma_f32_16x16x32_bf16 v[160:163], v[16:19], v[48:51], v[160:163]
    ds_read_b128 v[60:63], v9 offset:10240
    v_mfma_f32_16x16x32_bf16 v[164:167], v[20:23], v[48:51], v[164:167]
    buffer_load_dwordx4 a[72:75], v14, s[36:39], s47 offen offset:3072 sc1
    v_mfma_f32_16x16x32_bf16 v[168:171], v[24:27], v[48:51], v[168:171]
    ds_read_b128 v[40:43], v7 offset:12288
    v_mfma_f32_16x16x32_bf16 v[172:175], v[28:31], v[48:51], v[172:175]
    s_waitcnt lgkmcnt(5)
    ds_read_b128 v[44:47], v7 offset:14336
    v_mfma_f32_16x16x32_bf16 v[176:179], v[16:19], v[52:55], v[176:179]
    ds_read_b128 v[48:51], v9 offset:1024
    v_mfma_f32_16x16x32_bf16 v[180:183], v[20:23], v[52:55], v[180:183]
    s_add_u32 s47, s47, 1024
    v_mfma_f32_16x16x32_bf16 v[184:187], v[24:27], v[52:55], v[184:187]
    buffer_load_dwordx4 a[76:79], v14, s[36:39], s47 offen offset:3072 sc1
    v_mfma_f32_16x16x32_bf16 v[188:191], v[28:31], v[52:55], v[188:191]
    s_waitcnt lgkmcnt(5)
    v_mfma_f32_16x16x32_bf16 v[96:99], v[32:35], v[56:59], v[96:99]
    s_waitcnt lgkmcnt(4)
    ds_read_b128 v[52:55], v9 offset:11264
    v_mfma_f32_16x16x32_bf16 v[100:103], v[36:39], v[56:59], v[100:103]
    s_waitcnt lgkmcnt(3)
    s_mov_b32 s47, 20480
    v_mfma_f32_16x16x32_bf16 v[104:107], v[40:43], v[56:59], v[104:107]
    s_waitcnt lgkmcnt(2)
    buffer_load_dwordx4 a[80:83], v14, s[36:39], s47 offen offset:0 sc1
    v_mfma_f32_16x16x32_bf16 v[108:111], v[44:47], v[56:59], v[108:111]
    v_mfma_f32_16x16x32_bf16 v[112:115], v[32:35], v[60:63], v[112:115]
    ds_read_b128 v[56:59], v9 offset:2048
    v_mfma_f32_16x16x32_bf16 v[116:119], v[36:39], v[60:63], v[116:119]
    v_mfma_f32_16x16x32_bf16 v[120:123], v[40:43], v[60:63], v[120:123]
    buffer_load_dwordx4 a[84:87], v14, s[36:39], s47 offen offset:1024 sc1
    v_mfma_f32_16x16x32_bf16 v[124:127], v[44:47], v[60:63], v[124:127]
    s_waitcnt lgkmcnt(2)
    v_mfma_f32_16x16x32_bf16 v[128:131], v[32:35], v[48:51], v[128:131]
    ds_read_b128 v[60:63], v9 offset:12288
    v_mfma_f32_16x16x32_bf16 v[132:135], v[36:39], v[48:51], v[132:135]
    v_mfma_f32_16x16x32_bf16 v[136:139], v[40:43], v[48:51], v[136:139]
    buffer_load_dwordx4 a[88:91], v14, s[36:39], s47 offen offset:2048 sc1
    v_mfma_f32_16x16x32_bf16 v[140:143], v[44:47], v[48:51], v[140:143]
    s_waitcnt lgkmcnt(2)
    v_mfma_f32_16x16x32_bf16 v[144:147], v[32:35], v[52:55], v[144:147]
    v_mfma_f32_16x16x32_bf16 v[148:151], v[36:39], v[52:55], v[148:151]
    buffer_load_dwordx4 a[92:95], v14, s[36:39], s47 offen offset:3072 sc1
    v_mfma_f32_16x16x32_bf16 v[152:155], v[40:43], v[52:55], v[152:155]
    v_mfma_f32_16x16x32_bf16 v[156:159], v[44:47], v[52:55], v[156:159]
    s_waitcnt lgkmcnt(1)
    v_mfma_f32_16x16x32_bf16 v[160:163], v[32:35], v[56:59], v[160:163]
    s_add_u32 s47, s47, 1024
    v_mfma_f32_16x16x32_bf16 v[164:167], v[36:39], v[56:59], v[164:167]
    buffer_load_dwordx4 a[96:99], v14, s[36:39], s47 offen offset:3072 sc1
    v_mfma_f32_16x16x32_bf16 v[168:171], v[40:43], v[56:59], v[168:171]
    v_mfma_f32_16x16x32_bf16 v[172:175], v[44:47], v[56:59], v[172:175]
    s_waitcnt lgkmcnt(0)
    v_mfma_f32_16x16x32_bf16 v[176:179], v[32:35], v[60:63], v[176:179]
    v_mfma_f32_16x16x32_bf16 v[180:183], v[36:39], v[60:63], v[180:183]
    s_mov_b32 s47, 25600
    v_mfma_f32_16x16x32_bf16 v[184:187], v[40:43], v[60:63], v[184:187]
    buffer_load_dwordx4 a[100:103], v14, s[36:39], s47 offen offset:0 sc1
    v_mfma_f32_16x16x32_bf16 v[188:191], v[44:47], v[60:63], v[188:191]
L_epy:
    s_barrier
    s_waitcnt vmcnt(26)
    ds_read_b128 v[48:51], v88 offset:4096
    ds_read_b128 v[52:55], v88 offset:4112
    ds_read_b128 v[56:59], v88 offset:4128
    ds_read_b128 v[60:63], v88 offset:4144
    ds_read_b128 v[224:227], v88 offset:4160
    ds_read_b128 v[228:231], v88 offset:4176
    ds_read_b128 v[232:235], v88 offset:4192
    ds_read_b128 v[236:239], v88 offset:4208
    s_lshl_b32 s56, s50, 12
    s_add_u32 s56, s56, 65536
    s_add_u32 s24, s94, s56
    s_addc_u32 s25, s95, 0
    s_mov_b32 s26, 4096
    s_mov_b32 s27, 0x20000
    ds_read_b32 v6, v89 offset:4608
    ds_read_b32 v7, v89 offset:4672
    v_pk_mul_f32 v[16:17], v[66:67], v[96:97] op_sel:[0,0] op_sel_hi:[1,0]
    v_pk_mul_f32 v[18:19], v[66:67], v[96:97] op_sel:[0,1] op_sel_hi:[1,1]
    v_pk_mul_f32 v[20:21], v[66:67], v[98:99] op_sel:[0,0] op_sel_hi:[1,0]
    v_pk_mul_f32 v[22:23], v[66:67], v[98:99] op_sel:[0,1] op_sel_hi:[1,1]
    v_pk_fma_f32 v[16:17], v[66:67], v[112:113], v[16:17] op_sel:[1,0,0] op_sel_hi:[0,0,1] neg_lo:[1,0,0]
    v_pk_fma_f32 v[18:19], v[66:67], v[112:113], v[18:19] op_sel:[1,1,0] op_sel_hi:[0,1,1] neg_lo:[1,0,0]
    v_pk_fma_f32 v[20:21], v[66:67], v[114:115], v[20:21] op_sel:[1,0,0] op_sel_hi:[0,0,1] neg_lo:[1,0,0]
    v_pk_fma_f32 v[22:23], v[66:67], v[114:115], v[22:23] op_sel:[1,1,0] op_sel_hi:[0,1,1] neg_lo:[1,0,0]
    v_pk_mul_f32 v[24:25], v[66:67], v[100:101] op_sel:[0,0] op_sel_hi:[1,0]
    v_pk_mul_f32 v[26:27], v[66:67], v[100:101] op_sel:[0,1] op_sel_hi:[1,1]
    v_pk_mul_f32 v[28:29], v[66:67], v[102:103] op_sel:[0,0] op_sel_hi:[1,0]
    v_pk_mul_f32 v[30:31], v[66:67], v[102:103] op_sel:[0,1] op_sel_hi:[1,1]
    v_pk_fma_f32 v[24:25], v[66:67], v[116:117], v[24:25] op_sel:[1,0,0] op_sel_hi:[0,0,1] neg_lo:[1,0,0]
    v_pk_fma_f32 v[26:27], v[66:67], v[116:117], v[26:27] op_sel:[1,1,0] op_sel_hi:[0,1,1] neg_lo:[1,0,0]
    v_pk_fma_f32 v[28:29], v[66:67], v[118:119], v[28:29] op_sel:[1,0,0] op_sel_hi:[0,0,1] neg_lo:[1,0,0]
    v_pk_fma_f32 v[30:31], v[66:67], v[118:119], v[30:31] op_sel:[1,1,0] op_sel_hi:[0,1,1] neg_lo:[1,0,0]
    buffer_load_dwordx4 a[104:107], v14, s[36:39], s47 offen offset:1024 sc1
    v_pk_mul_f32 v[32:33], v[66:67], v[104:105] op_sel:[0,0] op_sel_hi:[1,0]
    v_pk_mul_f32 v[34:35], v[66:67], v[104:105] op_sel:[0,1] op_sel_hi:[1,1]
    v_pk_mul_f32 v[36:37], v[66:67], v[106:107] op_sel:[0,0] op_sel_hi:[1,0]
    v_pk_mul_f32 v[38:39], v[66:67], v[106:107] op_sel:[0,1] op_sel_hi:[1,1]
    v_pk_fma_f32 v[32:33], v[66:67], v[120:121], v[32:33] op_sel:[1,0,0] op_sel_hi:[0,0,1] neg_lo:[1,0,0]
    v_pk_fma_f32 v[34:35], v[66:67], v[120:121], v[34:35] op_sel:[1,1,0] op_sel_hi:[0,1,1] neg_lo:[1,0,0]
    v_pk_fma_f32 v[36:37], v[66:67], v[122:123], v[36:37] op_sel:[1,0,0] op_sel_hi:[0,0,1] neg_lo:[1,0,0]
    v_pk_fma_f32 v[38:39], v[66:67], v[122:123], v[38:39] op_sel:[1,1,0] op_sel_hi:[0,1,1] neg_lo:[1,0,0]
    v_pk_mul_f32 v[40:41], v[66:67], v[108:109] op_sel:[0,0] op_sel_hi:[1,0]
    v_pk_mul_f32 v[42:43], v[66:67], v[108:109] op_sel:[0,1] op_sel_hi:[1,1]
    v_pk_mul_f32 v[44:45], v[66:67], v[110:111] op_sel:[0,0] op_sel_hi:[1,0]
    v_pk_mul_f32 v[46:47], v[66:67], v[110:111] op_sel:[0,1] op_sel_hi:[1,1]
    v_pk_fma_f32 v[40:41], v[66:67], v[124:125], v[40:41] op_sel:[1,0,0] op_sel_hi:[0,0,1] neg_lo:[1,0,0]
    v_pk_fma_f32 v[42:43], v[66:67], v[124:125], v[42:43] op_sel:[1,1,0] op_sel_hi:[0,1,1] neg_lo:[1,0,0]
    v_pk_fma_f32 v[44:45], v[66:67], v[126:127], v[44:45] op_sel:[1,0,0] op_sel_hi:[0,0,1] neg_lo:[1,0,0]
    v_pk_fma_f32 v[46:47], v[66:67], v[126:127], v[46:47] op_sel:[1,1,0] op_sel_hi:[0,1,1] neg_lo:[1,0,0]
    s_waitcnt lgkmcnt(0)
    v_pk_mul_f32 v[8:9], v[6:7], v[66:67] op_sel_hi:[1,0]
    v_pk_fma_f32 v[8:9], v[6:7], v[66:67], v[8:9] op_sel:[1,1,0] op_sel_hi:[0,1,1] neg_lo:[1,0,0]
    v_pk_fma_f32 v[16:17], v[8:9], v[48:49], v[16:17] op_sel_hi:[1,0,1]
    v_pk_fma_f32 v[18:19], v[8:9], v[50:51], v[18:19] op_sel_hi:[1,0,1]
    v_pk_fma_f32 v[20:21], v[8:9], v[52:53], v[20:21] op_sel_hi:[1,0,1]
    v_pk_fma_f32 v[22:23], v[8:9], v[54:55], v[22:23] op_sel_hi:[1,0,1]
    v_pk_mul_f32 v[16:17], v[16:17], v[48:49] op_sel:[0,1] op_sel_hi:[1,1]
    v_pk_mul_f32 v[18:19], v[18:19], v[50:51] op_sel:[0,1] op_sel_hi:[1,1]
    v_pk_mul_f32 v[20:21], v[20:21], v[52:53] op_sel:[0,1] op_sel_hi:[1,1]
    v_pk_mul_f32 v[22:23], v[22:23], v[54:55] op_sel:[0,1] op_sel_hi:[1,1]
    v_pk_fma_f32 v[24:25], v[8:9], v[56:57], v[24:25] op_sel_hi:[1,0,1]
    v_pk_fma_f32 v[26:27], v[8:9], v[58:59], v[26:27] op_sel_hi:[1,0,1]
    v_pk_fma_f32 v[28:29], v[8:9], v[60:61], v[28:29] op_sel_hi:[1,0,1]
    v_pk_fma_f32 v[30:31], v[8:9], v[62:63], v[30:31] op_sel_hi:[1,0,1]
    v_pk_mul_f32 v[24:25], v[24:25], v[56:57] op_sel:[0,1] op_sel_hi:[1,1]
    v_pk_mul_f32 v[26:27], v[26:27], v[58:59] op_sel:[0,1] op_sel_hi:[1,1]
    v_pk_mul_f32 v[28:29], v[28:29], v[60:61] op_sel:[0,1] op_sel_hi:[1,1]
    v_pk_mul_f32 v[30:31], v[30:31], v[62:63] op_sel:[0,1] op_sel_hi:[1,1]
    buffer_load_dwordx4 a[108:111], v14, s[36:39], s47 offen offset:2048 sc1
    v_pk_fma_f32 v[32:33], v[8:9], v[224:225], v[32:33] op_sel_hi:[1,0,1]
    v_pk_fma_f32 v[34:35], v[8:9], v[226:227], v[34:35] op_sel_hi:[1,0,1]
    v_pk_fma_f32 v[36:37], v[8:9], v[228:229], v[36:37] op_sel_hi:[1,0,1]
    v_pk_fma_f32 v[38:39], v[8:9], v[230:231], v[38:39] op_sel_hi:[1,0,1]
    v_pk_mul_f32 v[32:33], v[32:33], v[224:225] op_sel:[0,1] op_sel_hi:[1,1]
    v_pk_mul_f32 v[34:35], v[34:35], v[226:227] op_sel:[0,1] op_sel_hi:[1,1]
    v_pk_mul_f32 v[36:37], v[36:37], v[228:229] op_sel:[0,1] op_sel_hi:[1,1]
    v_pk_mul_f32 v[38:39], v[38:39], v[230:231] op_sel:[0,1] op_sel_hi:[1,1]
    v_pk_fma_f32 v[40:41], v[8:9], v[232:233], v[40:41] op_sel_hi:[1,0,1]
    v_pk_fma_f32 v[42:43], v[8:9], v[234:235], v[42:43] op_sel_hi:[1,0,1]
    v_pk_fma_f32 v[44:45], v[8:9], v[236:237], v[44:45] op_sel_hi:[1,0,1]
    v_pk_fma_f32 v[46:47], v[8:9], v[238:239], v[46:47] op_sel_hi:[1,0,1]
    v_pk_mul_f32 v[40:41], v[40:41], v[232:233] op_sel:[0,1] op_sel_hi:[1,1]
    v_pk_mul_f32 v[42:43], v[42:43], v[234:235] op_sel:[0,1] op_sel_hi:[1,1]
    v_pk_mul_f32 v[44:45], v[44:45], v[236:237] op_sel:[0,1] op_sel_hi:[1,1]
    v_pk_mul_f32 v[46:47], v[46:47], v[238:239] op_sel:[0,1] op_sel_hi:[1,1]
    v_pk_fma_f32 v[8:9], v[16:17], v[64:65], v[18:19] op_sel:[1,1,0] op_sel_hi:[0,1,1] neg_lo:[1,0,0]
    v_pk_fma_f32 v[8:9], v[16:17], v[64:65], v[8:9] op_sel_hi:[1,0,1]
    v_pk_fma_f32 v[6:7], v[8:9], v[64:65], v[20:21] op_sel:[1,1,0] op_sel_hi:[0,1,1] neg_lo:[1,0,0]
    v_pk_fma_f32 v[6:7], v[8:9], v[64:65], v[6:7] op_sel_hi:[1,0,1]
    v_pk_fma_f32 v[8:9], v[6:7], v[64:65], v[22:23] op_sel:[1,1,0] op_sel_hi:[0,1,1] neg_lo:[1,0,0]
    v_pk_fma_f32 v[8:9], v[6:7], v[64:65], v[8:9] op_sel_hi:[1,0,1]
    v_pk_fma_f32 v[6:7], v[8:9], v[64:65], v[24:25] op_sel:[1,1,0] op_sel_hi:[0,1,1] neg_lo:[1,0,0]
    v_pk_fma_f32 v[6:7], v[8:9], v[64:65], v[6:7] op_sel_hi:[1,0,1]
    v_pk_fma_f32 v[8:9], v[6:7], v[64:65], v[26:27] op_sel:[1,1,0] op_sel_hi:[0,1,1] neg_lo:[1,0,0]
    v_pk_fma_f32 v[8:9], v[6:7], v[64:65], v[8:9] op_sel_hi:[1,0,1]
    v_pk_fma_f32 v[6:7], v[8:9], v[64:65], v[28:29] op_sel:[1,1,0] op_sel_hi:[0,1,1] neg_lo:[1,0,0]
    v_pk_fma_f32 v[6:7], v[8:9], v[64:65], v[6:7] op_sel_hi:[1,0,1]
    v_pk_fma_f32 v[8:9], v[6:7], v[64:65], v[30:31] op_sel:[1,1,0] op_sel_hi:[0,1,1] neg_lo:[1,0,0]
    v_pk_fma_f32 v[8:9], v[6:7], v[64:65], v[8:9] op_sel_hi:[1,0,1]
    buffer_load_dwordx4 a[112:115], v14, s[36:39], s47 offen offset:3072 sc1
    v_pk_fma_f32 v[6:7], v[8:9], v[64:65], v[32:33] op_sel:[1,1,0] op_sel_hi:[0,1,1] neg_lo:[1,0,0]
    v_pk_fma_f32 v[6:7], v[8:9], v[64:65], v[6:7] op_sel_hi:[1,0,1]
    v_pk_fma_f32 v[8:9], v[6:7], v[64:65], v[34:35] op_sel:[1,1,0] op_sel_hi:[0,1,1] neg_lo:[1,0,0]
    v_pk_fma_f32 v[8:9], v[6:7], v[64:65], v[8:9] op_sel_hi:[1,0,1]
    v_pk_fma_f32 v[6:7], v[8:9], v[64:65], v[36:37] op_sel:[1,1,0] op_sel_hi:[0,1,1] neg_lo:[1,0,0]
    v_pk_fma_f32 v[6:7], v[8:9], v[64:65], v[6:7] op_sel_hi:[1,0,1]
    v_pk_fma_f32 v[8:9], v[6:7], v[64:65], v[38:39] op_sel:[1,1,0] op_sel_hi:[0,1,1] neg_lo:[1,0,0]
    v_pk_fma_f32 v[8:9], v[6:7], v[64:65], v[8:9] op_sel_hi:[1,0,1]
    v_pk_fma_f32 v[6:7], v[8:9], v[64:65], v[40:41] op_sel:[1,1,0] op_sel_hi:[0,1,1] neg_lo:[1,0,0]
    v_pk_fma_f32 v[6:7], v[8:9], v[64:65], v[6:7] op_sel_hi:[1,0,1]
    v_pk_fma_f32 v[8:9], v[6:7], v[64:65], v[42:43] op_sel:[1,1,0] op_sel_hi:[0,1,1] neg_lo:[1,0,0]
    v_pk_fma_f32 v[8:9], v[6:7], v[64:65], v[8:9] op_sel_hi:[1,0,1]
    v_pk_fma_f32 v[6:7], v[8:9], v[64:65], v[44:45] op_sel:[1,1,0] op_sel_hi:[0,1,1] neg_lo:[1,0,0]
    v_pk_fma_f32 v[6:7], v[8:9], v[64:65], v[6:7] op_sel_hi:[1,0,1]
    v_pk_fma_f32 v[8:9], v[6:7], v[64:65], v[46:47] op_sel:[1,1,0] op_sel_hi:[0,1,1] neg_lo:[1,0,0]
    v_pk_fma_f32 v[8:9], v[6:7], v[64:65], v[8:9] op_sel_hi:[1,0,1]
    v_mov_b32 v240, v8
    v_mov_b32 v241, v9
    v_lshlrev_b32 v6, 3, v0
    v_permlane16_swap_b32 v8, v240
    v_permlane16_swap_b32 v9, v241
    v_mov_b32 v242, v8
    v_mov_b32 v244, v240
    v_mov_b32 v243, v9
    v_mov_b32 v245, v241
    v_permlane32_swap_b32 v8, v242
    v_permlane32_swap_b32 v240, v244
    v_permlane32_swap_b32 v9, v243
    v_permlane32_swap_b32 v241, v245
    v_pk_fma_f32 v[240:241], v[8:9], v[68:69], v[240:241] op_sel:[1,1,0] op_sel_hi:[0,1,1] neg_lo:[1,0,0]
    v_pk_fma_f32 v[240:241], v[8:9], v[68:69], v[240:241] op_sel_hi:[1,0,1]
    v_pk_fma_f32 v[242:243], v[240:241], v[68:69], v[242:243] op_sel:[1,1,0] op_sel_hi:[0,1,1] neg_lo:[1,0,0]
    v_pk_fma_f32 v[242:243], v[240:241], v[68:69], v[242:243] op_sel_hi:[1,0,1]
    v_pk_fma_f32 v[244:245], v[242:243], v[68:69], v[244:245] op_sel:[1,1,0] op_sel_hi:[0,1,1] neg_lo:[1,0,0]
    v_pk_fma_f32 v[244:245], v[242:243], v[68:69], v[244:245] op_sel_hi:[1,0,1]
    s_mov_b64 exec, 0xffff
    buffer_store_dwordx2 v[244:245], v6, s[24:27], s83 offen sc1
    s_mov_b64 exec, -1
    v_cndmask_b32 v216, 0, v8, s[60:61]
    v_cndmask_b32 v216, v216, v240, s[62:63]
    v_cndmask_b32 v216, v216, v242, s[96:97]
    v_cndmask_b32 v217, 0, v9, s[60:61]
    v_cndmask_b32 v217, v217, v241, s[62:63]
    v_cndmask_b32 v217, v217, v243, s[96:97]
    s_lshl_b32 s56, s50, 12
    s_add_u32 s56, s56, 69632
    s_add_u32 s24, s94, s56
    s_addc_u32 s25, s95, 0
    s_cmp_lt_u32 s56, 229376
    s_cselect_b32 s26, 4096, 0
    s_mov_b32 s27, 0x20000
    ds_read_b32 v6, v89 offset:4736
    ds_read_b32 v7, v89 offset:4800
    v_pk_mul_f32 v[96:97], v[194:195], v[128:129] op_sel:[0,0] op_sel_hi:[1,0]
    v_pk_mul_f32 v[98:99], v[194:195], v[128:129] op_sel:[0,1] op_sel_hi:[1,1]
    v_pk_mul_f32 v[100:101], v[194:195], v[130:131] op_sel:[0,0] op_sel_hi:[1,0]
    v_pk_mul_f32 v[102:103], v[194:195], v[130:131] op_sel:[0,1] op_sel_hi:[1,1]
    v_pk_fma_f32 v[96:97], v[194:195], v[144:145], v[96:97] op_sel:[1,0,0] op_sel_hi:[0,0,1] neg_lo:[1,0,0]
    v_pk_fma_f32 v[98:99], v[194:195], v[144:145], v[98:99] op_sel:[1,1,0] op_sel_hi:[0,1,1] neg_lo:[1,0,0]
    v_pk_fma_f32 v[100:101], v[194:195], v[146:147], v[100:101] op_sel:[1,0,0] op_sel_hi:[0,0,1] neg_lo:[1,0,0]
    v_pk_fma_f32 v[102:103], v[194:195], v[146:147], v[102:103] op_sel:[1,1,0] op_sel_hi:[0,1,1] neg_lo:[1,0,0]
    v_pk_mul_f32 v[104:105], v[194:195], v[132:133] op_sel:[0,0] op_sel_hi:[1,0]
    v_pk_mul_f32 v[106:107], v[194:195], v[132:133] op_sel:[0,1] op_sel_hi:[1,1]
    v_pk_mul_f32 v[108:109], v[194:195], v[134:135] op_sel:[0,0] op_sel_hi:[1,0]
    v_pk_mul_f32 v[110:111], v[194:195], v[134:135] op_sel:[0,1] op_sel_hi:[1,1]
    v_pk_fma_f32 v[104:105], v[194:195], v[148:149], v[104:105] op_sel:[1,0,0] op_sel_hi:[0,0,1] neg_lo:[1,0,0]
    v_pk_fma_f32 v[106:107], v[194:195], v[148:149], v[106:107] op_sel:[1,1,0] op_sel_hi:[0,1,1] neg_lo:[1,0,0]
    v_pk_fma_f32 v[108:109], v[194:195], v[150:151], v[108:109] op_sel:[1,0,0] op_sel_hi:[0,0,1] neg_lo:[1,0,0]
    v_pk_fma_f32 v[110:111], v[194:195], v[150:151], v[110:111] op_sel:[1,1,0] op_sel_hi:[0,1,1] neg_lo:[1,0,0]
    s_add_u32 s47, s47, 1024
    buffer_load_dwordx4 a[116:119], v14, s[36:39], s47 offen offset:3072 sc1
    v_pk_mul_f32 v[112:113], v[194:195], v[136:137] op_sel:[0,0] op_sel_hi:[1,0]
    v_pk_mul_f32 v[114:115], v[194:195], v[136:137] op_sel:[0,1] op_sel_hi:[1,1]
    v_pk_mul_f32 v[116:117], v[194:195], v[138:139] op_sel:[0,0] op_sel_hi:[1,0]
    v_pk_mul_f32 v[118:119], v[194:195], v[138:139] op_sel:[0,1] op_sel_hi:[1,1]
    v_pk_fma_f32 v[112:113], v[194:195], v[152:153], v[112:113] op_sel:[1,0,0] op_sel_hi:[0,0,1] neg_lo:[1,0,0]
    v_pk_fma_f32 v[114:115], v[194:195], v[152:153], v[114:115] op_sel:[1,1,0] op_sel_hi:[0,1,1] neg_lo:[1,0,0]
    v_pk_fma_f32 v[116:117], v[194:195], v[154:155], v[116:117] op_sel:[1,0,0] op_sel_hi:[0,0,1] neg_lo:[1,0,0]
    v_pk_fma_f32 v[118:119], v[194:195], v[154:155], v[118:119] op_sel:[1,1,0] op_sel_hi:[0,1,1] neg_lo:[1,0,0]
    v_pk_mul_f32 v[120:121], v[194:195], v[140:141] op_sel:[0,0] op_sel_hi:[1,0]
    v_pk_mul_f32 v[122:123], v[194:195], v[140:141] op_sel:[0,1] op_sel_hi:[1,1]
    v_pk_mul_f32 v[124:125], v[194:195], v[142:143] op_sel:[0,0] op_sel_hi:[1,0]
    v_pk_mul_f32 v[126:127], v[194:195], v[142:143] op_sel:[0,1] op_sel_hi:[1,1]
    v_pk_fma_f32 v[120:121], v[194:195], v[156:157], v[120:121] op_sel:[1,0,0] op_sel_hi:[0,0,1] neg_lo:[1,0,0]
    v_pk_fma_f32 v[122:123], v[194:195], v[156:157], v[122:123] op_sel:[1,1,0] op_sel_hi:[0,1,1] neg_lo:[1,0,0]
    v_pk_fma_f32 v[124:125], v[194:195], v[158:159], v[124:125] op_sel:[1,0,0] op_sel_hi:[0,0,1] neg_lo:[1,0,0]
    v_pk_fma_f32 v[126:127], v[194:195], v[158:159], v[126:127] op_sel:[1,1,0] op_sel_hi:[0,1,1] neg_lo:[1,0,0]
    s_waitcnt lgkmcnt(0)
    v_pk_mul_f32 v[8:9], v[6:7], v[194:195] op_sel_hi:[1,0]
    v_pk_fma_f32 v[8:9], v[6:7], v[194:195], v[8:9] op_sel:[1,1,0] op_sel_hi:[0,1,1] neg_lo:[1,0,0]
    v_pk_fma_f32 v[96:97], v[8:9], v[48:49], v[96:97] op_sel_hi:[1,0,1]
    v_pk_fma_f32 v[98:99], v[8:9], v[50:51], v[98:99] op_sel_hi:[1,0,1]
    v_pk_fma_f32 v[100:101], v[8:9], v[52:53], v[100:101] op_sel_hi:[1,0,1]
    v_pk_fma_f32 v[102:103], v[8:9], v[54:55], v[102:103] op_sel_hi:[1,0,1]
    v_pk_mul_f32 v[96:97], v[96:97], v[48:49] op_sel:[0,1] op_sel_hi:[1,1]
    v_pk_mul_f32 v[98:99], v[98:99], v[50:51] op_sel:[0,1] op_sel_hi:[1,1]
    v_pk_mul_f32 v[100:101], v[100:101], v[52:53] op_sel:[0,1] op_sel_hi:[1,1]
    v_pk_mul_f32 v[102:103], v[102:103], v[54:55] op_sel:[0,1] op_sel_hi:[1,1]
    v_pk_fma_f32 v[104:105], v[8:9], v[56:57], v[104:105] op_sel_hi:[1,0,1]
    v_pk_fma_f32 v[106:107], v[8:9], v[58:59], v[106:107] op_sel_hi:[1,0,1]
    v_pk_fma_f32 v[108:109], v[8:9], v[60:61], v[108:109] op_sel_hi:[1,0,1]
    v_pk_fma_f32 v[110:111], v[8:9], v[62:63], v[110:111] op_sel_hi:[1,0,1]
    v_pk_mul_f32 v[104:105], v[104:105], v[56:57] op_sel:[0,1] op_sel_hi:[1,1]
    v_pk_mul_f32 v[106:107], v[106:107], v[58:59] op_sel:[0,1] op_sel_hi:[1,1]
    v_pk_mul_f32 v[108:109], v[108:109], v[60:61] op_sel:[0,1] op_sel_hi:[1,1]
    v_pk_mul_f32 v[110:111], v[110:111], v[62:63] op_sel:[0,1] op_sel_hi:[1,1]
    s_add_u32 s47, s54, 30720
    buffer_load_dwordx4 a[120:123], v14, s[36:39], s47 offen offset:0 sc1
    v_pk_fma_f32 v[112:113], v[8:9], v[224:225], v[112:113] op_sel_hi:[1,0,1]
    v_pk_fma_f32 v[114:115], v[8:9], v[226:227], v[114:115] op_sel_hi:[1,0,1]
    v_pk_fma_f32 v[116:117], v[8:9], v[228:229], v[116:117] op_sel_hi:[1,0,1]
    v_pk_fma_f32 v[118:119], v[8:9], v[230:231], v[118:119] op_sel_hi:[1,0,1]
    v_pk_mul_f32 v[112:113], v[112:113], v[224:225] op_sel:[0,1] op_sel_hi:[1,1]
    v_pk_mul_f32 v[114:115], v[114:115], v[226:227] op_sel:[0,1] op_sel_hi:[1,1]
    v_pk_mul_f32 v[116:117], v[116:117], v[228:229] op_sel:[0,1] op_sel_hi:[1,1]
    v_pk_mul_f32 v[118:119], v[118:119], v[230:231] op_sel:[0,1] op_sel_hi:[1,1]
    v_pk_fma_f32 v[120:121], v[8:9], v[232:233], v[120:121] op_sel_hi:[1,0,1]
    v_pk_fma_f32 v[122:123], v[8:9], v[234:235], v[122:123] op_sel_hi:[1,0,1]
    v_pk_fma_f32 v[124:125], v[8:9], v[236:237], v[124:125] op_sel_hi:[1,0,1]
    v_pk_fma_f32 v[126:127], v[8:9], v[238:239], v[126:127] op_sel_hi:[1,0,1]
    v_pk_mul_f32 v[120:121], v[120:121], v[232:233] op_sel:[0,1] op_sel_hi:[1,1]
    v_pk_mul_f32 v[122:123], v[122:123], v[234:235] op_sel:[0,1] op_sel_hi:[1,1]
    v_pk_mul_f32 v[124:125], v[124:125], v[236:237] op_sel:[0,1] op_sel_hi:[1,1]
    v_pk_mul_f32 v[126:127], v[126:127], v[238:239] op_sel:[0,1] op_sel_hi:[1,1]
    v_pk_fma_f32 v[8:9], v[96:97], v[192:193], v[98:99] op_sel:[1,1,0] op_sel_hi:[0,1,1] neg_lo:[1,0,0]
    v_pk_fma_f32 v[8:9], v[96:97], v[192:193], v[8:9] op_sel_hi:[1,0,1]
    v_pk_fma_f32 v[6:7], v[8:9], v[192:193], v[100:101] op_sel:[1,1,0] op_sel_hi:[0,1,1] neg_lo:[1,0,0]
    v_pk_fma_f32 v[6:7], v[8:9], v[192:193], v[6:7] op_sel_hi:[1,0,1]
    v_pk_fma_f32 v[8:9], v[6:7], v[192:193], v[102:103] op_sel:[1,1,0] op_sel_hi:[0,1,1] neg_lo:[1,0,0]
    v_pk_fma_f32 v[8:9], v[6:7], v[192:193], v[8:9] op_sel_hi:[1,0,1]
    v_pk_fma_f32 v[6:7], v[8:9], v[192:193], v[104:105] op_sel:[1,1,0] op_sel_hi:[0,1,1] neg_lo:[1,0,0]
    v_pk_fma_f32 v[6:7], v[8:9], v[192:193], v[6:7] op_sel_hi:[1,0,1]
    v_pk_fma_f32 v[8:9], v[6:7], v[192:193], v[106:107] op_sel:[1,1,0] op_sel_hi:[0,1,1] neg_lo:[1,0,0]
    v_pk_fma_f32 v[8:9], v[6:7], v[192:193], v[8:9] op_sel_hi:[1,0,1]
    v_pk_fma_f32 v[6:7], v[8:9], v[192:193], v[108:109] op_sel:[1,1,0] op_sel_hi:[0,1,1] neg_lo:[1,0,0]
    v_pk_fma_f32 v[6:7], v[8:9], v[192:193], v[6:7] op_sel_hi:[1,0,1]
    v_pk_fma_f32 v[8:9], v[6:7], v[192:193], v[110:111] op_sel:[1,1,0] op_sel_hi:[0,1,1] neg_lo:[1,0,0]
    v_pk_fma_f32 v[8:9], v[6:7], v[192:193], v[8:9] op_sel_hi:[1,0,1]
    buffer_load_dwordx4 a[124:127], v14, s[36:39], s47 offen offset:1024 sc1
    v_pk_fma_f32 v[6:7], v[8:9], v[192:193], v[112:113] op_sel:[1,1,0] op_sel_hi:[0,1,1] neg_lo:[1,0,0]
    v_pk_fma_f32 v[6:7], v[8:9], v[192:193], v[6:7] op_sel_hi:[1,0,1]
    v_pk_fma_f32 v[8:9], v[6:7], v[192:193], v[114:115] op_sel:[1,1,0] op_sel_hi:[0,1,1] neg_lo:[1,0,0]
    v_pk_fma_f32 v[8:9], v[6:7], v[192:193], v[8:9] op_sel_hi:[1,0,1]
    v_pk_fma_f32 v[6:7], v[8:9], v[192:193], v[116:117] op_sel:[1,1,0] op_sel_hi:[0,1,1] neg_lo:[1,0,0]
    v_pk_fma_f32 v[6:7], v[8:9], v[192:193], v[6:7] op_sel_hi:[1,0,1]
    v_pk_fma_f32 v[8:9], v[6:7], v[192:193], v[118:119] op_sel:[1,1,0] op_sel_hi:[0,1,1] neg_lo:[1,0,0]
    v_pk_fma_f32 v[8:9], v[6:7], v[192:193], v[8:9] op_sel_hi:[1,0,1]
    v_pk_fma_f32 v[6:7], v[8:9], v[192:193], v[120:121] op_sel:[1,1,0] op_sel_hi:[0,1,1] neg_lo:[1,0,0]
    v_pk_fma_f32 v[6:7], v[8:9], v[192:193], v[6:7] op_sel_hi:[1,0,1]
    v_pk_fma_f32 v[8:9], v[6:7], v[192:193], v[122:123] op_sel:[1,1,0] op_sel_hi:[0,1,1] neg_lo:[1,0,0]
    v_pk_fma_f32 v[8:9], v[6:7], v[192:193], v[8:9] op_sel_hi:[1,0,1]
    v_pk_fma_f32 v[6:7], v[8:9], v[192:193], v[124:125] op_sel:[1,1,0] op_sel_hi:[0,1,1] neg_lo:[1,0,0]
    v_pk_fma_f32 v[6:7], v[8:9], v[192:193], v[6:7] op_sel_hi:[1,0,1]
    v_pk_fma_f32 v[8:9], v[6:7], v[192:193], v[126:127] op_sel:[1,1,0] op_sel_hi:[0,1,1] neg_lo:[1,0,0]
    v_pk_fma_f32 v[8:9], v[6:7], v[192:193], v[8:9] op_sel_hi:[1,0,1]
    v_mov_b32 v240, v8
    v_mov_b32 v241, v9
    v_lshlrev_b32 v6, 3, v0
    v_permlane16_swap_b32 v8, v240
    v_permlane16_swap_b32 v9, v241
    v_mov_b32 v242, v8
    v_mov_b32 v244, v240
    v_mov_b32 v243, v9
    v_mov_b32 v245, v241
    v_permlane32_swap_b32 v8, v242
    v_permlane32_swap_b32 v240, v244
    v_permlane32_swap_b32 v9, v243
    v_permlane32_swap_b32 v241, v245
    v_pk_fma_f32 v[240:241], v[8:9], v[196:197], v[240:241] op_sel:[1,1,0] op_sel_hi:[0,1,1] neg_lo:[1,0,0]
    v_pk_fma_f32 v[240:241], v[8:9], v[196:197], v[240:241] op_sel_hi:[1,0,1]
    v_pk_fma_f32 v[242:243], v[240:241], v[196:197], v[242:243] op_sel:[1,1,0] op_sel_hi:[0,1,1] neg_lo:[1,0,0]
    v_pk_fma_f32 v[242:243], v[240:241], v[196:197], v[242:243] op_sel_hi:[1,0,1]
    v_pk_fma_f32 v[244:245], v[242:243], v[196:197], v[244:245] op_sel:[1,1,0] op_sel_hi:[0,1,1] neg_lo:[1,0,0]
    v_pk_fma_f32 v[244:245], v[242:243], v[196:197], v[244:245] op_sel_hi:[1,0,1]
    s_mov_b64 exec, 0xffff
    buffer_store_dwordx2 v[244:245], v6, s[24:27], s83 offen sc1
    s_mov_b64 exec, -1
    v_cndmask_b32 v218, 0, v8, s[60:61]
    v_cndmask_b32 v218, v218, v240, s[62:63]
    v_cndmask_b32 v218, v218, v242, s[96:97]
    v_cndmask_b32 v219, 0, v9, s[60:61]
    v_cndmask_b32 v219, v219, v241, s[62:63]
    v_cndmask_b32 v219, v219, v243, s[96:97]
    s_lshl_b32 s56, s50, 12
    s_add_u32 s56, s56, 73728
    s_add_u32 s24, s94, s56
    s_addc_u32 s25, s95, 0
    s_cmp_lt_u32 s56, 229376
    s_cselect_b32 s26, 4096, 0
    s_mov_b32 s27, 0x20000
    ds_read_b32 v6, v89 offset:4864
    ds_read_b32 v7, v89 offset:4928
L_st_11:
    s_cbranch_execz L_st_12
    v_pk_mul_f32 v[128:129], v[206:207], v[160:161] op_sel:[0,0] op_sel_hi:[1,0]
    v_pk_mul_f32 v[130:131], v[206:207], v[160:161] op_sel:[0,1] op_sel_hi:[1,1]
    v_pk_mul_f32 v[132:133], v[206:207], v[162:163] op_sel:[0,0] op_sel_hi:[1,0]
    v_pk_mul_f32 v[134:135], v[206:207], v[162:163] op_sel:[0,1] op_sel_hi:[1,1]
    v_pk_fma_f32 v[128:129], v[206:207], v[176:177], v[128:129] op_sel:[1,0,0] op_sel_hi:[0,0,1] neg_lo:[1,0,0]
    v_pk_fma_f32 v[130:131], v[206:207], v[176:177], v[130:131] op_sel:[1,1,0] op_sel_hi:[0,1,1] neg_lo:[1,0,0]
    v_pk_fma_f32 v[132:133], v[206:207], v[178:179], v[132:133] op_sel:[1,0,0] op_sel_hi:[0,0,1] neg_lo:[1,0,0]
    v_pk_fma_f32 v[134:135], v[206:207], v[178:179], v[134:135] op_sel:[1,1,0] op_sel_hi:[0,1,1] neg_lo:[1,0,0]
    v_pk_mul_f32 v[136:137], v[206:207], v[164:165] op_sel:[0,0] op_sel_hi:[1,0]
    v_pk_mul_f32 v[138:139], v[206:207], v[164:165] op_sel:[0,1] op_sel_hi:[1,1]
    v_pk_mul_f32 v[140:141], v[206:207], v[166:167] op_sel:[0,0] op_sel_hi:[1,0]
    v_pk_mul_f32 v[142:143], v[206:207], v[166:167] op_sel:[0,1] op_sel_hi:[1,1]
    v_pk_fma_f32 v[136:137], v[206:207], v[180:181], v[136:137] op_sel:[1,0,0] op_sel_hi:[0,0,1] neg_lo:[1,0,0]
    v_pk_fma_f32 v[138:139], v[206:207], v[180:181], v[138:139] op_sel:[1,1,0] op_sel_hi:[0,1,1] neg_lo:[1,0,0]
    v_pk_fma_f32 v[140:141], v[206:207], v[182:183], v[140:141] op_sel:[1,0,0] op_sel_hi:[0,0,1] neg_lo:[1,0,0]
    v_pk_fma_f32 v[142:143], v[206:207], v[182:183], v[142:143] op_sel:[1,1,0] op_sel_hi:[0,1,1] neg_lo:[1,0,0]
    buffer_load_dwordx4 a[128:131], v14, s[36:39], s47 offen offset:2048 sc1
    v_pk_mul_f32 v[144:145], v[206:207], v[168:169] op_sel:[0,0] op_sel_hi:[1,0]
    v_pk_mul_f32 v[146:147], v[206:207], v[168:169] op_sel:[0,1] op_sel_hi:[1,1]
    v_pk_mul_f32 v[148:149], v[206:207], v[170:171] op_sel:[0,0] op_sel_hi:[1,0]
    v_pk_mul_f32 v[150:151], v[206:207], v[170:171] op_sel:[0,1] op_sel_hi:[1,1]
    v_pk_fma_f32 v[144:145], v[206:207], v[184:185], v[144:145] op_sel:[1,0,0] op_sel_hi:[0,0,1] neg_lo:[1,0,0]
    v_pk_fma_f32 v[146:147], v[206:207], v[184:185], v[146:147] op_sel:[1,1,0] op_sel_hi:[0,1,1] neg_lo:[1,0,0]
    v_pk_fma_f32 v[148:149], v[206:207], v[186:187], v[148:149] op_sel:[1,0,0] op_sel_hi:[0,0,1] neg_lo:[1,0,0]
    v_pk_fma_f32 v[150:151], v[206:207], v[186:187], v[150:151] op_sel:[1,1,0] op_sel_hi:[0,1,1] neg_lo:[1,0,0]
    v_pk_mul_f32 v[152:153], v[206:207], v[172:173] op_sel:[0,0] op_sel_hi:[1,0]
    v_pk_mul_f32 v[154:155], v[206:207], v[172:173] op_sel:[0,1] op_sel_hi:[1,1]
    v_pk_mul_f32 v[156:157], v[206:207], v[174:175] op_sel:[0,0] op_sel_hi:[1,0]
    v_pk_mul_f32 v[158:159], v[206:207], v[174:175] op_sel:[0,1] op_sel_hi:[1,1]
    v_pk_fma_f32 v[152:153], v[206:207], v[188:189], v[152:153] op_sel:[1,0,0] op_sel_hi:[0,0,1] neg_lo:[1,0,0]
    v_pk_fma_f32 v[154:155], v[206:207], v[188:189], v[154:155] op_sel:[1,1,0] op_sel_hi:[0,1,1] neg_lo:[1,0,0]
    v_pk_fma_f32 v[156:157], v[206:207], v[190:191], v[156:157] op_sel:[1,0,0] op_sel_hi:[0,0,1] neg_lo:[1,0,0]
    v_pk_fma_f32 v[158:159], v[206:207], v[190:191], v[158:159] op_sel:[1,1,0] op_sel_hi:[0,1,1] neg_lo:[1,0,0]
    s_waitcnt lgkmcnt(0)
    v_pk_mul_f32 v[8:9], v[6:7], v[206:207] op_sel_hi:[1,0]
    v_pk_fma_f32 v[8:9], v[6:7], v[206:207], v[8:9] op_sel:[1,1,0] op_sel_hi:[0,1,1] neg_lo:[1,0,0]
    v_pk_fma_f32 v[128:129], v[8:9], v[48:49], v[128:129] op_sel_hi:[1,0,1]
    v_pk_fma_f32 v[130:131], v[8:9], v[50:51], v[130:131] op_sel_hi:[1,0,1]
    v_pk_fma_f32 v[132:133], v[8:9], v[52:53], v[132:133] op_sel_hi:[1,0,1]
    v_pk_fma_f32 v[134:135], v[8:9], v[54:55], v[134:135] op_sel_hi:[1,0,1]
    v_pk_mul_f32 v[128:129], v[128:129], v[48:49] op_sel:[0,1] op_sel_hi:[1,1]
    v_pk_mul_f32 v[130:131], v[130:131], v[50:51] op_sel:[0,1] op_sel_hi:[1,1]
    v_pk_mul_f32 v[132:133], v[132:133], v[52:53] op_sel:[0,1] op_sel_hi:[1,1]
    v_pk_mul_f32 v[134:135], v[134:135], v[54:55] op_sel:[0,1] op_sel_hi:[1,1]
    v_pk_fma_f32 v[136:137], v[8:9], v[56:57], v[136:137] op_sel_hi:[1,0,1]
    v_pk_fma_f32 v[138:139], v[8:9], v[58:59], v[138:139] op_sel_hi:[1,0,1]
    v_pk_fma_f32 v[140:141], v[8:9], v[60:61], v[140:141] op_sel_hi:[1,0,1]
    v_pk_fma_f32 v[142:143], v[8:9], v[62:63], v[142:143] op_sel_hi:[1,0,1]
    v_pk_mul_f32 v[136:137], v[136:137], v[56:57] op_sel:[0,1] op_sel_hi:[1,1]
    v_pk_mul_f32 v[138:139], v[138:139], v[58:59] op_sel:[0,1] op_sel_hi:[1,1]
    v_pk_mul_f32 v[140:141], v[140:141], v[60:61] op_sel:[0,1] op_sel_hi:[1,1]
    v_pk_mul_f32 v[142:143], v[142:143], v[62:63] op_sel:[0,1] op_sel_hi:[1,1]
    buffer_load_dwordx4 a[132:135], v14, s[36:39], s47 offen offset:3072 sc1
    v_pk_fma_f32 v[144:145], v[8:9], v[224:225], v[144:145] op_sel_hi:[1,0,1]
    v_pk_fma_f32 v[146:147], v[8:9], v[226:227], v[146:147] op_sel_hi:[1,0,1]
    v_pk_fma_f32 v[148:149], v[8:9], v[228:229], v[148:149] op_sel_hi:[1,0,1]
    v_pk_fma_f32 v[150:151], v[8:9], v[230:231], v[150:151] op_sel_hi:[1,0,1]
    v_pk_mul_f32 v[144:145], v[144:145], v[224:225] op_sel:[0,1] op_sel_hi:[1,1]
    v_pk_mul_f32 v[146:147], v[146:147], v[226:227] op_sel:[0,1] op_sel_hi:[1,1]
    v_pk_mul_f32 v[148:149], v[148:149], v[228:229] op_sel:[0,1] op_sel_hi:[1,1]
    v_pk_mul_f32 v[150:151], v[150:151], v[230:231] op_sel:[0,1] op_sel_hi:[1,1]
    v_pk_fma_f32 v[152:153], v[8:9], v[232:233], v[152:153] op_sel_hi:[1,0,1]
    v_pk_fma_f32 v[154:155], v[8:9], v[234:235], v[154:155] op_sel_hi:[1,0,1]
    v_pk_fma_f32 v[156:157], v[8:9], v[236:237], v[156:157] op_sel_hi:[1,0,1]
    v_pk_fma_f32 v[158:159], v[8:9], v[238:239], v[158:159] op_sel_hi:[1,0,1]
    v_pk_mul_f32 v[152:153], v[152:153], v[232:233] op_sel:[0,1] op_sel_hi:[1,1]
    v_pk_mul_f32 v[154:155], v[154:155], v[234:235] op_sel:[0,1] op_sel_hi:[1,1]
    v_pk_mul_f32 v[156:157], v[156:157], v[236:237] op_sel:[0,1] op_sel_hi:[1,1]
    v_pk_mul_f32 v[158:159], v[158:159], v[238:239] op_sel:[0,1] op_sel_hi:[1,1]
    v_pk_fma_f32 v[8:9], v[128:129], v[204:205], v[130:131] op_sel:[1,1,0] op_sel_hi:[0,1,1] neg_lo:[1,0,0]
    v_pk_fma_f32 v[8:9], v[128:129], v[204:205], v[8:9] op_sel_hi:[1,0,1]
    v_pk_fma_f32 v[6:7], v[8:9], v[204:205], v[132:133] op_sel:[1,1,0] op_sel_hi:[0,1,1] neg_lo:[1,0,0]
    v_pk_fma_f32 v[6:7], v[8:9], v[204:205], v[6:7] op_sel_hi:[1,0,1]
    v_pk_fma_f32 v[8:9], v[6:7], v[204:205], v[134:135] op_sel:[1,1,0] op_sel_hi:[0,1,1] neg_lo:[1,0,0]
    v_pk_fma_f32 v[8:9], v[6:7], v[204:205], v[8:9] op_sel_hi:[1,0,1]
    v_pk_fma_f32 v[6:7], v[8:9], v[204:205], v[136:137] op_sel:[1,1,0] op_sel_hi:[0,1,1] neg_lo:[1,0,0]
    v_pk_fma_f32 v[6:7], v[8:9], v[204:205], v[6:7] op_sel_hi:[1,0,1]
    v_pk_fma_f32 v[8:9], v[6:7], v[204:205], v[138:139] op_sel:[1,1,0] op_sel_hi:[0,1,1] neg_lo:[1,0,0]
    v_pk_fma_f32 v[8:9], v[6:7], v[204:205], v[8:9] op_sel_hi:[1,0,1]
    v_pk_fma_f32 v[6:7], v[8:9], v[204:205], v[140:141] op_sel:[1,1,0] op_sel_hi:[0,1,1] neg_lo:[1,0,0]
    v_pk_fma_f32 v[6:7], v[8:9], v[204:205], v[6:7] op_sel_hi:[1,0,1]
    v_pk_fma_f32 v[8:9], v[6:7], v[204:205], v[142:143] op_sel:[1,1,0] op_sel_hi:[0,1,1] neg_lo:[1,0,0]
    v_pk_fma_f32 v[8:9], v[6:7], v[204:205], v[8:9] op_sel_hi:[1,0,1]
    s_add_u32 s47, s47, 1024
    buffer_load_dwordx4 a[136:139], v14, s[36:39], s47 offen offset:3072 sc1
    v_pk_fma_f32 v[6:7], v[8:9], v[204:205], v[144:145] op_sel:[1,1,0] op_sel_hi:[0,1,1] neg_lo:[1,0,0]
    v_pk_fma_f32 v[6:7], v[8:9], v[204:205], v[6:7] op_sel_hi:[1,0,1]
    v_pk_fma_f32 v[8:9], v[6:7], v[204:205], v[146:147] op_sel:[1,1,0] op_sel_hi:[0,1,1] neg_lo:[1,0,0]
    v_pk_fma_f32 v[8:9], v[6:7], v[204:205], v[8:9] op_sel_hi:[1,0,1]
    v_pk_fma_f32 v[6:7], v[8:9], v[204:205], v[148:149] op_sel:[1,1,0] op_sel_hi:[0,1,1] neg_lo:[1,0,0]
    v_pk_fma_f32 v[6:7], v[8:9], v[204:205], v[6:7] op_sel_hi:[1,0,1]
    v_pk_fma_f32 v[8:9], v[6:7], v[204:205], v[150:151] op_sel:[1,1,0] op_sel_hi:[0,1,1] neg_lo:[1,0,0]
    v_pk_fma_f32 v[8:9], v[6:7], v[204:205], v[8:9] op_sel_hi:[1,0,1]
    v_pk_fma_f32 v[6:7], v[8:9], v[204:205], v[152:153] op_sel:[1,1,0] op_sel_hi:[0,1,1] neg_lo:[1,0,0]
    v_pk_fma_f32 v[6:7], v[8:9], v[204:205], v[6:7] op_sel_hi:[1,0,1]
    v_pk_fma_f32 v[8:9], v[6:7], v[204:205], v[154:155] op_sel:[1,1,0] op_sel_hi:[0,1,1] neg_lo:[1,0,0]
    v_pk_fma_f32 v[8:9], v[6:7], v[204:205], v[8:9] op_sel_hi:[1,0,1]
    v_pk_fma_f32 v[6:7], v[8:9], v[204:205], v[156:157] op_sel:[1,1,0] op_sel_hi:[0,1,1] neg_lo:[1,0,0]
    v_pk_fma_f32 v[6:7], v[8:9], v[204:205], v[6:7] op_sel_hi:[1,0,1]
    v_pk_fma_f32 v[8:9], v[6:7], v[204:205], v[158:159] op_sel:[1,1,0] op_sel_hi:[0,1,1] neg_lo:[1,0,0]
    v_pk_fma_f32 v[8:9], v[6:7], v[204:205], v[8:9] op_sel_hi:[1,0,1]
    v_mov_b32 v240, v8
    v_mov_b32 v241, v9
    v_lshlrev_b32 v6, 3, v0
    v_permlane16_swap_b32 v8, v240
    v_permlane16_swap_b32 v9, v241
    v_mov_b32 v242, v8
    v_mov_b32 v244, v240
    v_mov_b32 v243, v9
    v_mov_b32 v245, v241
    v_permlane32_swap_b32 v8, v242
    v_permlane32_swap_b32 v240, v244
    v_permlane32_swap_b32 v9, v243
    v_permlane32_swap_b32 v241, v245
    v_pk_fma_f32 v[240:241], v[8:9], v[208:209], v[240:241] op_sel:[1,1,0] op_sel_hi:[0,1,1] neg_lo:[1,0,0]
    v_pk_fma_f32 v[240:241], v[8:9], v[208:209], v[240:241] op_sel_hi:[1,0,1]
    v_pk_fma_f32 v[242:243], v[240:241], v[208:209], v[242:243] op_sel:[1,1,0] op_sel_hi:[0,1,1] neg_lo:[1,0,0]
    v_pk_fma_f32 v[242:243], v[240:241], v[208:209], v[242:243] op_sel_hi:[1,0,1]
    v_pk_fma_f32 v[244:245], v[242:243], v[208:209], v[244:245] op_sel:[1,1,0] op_sel_hi:[0,1,1] neg_lo:[1,0,0]
    v_pk_fma_f32 v[244:245], v[242:243], v[208:209], v[244:245] op_sel_hi:[1,0,1]
    s_mov_b64 exec, 0xffff
    buffer_store_dwordx2 v[244:245], v6, s[24:27], s83 offen sc1
    s_mov_b64 exec, -1
    v_cndmask_b32 v220, 0, v8, s[60:61]
    v_cndmask_b32 v220, v220, v240, s[62:63]
    v_cndmask_b32 v220, v220, v242, s[96:97]
    v_cndmask_b32 v221, 0, v9, s[60:61]
    v_cndmask_b32 v221, v221, v241, s[62:63]
    v_cndmask_b32 v221, v221, v243, s[96:97]
    s_lshl_b32 s56, s50, 12
    s_add_u32 s56, s56, 65536
    s_add_u32 s24, s94, s56
    s_addc_u32 s25, s95, 0
    s_mov_b32 s26, 4096
    s_mov_b32 s27, 0x20000
    buffer_load_dwordx2 v[160:161], v91, s[24:27], 0 offen offset:896 sc1
    buffer_load_dwordx2 v[162:163], v91, s[24:27], 0 offen offset:768 sc1
    buffer_load_dwordx2 v[164:165], v91, s[24:27], 0 offen offset:640 sc1
    buffer_load_dwordx2 v[166:167], v91, s[24:27], 0 offen offset:512 sc1
    buffer_load_dwordx2 v[168:169], v91, s[24:27], 0 offen offset:384 sc1
    buffer_load_dwordx2 v[170:171], v91, s[24:27], 0 offen offset:256 sc1
    buffer_load_dwordx2 v[172:173], v91, s[24:27], 0 offen offset:128 sc1
    buffer_load_dwordx2 v[174:175], v91, s[24:27], 0 offen offset:0 sc1
    s_lshl_b32 s56, s50, 12
    s_add_u32 s56, s56, 69632
    s_add_u32 s24, s94, s56
    s_addc_u32 s25, s95, 0
    s_cmp_lt_u32 s56, 229376
    s_cselect_b32 s26, 4096, 0
    s_mov_b32 s27, 0x20000
    buffer_load_dwordx2 v[176:177], v91, s[24:27], 0 offen offset:896 sc1
    buffer_load_dwordx2 v[178:179], v91, s[24:27], 0 offen offset:768 sc1
    buffer_load_dwordx2 v[180:181], v91, s[24:27], 0 offen offset:640 sc1
    buffer_load_dwordx2 v[182:183], v91, s[24:27], 0 offen offset:512 sc1
    buffer_load_dwordx2 v[184:185], v91, s[24:27], 0 offen offset:384 sc1
    buffer_load_dwordx2 v[186:187], v91, s[24:27], 0 offen offset:256 sc1
    buffer_load_dwordx2 v[188:189], v91, s[24:27], 0 offen offset:128 sc1
    buffer_load_dwordx2 v[190:191], v91, s[24:27], 0 offen offset:0 sc1
    s_mov_b32 s47, 35840
    buffer_load_dwordx4 a[140:143], v14, s[36:39], s47 offen offset:0 sc1
    buffer_load_dwordx4 a[144:147], v14, s[36:39], s47 offen offset:1024 sc1
    buffer_load_dwordx4 a[148:151], v14, s[36:39], s47 offen offset:2048 sc1
    buffer_load_dwordx4 a[152:155], v14, s[36:39], s47 offen offset:3072 sc1
    s_lshl_b32 s56, s50, 12
    s_add_u32 s56, s56, 73728
    s_add_u32 s24, s94, s56
    s_addc_u32 s25, s95, 0
    s_cmp_lt_u32 s56, 229376
    s_cselect_b32 s26, 4096, 0
    s_mov_b32 s27, 0x20000
    buffer_load_dwordx2 v[48:49], v91, s[24:27], 0 offen offset:896 sc1
    buffer_load_dwordx2 v[50:51], v91, s[24:27], 0 offen offset:768 sc1
    buffer_load_dwordx2 v[52:53], v91, s[24:27], 0 offen offset:640 sc1
    buffer_load_dwordx2 v[54:55], v91, s[24:27], 0 offen offset:512 sc1
    buffer_load_dwordx2 v[56:57], v91, s[24:27], 0 offen offset:384 sc1
    buffer_load_dwordx2 v[58:59], v91, s[24:27], 0 offen offset:256 sc1
    buffer_load_dwordx2 v[60:61], v91, s[24:27], 0 offen offset:128 sc1
    buffer_load_dwordx2 v[62:63], v91, s[24:27], 0 offen offset:0 sc1
    s_add_u32 s56, s50, 0
    s_and_b32 s57, s56, 3
    s_lshl2_add_u32 s57, s49, s57
    s_mul_i32 s57, s57, 24
    s_lshr_b32 s58, s56, 3
    s_add_u32 s57, s58, s57
    s_bfe_u32 s58, s56, 0x10002
    s_mul_i32 s58, s58, 12
    s_add_u32 s57, s58, s57
    s_lshl_b32 s57, s57, 12
    s_add_u32 s82, s57, 5271552
    s_cmp_lt_u32 s56, 40
    s_cselect_b32 s82, s82, 1073741824
    s_lshl_b32 s56, s50, 12
    s_add_u32 s56, s56, 65536
    s_add_u32 s24, s94, s56
    s_addc_u32 s25, s95, 0
    s_mov_b32 s26, 4096
    s_mov_b32 s27, 0x20000
    s_waitcnt vmcnt(20)
    s_mov_b32 s55, 0
L_fh_26:
    v_pk_fma_f32 v[8:9], v[160:161], v[70:71], v[162:163] op_sel:[1,1,0] op_sel_hi:[0,1,1] neg_lo:[1,0,0]
    v_pk_fma_f32 v[8:9], v[160:161], v[70:71], v[8:9] op_sel_hi:[1,0,1]
    v_pk_fma_f32 v[6:7], v[8:9], v[70:71], v[164:165] op_sel:[1,1,0] op_sel_hi:[0,1,1] neg_lo:[1,0,0]
    v_pk_fma_f32 v[6:7], v[8:9], v[70:71], v[6:7] op_sel_hi:[1,0,1]
    v_pk_fma_f32 v[8:9], v[6:7], v[70:71], v[166:167] op_sel:[1,1,0] op_sel_hi:[0,1,1] neg_lo:[1,0,0]
    v_pk_fma_f32 v[8:9], v[6:7], v[70:71], v[8:9] op_sel_hi:[1,0,1]
    v_pk_fma_f32 v[6:7], v[8:9], v[70:71], v[168:169] op_sel:[1,1,0] op_sel_hi:[0,1,1] neg_lo:[1,0,0]
    v_pk_fma_f32 v[6:7], v[8:9], v[70:71], v[6:7] op_sel_hi:[1,0,1]
    v_pk_fma_f32 v[8:9], v[6:7], v[70:71], v[170:171] op_sel:[1,1,0] op_sel_hi:[0,1,1] neg_lo:[1,0,0]
    v_pk_fma_f32 v[8:9], v[6:7], v[70:71], v[8:9] op_sel_hi:[1,0,1]
    v_pk_fma_f32 v[6:7], v[8:9], v[70:71], v[172:173] op_sel:[1,1,0] op_sel_hi:[0,1,1] neg_lo:[1,0,0]
    v_pk_fma_f32 v[6:7], v[8:9], v[70:71], v[6:7] op_sel_hi:[1,0,1]
    v_pk_fma_f32 v[8:9], v[6:7], v[70:71], v[174:175] op_sel:[1,1,0] op_sel_hi:[0,1,1] neg_lo:[1,0,0]
    v_pk_fma_f32 v[8:9], v[6:7], v[70:71], v[8:9] op_sel_hi:[1,0,1]
    v_cmp_u_f32 vcc, v8, v9
    s_nop 0
    s_cbranch_vccnz L_fs_28
L_fok_27:
    v_pk_mul_f32 v[6:7], v[8:9], v[74:75] op_sel_hi:[1,0]
    v_pk_fma_f32 v[6:7], v[8:9], v[74:75], v[6:7] op_sel:[1,1,0] op_sel_hi:[0,1,1] neg_lo:[1,0,0]
    s_add_u32 s47, s47, 1024
    buffer_load_dwordx4 a[156:159], v14, s[36:39], s47 offen offset:3072 sc1
    v_mov_b32 v10, v6
    v_mov_b32 v11, v7
    s_nop 0
    v_permlane16_swap_b32 v6, v10
    v_permlane16_swap_b32 v7, v11
    v_pk_add_f32 v[6:7], v[6:7], v[10:11]
    v_mov_b32 v10, v6
    v_mov_b32 v11, v7
    s_nop 0
    v_permlane32_swap_b32 v6, v10
    v_permlane32_swap_b32 v7, v11
    v_pk_add_f32 v[6:7], v[6:7], v[10:11]
    v_pk_fma_f32 v[216:217], v[6:7], v[72:73], v[216:217] op_sel:[1,1,0] op_sel_hi:[0,1,1] neg_lo:[1,0,0]
    v_pk_fma_f32 v[216:217], v[6:7], v[72:73], v[216:217] op_sel_hi:[1,0,1]
    v_pk_fma_f32 v[16:17], v[216:217], v[64:65], v[16:17] op_sel:[1,1,0] op_sel_hi:[0,1,1] neg_lo:[1,0,0]
    v_pk_fma_f32 v[16:17], v[216:217], v[64:65], v[16:17] op_sel_hi:[1,0,1]
    v_pk_fma_f32 v[18:19], v[16:17], v[64:65], v[18:19] op_sel:[1,1,0] op_sel_hi:[0,1,1] neg_lo:[1,0,0]
    v_pk_fma_f32 v[18:19], v[16:17], v[64:65], v[18:19] op_sel_hi:[1,0,1]
    v_pk_fma_f32 v[20:21], v[18:19], v[64:65], v[20:21] op_sel:[1,1,0] op_sel_hi:[0,1,1] neg_lo:[1,0,0]
    v_pk_fma_f32 v[20:21], v[18:19], v[64:65], v[20:21] op_sel_hi:[1,0,1]
    v_pk_fma_f32 v[22:23], v[20:21], v[64:65], v[22:23] op_sel:[1,1,0] op_sel_hi:[0,1,1] neg_lo:[1,0,0]
    v_pk_fma_f32 v[22:23], v[20:21], v[64:65], v[22:23] op_sel_hi:[1,0,1]
    v_cvt_pk_bf16_f32 v160, v16, v18
    v_cvt_pk_bf16_f32 v161, v20, v22
    v_cvt_pk_bf16_f32 v162, -v17, -v19
    v_cvt_pk_bf16_f32 v163, -v21, -v23
    ds_write_b64 v92, v[160:161] offset:0
    ds_write_b64 v92, v[162:163] offset:512
    ds_read_b64_tr_b16 v[16:17], v93 offset:0
    ds_read_b64_tr_b16 v[18:19], v93 offset:512
    v_pk_fma_f32 v[24:25], v[22:23], v[64:65], v[24:25] op_sel:[1,1,0] op_sel_hi:[0,1,1] neg_lo:[1,0,0]
    v_pk_fma_f32 v[24:25], v[22:23], v[64:65], v[24:25] op_sel_hi:[1,0,1]
    s_mov_b32 s47, 40960
    buffer_load_dwordx4 a[160:163], v14, s[36:39], s47 offen offset:0 sc1
    v_pk_fma_f32 v[26:27], v[24:25], v[64:65], v[26:27] op_sel:[1,1,0] op_sel_hi:[0,1,1] neg_lo:[1,0,0]
    v_pk_fma_f32 v[26:27], v[24:25], v[64:65], v[26:27] op_sel_hi:[1,0,1]
    v_pk_fma_f32 v[28:29], v[26:27], v[64:65], v[28:29] op_sel:[1,1,0] op_sel_hi:[0,1,1] neg_lo:[1,0,0]
    v_pk_fma_f32 v[28:29], v[26:27], v[64:65], v[28:29] op_sel_hi:[1,0,1]
    v_pk_fma_f32 v[30:31], v[28:29], v[64:65], v[30:31] op_sel:[1,1,0] op_sel_hi:[0,1,1] neg_lo:[1,0,0]
    v_pk_fma_f32 v[30:31], v[28:29], v[64:65], v[30:31] op_sel_hi:[1,0,1]
    v_cvt_pk_bf16_f32 v164, v24, v26
    v_cvt_pk_bf16_f32 v165, v28, v30
    v_cvt_pk_bf16_f32 v166, -v25, -v27
    v_cvt_pk_bf16_f32 v167, -v29, -v31
    ds_write_b64 v92, v[164:165] offset:1024
    ds_write_b64 v92, v[166:167] offset:1536
    ds_read_b64_tr_b16 v[24:25], v93 offset:1024
    ds_read_b64_tr_b16 v[26:27], v93 offset:1536
    s_waitcnt lgkmcnt(4)
    buffer_store_dwordx4 v[16:19], v14, s[20:23], s82 offen offset:0 sc1
    v_pk_fma_f32 v[32:33], v[30:31], v[64:65], v[32:33] op_sel:[1,1,0] op_sel_hi:[0,1,1] neg_lo:[1,0,0]
    v_pk_fma_f32 v[32:33], v[30:31], v[64:65], v[32:33] op_sel_hi:[1,0,1]
    v_pk_fma_f32 v[34:35], v[32:33], v[64:65], v[34:35] op_sel:[1,1,0] op_sel_hi:[0,1,1] neg_lo:[1,0,0]
    v_pk_fma_f32 v[34:35], v[32:33], v[64:65], v[34:35] op_sel_hi:[1,0,1]
    v_pk_fma_f32 v[36:37], v[34:35], v[64:65], v[36:37] op_sel:[1,1,0] op_sel_hi:[0,1,1] neg_lo:[1,0,0]
    v_pk_fma_f32 v[36:37], v[34:35], v[64:65], v[36:37] op_sel_hi:[1,0,1]
    v_pk_fma_f32 v[38:39], v[36:37], v[64:65], v[38:39] op_sel:[1,1,0] op_sel_hi:[0,1,1] neg_lo:[1,0,0]
    v_pk_fma_f32 v[38:39], v[36:37], v[64:65], v[38:39] op_sel_hi:[1,0,1]
    v_cvt_pk_bf16_f32 v168, v32, v34
    v_cvt_pk_bf16_f32 v169, v36, v38
    v_cvt_pk_bf16_f32 v170, -v33, -v35
    v_cvt_pk_bf16_f32 v171, -v37, -v39
    ds_write_b64 v92, v[168:169] offset:2048
    ds_write_b64 v92, v[170:171] offset:2560
    ds_read_b64_tr_b16 v[32:33], v93 offset:2048
    ds_read_b64_tr_b16 v[34:35], v93 offset:2560
    s_waitcnt lgkmcnt(4)
    buffer_store_dwordx4 v[24:27], v14, s[20:23], s82 offen offset:1024 sc1
    v_pk_fma_f32 v[40:41], v[38:39], v[64:65], v[40:41] op_sel:[1,1,0] op_sel_hi:[0,1,1] neg_lo:[1,0,0]
    v_pk_fma_f32 v[40:41], v[38:39], v[64:65], v[40:41] op_sel_hi:[1,0,1]
    v_pk_fma_f32 v[42:43], v[40:41], v[64:65], v[42:43] op_sel:[1,1,0] op_sel_hi:[0,1,1] neg_lo:[1,0,0]
    v_pk_fma_f32 v[42:43], v[40:41], v[64:65], v[42:43] op_sel_hi:[1,0,1]
    v_pk_fma_f32 v[44:45], v[42:43], v[64:65], v[44:45] op_sel:[1,1,0] op_sel_hi:[0,1,1] neg_lo:[1,0,0]
    v_pk_fma_f32 v[44:45], v[42:43], v[64:65], v[44:45] op_sel_hi:[1,0,1]
    v_pk_fma_f32 v[46:47], v[44:45], v[64:65], v[46:47] op_sel:[1,1,0] op_sel_hi:[0,1,1] neg_lo:[1,0,0]
    v_pk_fma_f32 v[46:47], v[44:45], v[64:65], v[46:47] op_sel_hi:[1,0,1]
    v_cvt_pk_bf16_f32 v172, v40, v42
    v_cvt_pk_bf16_f32 v173, v44, v46
    v_cvt_pk_bf16_f32 v174, -v41, -v43
    v_cvt_pk_bf16_f32 v175, -v45, -v47
    ds_write_b64 v92, v[172:173] offset:3072
    ds_write_b64 v92, v[174:175] offset:3584
    ds_read_b64_tr_b16 v[40:41], v93 offset:3072
    ds_read_b64_tr_b16 v[42:43], v93 offset:3584
    s_waitcnt lgkmcnt(4)
    buffer_store_dwordx4 v[32:35], v14, s[20:23], s82 offen offset:2048 sc1
    s_waitcnt lgkmcnt(0)
    buffer_store_dwordx4 v[40:43], v14, s[20:23], s82 offen offset:3072 sc1
    s_add_u32 s56, s50, 1
    s_and_b32 s57, s56, 3
    s_lshl2_add_u32 s57, s49, s57
    s_mul_i32 s57, s57, 24
    s_lshr_b32 s58, s56, 3
    s_add_u32 s57, s58, s57
    s_bfe_u32 s58, s56, 0x10002
    s_mul_i32 s58, s58, 12
    s_add_u32 s57, s58, s57
    s_lshl_b32 s57, s57, 12
    s_add_u32 s82, s57, 5271552
    s_cmp_lt_u32 s56, 40
    s_cselect_b32 s82, s82, 1073741824
    s_lshl_b32 s56, s50, 12
    s_add_u32 s56, s56, 69632
    s_add_u32 s24, s94, s56
    s_addc_u32 s25, s95, 0
    s_cmp_lt_u32 s56, 229376
    s_cselect_b32 s26, 4096, 0
    s_mov_b32 s27, 0x20000
    s_waitcnt vmcnt(18)
    s_mov_b32 s55, 0
L_fh_29:
    v_pk_fma_f32 v[8:9], v[176:177], v[198:199], v[178:179] op_sel:[1,1,0] op_sel_hi:[0,1,1] neg_lo:[1,0,0]
    v_pk_fma_f32 v[8:9], v[176:177], v[198:199], v[8:9] op_sel_hi:[1,0,1]
    v_pk_fma_f32 v[6:7], v[8:9], v[198:199], v[180:181] op_sel:[1,1,0] op_sel_hi:[0,1,1] neg_lo:[1,0,0]
    v_pk_fma_f32 v[6:7], v[8:9], v[198:199], v[6:7] op_sel_hi:[1,0,1]
    v_pk_fma_f32 v[8:9], v[6:7], v[198:199], v[182:183] op_sel:[1,1,0] op_sel_hi:[0,1,1] neg_lo:[1,0,0]
    v_pk_fma_f32 v[8:9], v[6:7], v[198:199], v[8:9] op_sel_hi:[1,0,1]
    v_pk_fma_f32 v[6:7], v[8:9], v[198:199], v[184:185] op_sel:[1,1,0] op_sel_hi:[0,1,1] neg_lo:[1,0,0]
    v_pk_fma_f32 v[6:7], v[8:9], v[198:199], v[6:7] op_sel_hi:[1,0,1]
    v_pk_fma_f32 v[8:9], v[6:7], v[198:199], v[186:187] op_sel:[1,1,0] op_sel_hi:[0,1,1] neg_lo:[1,0,0]
    v_pk_fma_f32 v[8:9], v[6:7], v[198:199], v[8:9] op_sel_hi:[1,0,1]
    v_pk_fma_f32 v[6:7], v[8:9], v[198:199], v[188:189] op_sel:[1,1,0] op_sel_hi:[0,1,1] neg_lo:[1,0,0]
    v_pk_fma_f32 v[6:7], v[8:9], v[198:199], v[6:7] op_sel_hi:[1,0,1]
    v_pk_fma_f32 v[8:9], v[6:7], v[198:199], v[190:191] op_sel:[1,1,0] op_sel_hi:[0,1,1] neg_lo:[1,0,0]
    v_pk_fma_f32 v[8:9], v[6:7], v[198:199], v[8:9] op_sel_hi:[1,0,1]
    v_cmp_u_f32 vcc, v8, v9
    s_nop 0
    s_cbranch_vccnz L_fs_31
L_fok_30:
    v_pk_mul_f32 v[6:7], v[8:9], v[202:203] op_sel_hi:[1,0]
    v_pk_fma_f32 v[6:7], v[8:9], v[202:203], v[6:7] op_sel:[1,1,0] op_sel_hi:[0,1,1] neg_lo:[1,0,0]
    buffer_load_dwordx4 a[164:167], v14, s[36:39], s47 offen offset:1024 sc1
    v_mov_b32 v10, v6
    v_mov_b32 v11, v7
    s_nop 0
    v_permlane16_swap_b32 v6, v10
    v_permlane16_swap_b32 v7, v11
    v_pk_add_f32 v[6:7], v[6:7], v[10:11]
    v_mov_b32 v10, v6
    v_mov_b32 v11, v7
    s_nop 0
    v_permlane32_swap_b32 v6, v10
    v_permlane32_swap_b32 v7, v11
    v_pk_add_f32 v[6:7], v[6:7], v[10:11]
    v_pk_fma_f32 v[218:219], v[6:7], v[200:201], v[218:219] op_sel:[1,1,0] op_sel_hi:[0,1,1] neg_lo:[1,0,0]
    v_pk_fma_f32 v[218:219], v[6:7], v[200:201], v[218:219] op_sel_hi:[1,0,1]
    v_pk_fma_f32 v[96:97], v[218:219], v[192:193], v[96:97] op_sel:[1,1,0] op_sel_hi:[0,1,1] neg_lo:[1,0,0]
    v_pk_fma_f32 v[96:97], v[218:219], v[192:193], v[96:97] op_sel_hi:[1,0,1]
    v_pk_fma_f32 v[98:99], v[96:97], v[192:193], v[98:99] op_sel:[1,1,0] op_sel_hi:[0,1,1] neg_lo:[1,0,0]
    v_pk_fma_f32 v[98:99], v[96:97], v[192:193], v[98:99] op_sel_hi:[1,0,1]
    v_pk_fma_f32 v[100:101], v[98:99], v[192:193], v[100:101] op_sel:[1,1,0] op_sel_hi:[0,1,1] neg_lo:[1,0,0]
    v_pk_fma_f32 v[100:101], v[98:99], v[192:193], v[100:101] op_sel_hi:[1,0,1]
    v_pk_fma_f32 v[102:103], v[100:101], v[192:193], v[102:103] op_sel:[1,1,0] op_sel_hi:[0,1,1] neg_lo:[1,0,0]
    v_pk_fma_f32 v[102:103], v[100:101], v[192:193], v[102:103] op_sel_hi:[1,0,1]
    v_cvt_pk_bf16_f32 v176, v96, v98
    v_cvt_pk_bf16_f32 v177, v100, v102
    v_cvt_pk_bf16_f32 v178, -v97, -v99
    v_cvt_pk_bf16_f32 v179, -v101, -v103
    ds_write_b64 v92, v[176:177] offset:0
    ds_write_b64 v92, v[178:179] offset:512
    ds_read_b64_tr_b16 v[96:97], v93 offset:0
    ds_read_b64_tr_b16 v[98:99], v93 offset:512
    v_pk_fma_f32 v[104:105], v[102:103], v[192:193], v[104:105] op_sel:[1,1,0] op_sel_hi:[0,1,1] neg_lo:[1,0,0]
    v_pk_fma_f32 v[104:105], v[102:103], v[192:193], v[104:105] op_sel_hi:[1,0,1]
    buffer_load_dwordx4 a[168:171], v14, s[36:39], s47 offen offset:2048 sc1
    v_pk_fma_f32 v[106:107], v[104:105], v[192:193], v[106:107] op_sel:[1,1,0] op_sel_hi:[0,1,1] neg_lo:[1,0,0]
    v_pk_fma_f32 v[106:107], v[104:105], v[192:193], v[106:107] op_sel_hi:[1,0,1]
    v_pk_fma_f32 v[108:109], v[106:107], v[192:193], v[108:109] op_sel:[1,1,0] op_sel_hi:[0,1,1] neg_lo:[1,0,0]
    v_pk_fma_f32 v[108:109], v[106:107], v[192:193], v[108:109] op_sel_hi:[1,0,1]
    v_pk_fma_f32 v[110:111], v[108:109], v[192:193], v[110:111] op_sel:[1,1,0] op_sel_hi:[0,1,1] neg_lo:[1,0,0]
    v_pk_fma_f32 v[110:111], v[108:109], v[192:193], v[110:111] op_sel_hi:[1,0,1]
    v_cvt_pk_bf16_f32 v180, v104, v106
    v_cvt_pk_bf16_f32 v181, v108, v110
    v_cvt_pk_bf16_f32 v182, -v105, -v107
    v_cvt_pk_bf16_f32 v183, -v109, -v111
    ds_write_b64 v92, v[180:181] offset:1024
    ds_write_b64 v92, v[182:183] offset:1536
    ds_read_b64_tr_b16 v[104:105], v93 offset:1024
    ds_read_b64_tr_b16 v[106:107], v93 offset:1536
    s_waitcnt lgkmcnt(4)
    buffer_store_dwordx4 v[96:99], v14, s[20:23], s82 offen offset:0 sc1
    v_pk_fma_f32 v[112:113], v[110:111], v[192:193], v[112:113] op_sel:[1,1,0] op_sel_hi:[0,1,1] neg_lo:[1,0,0]
    v_pk_fma_f32 v[112:113], v[110:111], v[192:193], v[112:113] op_sel_hi:[1,0,1]
    v_pk_fma_f32 v[114:115], v[112:113], v[192:193], v[114:115] op_sel:[1,1,0] op_sel_hi:[0,1,1] neg_lo:[1,0,0]
    v_pk_fma_f32 v[114:115], v[112:113], v[192:193], v[114:115] op_sel_hi:[1,0,1]
    v_pk_fma_f32 v[116:117], v[114:115], v[192:193], v[116:117] op_sel:[1,1,0] op_sel_hi:[0,1,1] neg_lo:[1,0,0]
    v_pk_fma_f32 v[116:117], v[114:115], v[192:193], v[116:117] op_sel_hi:[1,0,1]
    v_pk_fma_f32 v[118:119], v[116:117], v[192:193], v[118:119] op_sel:[1,1,0] op_sel_hi:[0,1,1] neg_lo:[1,0,0]
    v_pk_fma_f32 v[118:119], v[116:117], v[192:193], v[118:119] op_sel_hi:[1,0,1]
    v_cvt_pk_bf16_f32 v184, v112, v114
    v_cvt_pk_bf16_f32 v185, v116, v118
    v_cvt_pk_bf16_f32 v186, -v113, -v115
    v_cvt_pk_bf16_f32 v187, -v117, -v119
    ds_write_b64 v92, v[184:185] offset:2048
    ds_write_b64 v92, v[186:187] offset:2560
    ds_read_b64_tr_b16 v[112:113], v93 offset:2048
    ds_read_b64_tr_b16 v[114:115], v93 offset:2560
    s_waitcnt lgkmcnt(4)
    buffer_store_dwordx4 v[104:107], v14, s[20:23], s82 offen offset:1024 sc1
    v_pk_fma_f32 v[120:121], v[118:119], v[192:193], v[120:121] op_sel:[1,1,0] op_sel_hi:[0,1,1] neg_lo:[1,0,0]
    v_pk_fma_f32 v[120:121], v[118:119], v[192:193], v[120:121] op_sel_hi:[1,0,1]
    v_pk_fma_f32 v[122:123], v[120:121], v[192:193], v[122:123] op_sel:[1,1,0] op_sel_hi:[0,1,1] neg_lo:[1,0,0]
    v_pk_fma_f32 v[122:123], v[120:121], v[192:193], v[122:123] op_sel_hi:[1,0,1]
    v_pk_fma_f32 v[124:125], v[122:123], v[192:193], v[124:125] op_sel:[1,1,0] op_sel_hi:[0,1,1] neg_lo:[1,0,0]
    v_pk_fma_f32 v[124:125], v[122:123], v[192:193], v[124:125] op_sel_hi:[1,0,1]
    v_pk_fma_f32 v[126:127], v[124:125], v[192:193], v[126:127] op_sel:[1,1,0] op_sel_hi:[0,1,1] neg_lo:[1,0,0]
    v_pk_fma_f32 v[126:127], v[124:125], v[192:193], v[126:127] op_sel_hi:[1,0,1]
    v_cvt_pk_bf16_f32 v188, v120, v122
    v_cvt_pk_bf16_f32 v189, v124, v126
    v_cvt_pk_bf16_f32 v190, -v121, -v123
    v_cvt_pk_bf16_f32 v191, -v125, -v127
    ds_write_b64 v92, v[188:189] offset:3072
    ds_write_b64 v92, v[190:191] offset:3584
    ds_read_b64_tr_b16 v[120:121], v93 offset:3072
    ds_read_b64_tr_b16 v[122:123], v93 offset:3584
    s_waitcnt lgkmcnt(4)
    buffer_store_dwordx4 v[112:115], v14, s[20:23], s82 offen offset:2048 sc1
    s_waitcnt lgkmcnt(0)
    buffer_store_dwordx4 v[120:123], v14, s[20:23], s82 offen offset:3072 sc1
    s_add_u32 s56, s50, 2
    s_and_b32 s57, s56, 3
    s_lshl2_add_u32 s57, s49, s57
    s_mul_i32 s57, s57, 24
    s_lshr_b32 s58, s56, 3
    s_add_u32 s57, s58, s57
    s_bfe_u32 s58, s56, 0x10002
    s_mul_i32 s58, s58, 12
    s_add_u32 s57, s58, s57
    s_lshl_b32 s57, s57, 12
    s_add_u32 s82, s57, 5271552
    s_cmp_lt_u32 s56, 40
    s_cselect_b32 s82, s82, 1073741824
    s_lshl_b32 s56, s50, 12
    s_add_u32 s56, s56, 73728
    s_add_u32 s24, s94, s56
    s_addc_u32 s25, s95, 0
    s_cmp_lt_u32 s56, 229376
    s_cselect_b32 s26, 4096, 0
    s_mov_b32 s27, 0x20000
    s_waitcnt vmcnt(12)
    s_mov_b32 s55, 0
L_fh_32:
    v_pk_fma_f32 v[8:9], v[48:49], v[210:211], v[50:51] op_sel:[1,1,0] op_sel_hi:[0,1,1] neg_lo:[1,0,0]
    v_pk_fma_f32 v[8:9], v[48:49], v[210:211], v[8:9] op_sel_hi:[1,0,1]
    v_pk_fma_f32 v[6:7], v[8:9], v[210:211], v[52:53] op_sel:[1,1,0] op_sel_hi:[0,1,1] neg_lo:[1,0,0]
    v_pk_fma_f32 v[6:7], v[8:9], v[210:211], v[6:7] op_sel_hi:[1,0,1]
    v_pk_fma_f32 v[8:9], v[6:7], v[210:211], v[54:55] op_sel:[1,1,0] op_sel_hi:[0,1,1] neg_lo:[1,0,0]
    v_pk_fma_f32 v[8:9], v[6:7], v[210:211], v[8:9] op_sel_hi:[1,0,1]
    v_pk_fma_f32 v[6:7], v[8:9], v[210:211], v[56:57] op_sel:[1,1,0] op_sel_hi:[0,1,1] neg_lo:[1,0,0]
    v_pk_fma_f32 v[6:7], v[8:9], v[210:211], v[6:7] op_sel_hi:[1,0,1]
    v_pk_fma_f32 v[8:9], v[6:7], v[210:211], v[58:59] op_sel:[1,1,0] op_sel_hi:[0,1,1] neg_lo:[1,0,0]
    v_pk_fma_f32 v[8:9], v[6:7], v[210:211], v[8:9] op_sel_hi:[1,0,1]
    v_pk_fma_f32 v[6:7], v[8:9], v[210:211], v[60:61] op_sel:[1,1,0] op_sel_hi:[0,1,1] neg_lo:[1,0,0]
    v_pk_fma_f32 v[6:7], v[8:9], v[210:211], v[6:7] op_sel_hi:[1,0,1]
    v_pk_fma_f32 v[8:9], v[6:7], v[210:211], v[62:63] op_sel:[1,1,0] op_sel_hi:[0,1,1] neg_lo:[1,0,0]
    v_pk_fma_f32 v[8:9], v[6:7], v[210:211], v[8:9] op_sel_hi:[1,0,1]
    v_cmp_u_f32 vcc, v8, v9
    s_nop 0
    s_cbranch_vccnz L_fs_34
L_fok_33:
    v_pk_mul_f32 v[6:7], v[8:9], v[214:215] op_sel_hi:[1,0]
    v_pk_fma_f32 v[6:7], v[8:9], v[214:215], v[6:7] op_sel:[1,1,0] op_sel_hi:[0,1,1] neg_lo:[1,0,0]
    buffer_load_dwordx4 a[172:175], v14, s[36:39], s47 offen offset:3072 sc1
    v_mov_b32 v10, v6
    v_mov_b32 v11, v7
    s_nop 0
    v_permlane16_swap_b32 v6, v10
    v_permlane16_swap_b32 v7, v11
    v_pk_add_f32 v[6:7], v[6:7], v[10:11]
    v_mov_b32 v10, v6
    v_mov_b32 v11, v7
    s_nop 0
    v_permlane32_swap_b32 v6, v10
    v_permlane32_swap_b32 v7, v11
    v_pk_add_f32 v[6:7], v[6:7], v[10:11]
    v_pk_fma_f32 v[220:221], v[6:7], v[212:213], v[220:221] op_sel:[1,1,0] op_sel_hi:[0,1,1] neg_lo:[1,0,0]
    v_pk_fma_f32 v[220:221], v[6:7], v[212:213], v[220:221] op_sel_hi:[1,0,1]
    v_pk_fma_f32 v[128:129], v[220:221], v[204:205], v[128:129] op_sel:[1,1,0] op_sel_hi:[0,1,1] neg_lo:[1,0,0]
    v_pk_fma_f32 v[128:129], v[220:221], v[204:205], v[128:129] op_sel_hi:[1,0,1]
    v_pk_fma_f32 v[130:131], v[128:129], v[204:205], v[130:131] op_sel:[1,1,0] op_sel_hi:[0,1,1] neg_lo:[1,0,0]
    v_pk_fma_f32 v[130:131], v[128:129], v[204:205], v[130:131] op_sel_hi:[1,0,1]
    v_pk_fma_f32 v[132:133], v[130:131], v[204:205], v[132:133] op_sel:[1,1,0] op_sel_hi:[0,1,1] neg_lo:[1,0,0]
    v_pk_fma_f32 v[132:133], v[130:131], v[204:205], v[132:133] op_sel_hi:[1,0,1]
    v_pk_fma_f32 v[134:135], v[132:133], v[204:205], v[134:135] op_sel:[1,1,0] op_sel_hi:[0,1,1] neg_lo:[1,0,0]
    v_pk_fma_f32 v[134:135], v[132:133], v[204:205], v[134:135] op_sel_hi:[1,0,1]
    v_cvt_pk_bf16_f32 v48, v128, v130
    v_cvt_pk_bf16_f32 v49, v132, v134
    v_cvt_pk_bf16_f32 v50, -v129, -v131
    v_cvt_pk_bf16_f32 v51, -v133, -v135
    ds_write_b64 v92, v[48:49] offset:0
    ds_write_b64 v92, v[50:51] offset:512
    ds_read_b64_tr_b16 v[128:129], v93 offset:0
    ds_read_b64_tr_b16 v[130:131], v93 offset:512
    v_pk_fma_f32 v[136:137], v[134:135], v[204:205], v[136:137] op_sel:[1,1,0] op_sel_hi:[0,1,1] neg_lo:[1,0,0]
    v_pk_fma_f32 v[136:137], v[134:135], v[204:205], v[136:137] op_sel_hi:[1,0,1]
    s_add_u32 s47, s47, 1024
    buffer_load_dwordx4 a[176:179], v14, s[36:39], s47 offen offset:3072 sc1
    v_pk_fma_f32 v[138:139], v[136:137], v[204:205], v[138:139] op_sel:[1,1,0] op_sel_hi:[0,1,1] neg_lo:[1,0,0]
    v_pk_fma_f32 v[138:139], v[136:137], v[204:205], v[138:139] op_sel_hi:[1,0,1]
    v_pk_fma_f32 v[140:141], v[138:139], v[204:205], v[140:141] op_sel:[1,1,0] op_sel_hi:[0,1,1] neg_lo:[1,0,0]
    v_pk_fma_f32 v[140:141], v[138:139], v[204:205], v[140:141] op_sel_hi:[1,0,1]
    v_pk_fma_f32 v[142:143], v[140:141], v[204:205], v[142:143] op_sel:[1,1,0] op_sel_hi:[0,1,1] neg_lo:[1,0,0]
    v_pk_fma_f32 v[142:143], v[140:141], v[204:205], v[142:143] op_sel_hi:[1,0,1]
    v_cvt_pk_bf16_f32 v52, v136, v138
    v_cvt_pk_bf16_f32 v53, v140, v142
    v_cvt_pk_bf16_f32 v54, -v137, -v139
    v_cvt_pk_bf16_f32 v55, -v141, -v143
    ds_write_b64 v92, v[52:53] offset:1024
    ds_write_b64 v92, v[54:55] offset:1536
    ds_read_b64_tr_b16 v[136:137], v93 offset:1024
    ds_read_b64_tr_b16 v[138:139], v93 offset:1536
    s_waitcnt lgkmcnt(4)
    buffer_store_dwordx4 v[128:131], v14, s[20:23], s82 offen offset:0 sc1
    v_pk_fma_f32 v[144:145], v[142:143], v[204:205], v[144:145] op_sel:[1,1,0] op_sel_hi:[0,1,1] neg_lo:[1,0,0]
    v_pk_fma_f32 v[144:145], v[142:143], v[204:205], v[144:145] op_sel_hi:[1,0,1]
    v_pk_fma_f32 v[146:147], v[144:145], v[204:205], v[146:147] op_sel:[1,1,0] op_sel_hi:[0,1,1] neg_lo:[1,0,0]
    v_pk_fma_f32 v[146:147], v[144:145], v[204:205], v[146:147] op_sel_hi:[1,0,1]
    v_pk_fma_f32 v[148:149], v[146:147], v[204:205], v[148:149] op_sel:[1,1,0] op_sel_hi:[0,1,1] neg_lo:[1,0,0]
    v_pk_fma_f32 v[148:149], v[146:147], v[204:205], v[148:149] op_sel_hi:[1,0,1]
    v_pk_fma_f32 v[150:151], v[148:149], v[204:205], v[150:151] op_sel:[1,1,0] op_sel_hi:[0,1,1] neg_lo:[1,0,0]
    v_pk_fma_f32 v[150:151], v[148:149], v[204:205], v[150:151] op_sel_hi:[1,0,1]
    v_cvt_pk_bf16_f32 v56, v144, v146
    v_cvt_pk_bf16_f32 v57, v148, v150
    v_cvt_pk_bf16_f32 v58, -v145, -v147
    v_cvt_pk_bf16_f32 v59, -v149, -v151
    ds_write_b64 v92, v[56:57] offset:2048
    ds_write_b64 v92, v[58:59] offset:2560
    ds_read_b64_tr_b16 v[144:145], v93 offset:2048
    ds_read_b64_tr_b16 v[146:147], v93 offset:2560
    s_waitcnt lgkmcnt(4)
    buffer_store_dwordx4 v[136:139], v14, s[20:23], s82 offen offset:1024 sc1
    v_pk_fma_f32 v[152:153], v[150:151], v[204:205], v[152:153] op_sel:[1,1,0] op_sel_hi:[0,1,1] neg_lo:[1,0,0]
    v_pk_fma_f32 v[152:153], v[150:151], v[204:205], v[152:153] op_sel_hi:[1,0,1]
    v_pk_fma_f32 v[154:155], v[152:153], v[204:205], v[154:155] op_sel:[1,1,0] op_sel_hi:[0,1,1] neg_lo:[1,0,0]
    v_pk_fma_f32 v[154:155], v[152:153], v[204:205], v[154:155] op_sel_hi:[1,0,1]
    v_pk_fma_f32 v[156:157], v[154:155], v[204:205], v[156:157] op_sel:[1,1,0] op_sel_hi:[0,1,1] neg_lo:[1,0,0]
    v_pk_fma_f32 v[156:157], v[154:155], v[204:205], v[156:157] op_sel_hi:[1,0,1]
    v_pk_fma_f32 v[158:159], v[156:157], v[204:205], v[158:159] op_sel:[1,1,0] op_sel_hi:[0,1,1] neg_lo:[1,0,0]
    v_pk_fma_f32 v[158:159], v[156:157], v[204:205], v[158:159] op_sel_hi:[1,0,1]
    v_cvt_pk_bf16_f32 v60, v152, v154
    v_cvt_pk_bf16_f32 v61, v156, v158
    v_cvt_pk_bf16_f32 v62, -v153, -v155
    v_cvt_pk_bf16_f32 v63, -v157, -v159
    ds_write_b64 v92, v[60:61] offset:3072
    ds_write_b64 v92, v[62:63] offset:3584
    ds_read_b64_tr_b16 v[152:153], v93 offset:3072
    ds_read_b64_tr_b16 v[154:155], v93 offset:3584
    s_waitcnt lgkmcnt(4)
    buffer_store_dwordx4 v[144:147], v14, s[20:23], s82 offen offset:2048 sc1
    s_waitcnt lgkmcnt(0)
    buffer_store_dwordx4 v[152:155], v14, s[20:23], s82 offen offset:3072 sc1
    s_mov_b32 s47, 46080
    buffer_load_dwordx4 a[180:183], v14, s[36:39], s47 offen offset:0 sc1
    buffer_load_dwordx4 a[184:187], v14, s[36:39], s47 offen offset:1024 sc1
    buffer_load_dwordx4 a[188:191], v14, s[36:39], s47 offen offset:2048 sc1
    buffer_load_dwordx4 a[192:195], v14, s[36:39], s47 offen offset:3072 sc1
    s_add_u32 s47, s47, 1024
L_st_12:
    s_cbranch_execz L_tr_y
    buffer_load_dwordx4 a[196:199], v14, s[36:39], s47 offen offset:3072 sc1
    s_mov_b32 s47, 51200
    buffer_load_dwordx4 a[200:203], v14, s[36:39], s47 offen offset:0 sc1
    s_add_u32 s3, s3, 131072
    s_waitcnt vmcnt(6)
    s_mov_b64 exec, 1
    buffer_store_dword a255, off, s[20:23], s3 sc1
    s_mov_b64 exec, -1
    buffer_load_dwordx4 a[204:207], v14, s[36:39], s47 offen offset:1024 sc1
    buffer_load_dwordx4 a[208:211], v14, s[36:39], s47 offen offset:2048 sc1
    buffer_load_dwordx4 a[212:215], v14, s[36:39], s47 offen offset:3072 sc1
    s_add_u32 s47, s47, 1024
    buffer_load_dwordx4 a[216:219], v14, s[36:39], s47 offen offset:3072 sc1
    s_mov_b32 s47, 56320
    buffer_load_dwordx4 a[220:223], v14, s[36:39], s47 offen offset:0 sc1
    buffer_load_dwordx4 a[224:227], v14, s[36:39], s47 offen offset:1024 sc1
    buffer_load_dwordx4 a[228:231], v14, s[36:39], s47 offen offset:2048 sc1
    buffer_load_dwordx4 a[232:235], v14, s[36:39], s47 offen offset:3072 sc1
    s_add_u32 s47, s47, 1024
    buffer_load_dwordx4 a[236:239], v14, s[36:39], s47 offen offset:3072 sc1
    buffer_load_dword v13, v1, s[20:23], s100 offen sc1
    s_waitcnt vmcnt(0)
    s_branch L_p2
L_fs_28:
    s_mov_b32 s57, 0x7fa5a5a5
    s_mov_b64 s[58:59], 0
    v_cmp_eq_u32 vcc, s57, v160
    s_or_b64 s[58:59], s[58:59], vcc
    v_cmp_eq_u32 vcc, s57, v161
    s_or_b64 s[58:59], s[58:59], vcc
    v_cmp_eq_u32 vcc, s57, v162
    s_or_b64 s[58:59], s[58:59], vcc
    v_cmp_eq_u32 vcc, s57, v163
    s_or_b64 s[58:59], s[58:59], vcc
    v_cmp_eq_u32 vcc, s57, v164
    s_or_b64 s[58:59], s[58:59], vcc
    v_cmp_eq_u32 vcc, s57, v165
    s_or_b64 s[58:59], s[58:59], vcc
    v_cmp_eq_u32 vcc, s57, v166
    s_or_b64 s[58:59], s[58:59], vcc
    v_cmp_eq_u32 vcc, s57, v167
    s_or_b64 s[58:59], s[58:59], vcc
    v_cmp_eq_u32 vcc, s57, v168
    s_or_b64 s[58:59], s[58:59], vcc
    v_cmp_eq_u32 vcc, s57, v169
    s_or_b64 s[58:59], s[58:59], vcc
    v_cmp_eq_u32 vcc, s57, v170
    s_or_b64 s[58:59], s[58:59], vcc
    v_cmp_eq_u32 vcc, s57, v171
    s_or_b64 s[58:59], s[58:59], vcc
    v_cmp_eq_u32 vcc, s57, v172
    s_or_b64 s[58:59], s[58:59], vcc
    v_cmp_eq_u32 vcc, s57, v173
    s_or_b64 s[58:59], s[58:59], vcc
    v_cmp_eq_u32 vcc, s57, v174
    s_or_b64 s[58:59], s[58:59], vcc
    v_cmp_eq_u32 vcc, s57, v175
    s_or_b64 s[58:59], s[58:59], vcc
    s_cbranch_scc0 L_fok_27
    s_add_u32 s55, s55, 1
    s_cmp_gt_u32 s55, 200000
    s_cbranch_scc1 L_fok_27
    s_sleep 2
    buffer_load_dwordx2 v[160:161], v91, s[24:27], 0 offen offset:896 sc1
    buffer_load_dwordx2 v[162:163], v91, s[24:27], 0 offen offset:768 sc1
    buffer_load_dwordx2 v[164:165], v91, s[24:27], 0 offen offset:640 sc1
    buffer_load_dwordx2 v[166:167], v91, s[24:27], 0 offen offset:512 sc1
    buffer_load_dwordx2 v[168:169], v91, s[24:27], 0 offen offset:384 sc1
    buffer_load_dwordx2 v[170:171], v91, s[24:27], 0 offen offset:256 sc1
    buffer_load_dwordx2 v[172:173], v91, s[24:27], 0 offen offset:128 sc1
    buffer_load_dwordx2 v[174:175], v91, s[24:27], 0 offen offset:0 sc1
    s_waitcnt vmcnt(0)
    s_branch L_fh_26
L_fs_31:
    s_mov_b32 s57, 0x7fa5a5a5
    s_mov_b64 s[58:59], 0
    v_cmp_eq_u32 vcc, s57, v176
    s_or_b64 s[58:59], s[58:59], vcc
    v_cmp_eq_u32 vcc, s57, v177
    s_or_b64 s[58:59], s[58:59], vcc
    v_cmp_eq_u32 vcc, s57, v178
    s_or_b64 s[58:59], s[58:59], vcc
    v_cmp_eq_u32 vcc, s57, v179
    s_or_b64 s[58:59], s[58:59], vcc
    v_cmp_eq_u32 vcc, s57, v180
    s_or_b64 s[58:59], s[58:59], vcc
    v_cmp_eq_u32 vcc, s57, v181
    s_or_b64 s[58:59], s[58:59], vcc
    v_cmp_eq_u32 vcc, s57, v182
    s_or_b64 s[58:59], s[58:59], vcc
    v_cmp_eq_u32 vcc, s57, v183
    s_or_b64 s[58:59], s[58:59], vcc
    v_cmp_eq_u32 vcc, s57, v184
    s_or_b64 s[58:59], s[58:59], vcc
    v_cmp_eq_u32 vcc, s57, v185
    s_or_b64 s[58:59], s[58:59], vcc
    v_cmp_eq_u32 vcc, s57, v186
    s_or_b64 s[58:59], s[58:59], vcc
    v_cmp_eq_u32 vcc, s57, v187
    s_or_b64 s[58:59], s[58:59], vcc
    v_cmp_eq_u32 vcc, s57, v188
    s_or_b64 s[58:59], s[58:59], vcc
    v_cmp_eq_u32 vcc, s57, v189
    s_or_b64 s[58:59], s[58:59], vcc
    v_cmp_eq_u32 vcc, s57, v190
    s_or_b64 s[58:59], s[58:59], vcc
    v_cmp_eq_u32 vcc, s57, v191
    s_or_b64 s[58:59], s[58:59], vcc
    s_cbranch_scc0 L_fok_30
    s_add_u32 s55, s55, 1
    s_cmp_gt_u32 s55, 200000
    s_cbranch_scc1 L_fok_30
    s_sleep 2
    buffer_load_dwordx2 v[176:177], v91, s[24:27], 0 offen offset:896 sc1
    buffer_load_dwordx2 v[178:179], v91, s[24:27], 0 offen offset:768 sc1
    buffer_load_dwordx2 v[180:181], v91, s[24:27], 0 offen offset:640 sc1
    buffer_load_dwordx2 v[182:183], v91, s[24:27], 0 offen offset:512 sc1
    buffer_load_dwordx2 v[184:185], v91, s[24:27], 0 offen offset:384 sc1
    buffer_load_dwordx2 v[186:187], v91, s[24:27], 0 offen offset:256 sc1
    buffer_load_dwordx2 v[188:189], v91, s[24:27], 0 offen offset:128 sc1
    buffer_load_dwordx2 v[190:191], v91, s[24:27], 0 offen offset:0 sc1
    s_waitcnt vmcnt(0)
    s_branch L_fh_29
L_fs_34:
    s_mov_b32 s57, 0x7fa5a5a5
    s_mov_b64 s[58:59], 0
    v_cmp_eq_u32 vcc, s57, v48
    s_or_b64 s[58:59], s[58:59], vcc
    v_cmp_eq_u32 vcc, s57, v49
    s_or_b64 s[58:59], s[58:59], vcc
    v_cmp_eq_u32 vcc, s57, v50
    s_or_b64 s[58:59], s[58:59], vcc
    v_cmp_eq_u32 vcc, s57, v51
    s_or_b64 s[58:59], s[58:59], vcc
    v_cmp_eq_u32 vcc, s57, v52
    s_or_b64 s[58:59], s[58:59], vcc
    v_cmp_eq_u32 vcc, s57, v53
    s_or_b64 s[58:59], s[58:59], vcc
    v_cmp_eq_u32 vcc, s57, v54
    s_or_b64 s[58:59], s[58:59], vcc
    v_cmp_eq_u32 vcc, s57, v55
    s_or_b64 s[58:59], s[58:59], vcc
    v_cmp_eq_u32 vcc, s57, v56
    s_or_b64 s[58:59], s[58:59], vcc
    v_cmp_eq_u32 vcc, s57, v57
    s_or_b64 s[58:59], s[58:59], vcc
    v_cmp_eq_u32 vcc, s57, v58
    s_or_b64 s[58:59], s[58:59], vcc
    v_cmp_eq_u32 vcc, s57, v59
    s_or_b64 s[58:59], s[58:59], vcc
    v_cmp_eq_u32 vcc, s57, v60
    s_or_b64 s[58:59], s[58:59], vcc
    v_cmp_eq_u32 vcc, s57, v61
    s_or_b64 s[58:59], s[58:59], vcc
    v_cmp_eq_u32 vcc, s57, v62
    s_or_b64 s[58:59], s[58:59], vcc
    v_cmp_eq_u32 vcc, s57, v63
    s_or_b64 s[58:59], s[58:59], vcc
    s_cbranch_scc0 L_fok_33
    s_add_u32 s55, s55, 1
    s_cmp_gt_u32 s55, 200000
    s_cbranch_scc1 L_fok_33
    s_sleep 2
    buffer_load_dwordx2 v[48:49], v91, s[24:27], 0 offen offset:896 sc1
    buffer_load_dwordx2 v[50:51], v91, s[24:27], 0 offen offset:768 sc1
    buffer_load_dwordx2 v[52:53], v91, s[24:27], 0 offen offset:640 sc1
    buffer_load_dwordx2 v[54:55], v91, s[24:27], 0 offen offset:512 sc1
    buffer_load_dwordx2 v[56:57], v91, s[24:27], 0 offen offset:384 sc1
    buffer_load_dwordx2 v[58:59], v91, s[24:27], 0 offen offset:256 sc1
    buffer_load_dwordx2 v[60:61], v91, s[24:27], 0 offen offset:128 sc1
    buffer_load_dwordx2 v[62:63], v91, s[24:27], 0 offen offset:0 sc1
    s_waitcnt vmcnt(0)
    s_branch L_fh_32
L_codeend:
.section .rodata,"a"
.p2align 6
.amdhsa_kernel parallel_sum__ssm_conv_s5__swiglu_ffn__prompt_kernel
  .amdhsa_next_free_vgpr 512
  .amdhsa_next_free_sgpr 102
  .amdhsa_accum_offset 256
  .amdhsa_group_segment_fixed_size 0
  .amdhsa_kernarg_size 128
  .amdhsa_user_sgpr_count 2
  .amdhsa_user_sgpr_kernarg_segment_ptr 1
  .amdhsa_system_sgpr_workgroup_id_x 1
  .amdhsa_float_denorm_mode_32 3
.end_amdhsa_kernel
```
